```python
import torch

def _softmax(x, axis=-1):
    return torch.softmax(x, dim=axis)
def _gelu(x):
    return torch.nn.functional.gelu(x, approximate="tanh")
def _silu(x):
    return torch.nn.functional.silu(x)
def _sigmoid(x):
    return torch.sigmoid(x)
def _layernorm(x, axis=-1, eps=1e-5):
    m = x.mean(dim=axis, keepdim=True)
    v = x.var(dim=axis, keepdim=True, unbiased=False)
    return (x - m) / torch.sqrt(v + eps)
def _scatter_add(tgt, idx, src, axis=0):
    return tgt.clone().index_add_(axis, idx, src)
def _segment_sum(src, seg, n):
    out = torch.zeros((n,) + src.shape[1:], dtype=src.dtype)
    return out.index_add_(0, seg, src)
def _pad(x, pw):
    flat = tuple(v for pair in reversed(pw) for v in pair)
    return torch.nn.functional.pad(x, flat)

kernel_name = 'parallel_sum__sliding_block__dense_activation_gelu__prompt'

def setup_inputs():

    _w = (lambda a: (lambda t: t.to(torch.bfloat16) if t.is_floating_point() else t)(torch.as_tensor(a)))
    def _A_setup():
        B, S, D = 1, 2048, 576
        return {
            "x": _w((lambda *s: torch.randn(*s, dtype=torch.bfloat16) * 0.05)(B, S, D)),
            "wqkv": _w((lambda *s: torch.randn(*s, dtype=torch.bfloat16) * 0.05)(D, 3 * D)),
            "wo": _w((lambda *s: torch.randn(*s, dtype=torch.bfloat16) * 0.05)(D, D)),
        }
    _A_in = _A_setup()

    def _B_setup():
        B, S, D, F = 1, 2048, 576, 4608
        return {
            "x": _w((lambda *s: torch.randn(*s, dtype=torch.bfloat16) * 0.05)(B, S, D)),
            "w1": _w((lambda *s: torch.randn(*s, dtype=torch.bfloat16) * 0.8)(D, F) * (D ** -0.5)),
            "b1": _w((lambda *s: torch.randn(*s, dtype=torch.bfloat16) * 0.8)(F) * 0.01),
            "w2": _w((lambda *s: torch.randn(*s, dtype=torch.bfloat16) * 0.8)(F, D) * (F ** -0.5)),
            "b2": _w((lambda *s: torch.randn(*s, dtype=torch.bfloat16) * 0.8)(D) * 0.01),
        }
    _B_in = _B_setup()

    return {
        "A_x": _A_in["x"],
        "A_wqkv": _A_in["wqkv"],
        "A_wo": _A_in["wo"],
        "B_x": _B_in["x"],
        "B_w1": _B_in["w1"],
        "B_b1": _B_in["b1"],
        "B_w2": _B_in["w2"],
        "B_b2": _B_in["b2"],
    }

def reference(A_x, A_wqkv, A_wo, B_x, B_w1, B_b1, B_w2, B_b2):
    def _A_ref(x, wqkv, wo):
        B, S, D = x.shape
        H = 32; Dh = D // H; W = 256
        qkv = (lambda x, *d: x.permute(*d))((x @ wqkv).reshape(B, S, 3, H, Dh), 2, 0, 3, 1, 4)
        q, k, v = qkv[0], qkv[1], qkv[2]
        scores = torch.einsum("bhqd,bhkd->bhqk", q, k) * (Dh ** -0.5)
        idx = torch.arange(S)
        mask = (idx[:, None] - idx[None, :] >= 0) & (idx[:, None] - idx[None, :] < W)
        scores = torch.where(mask[None, None], scores, -1e9)
        p = _softmax(scores, axis=-1)
        o = torch.einsum("bhqk,bhkd->bhqd", p, v)
        return (lambda x, *d: x.permute(*d))(o, 0, 2, 1, 3).reshape(B, S, D) @ wo

    def _B_ref(x, w1, b1, w2, b2):
        h = torch.einsum("bsd,df->bsf", x, w1) + b1
        h = _gelu(h)
        return torch.einsum("bsf,fd->bsd", h, w2) + b2

    x = A_x
    xn = _layernorm(x, axis=-1)
    return x + _A_ref(xn, A_wqkv, A_wo) + _B_ref(xn, B_w1, B_b1, B_w2, B_b2)
```

```asm
; @launch grid=(256,1,1) block=(512,1,1) lds=163840
.amdgcn_target "amdgcn-amd-amdhsa--gfx950"
.text
.globl parallel_sum__sliding_block__dense_activation_gelu__prompt_kernel
.p2align 8
.type parallel_sum__sliding_block__dense_activation_gelu__prompt_kernel,@function
parallel_sum__sliding_block__dense_activation_gelu__prompt_kernel:
    s_cmp_ge_u32 s2, 256
    s_cbranch_scc1 L_k1_end
    s_load_dwordx4 s[72:75], s[0:1], 0
    s_load_dwordx4 s[76:79], s[0:1], 32
    s_load_dwordx4 s[64:67], s[0:1], 72
    s_getpc_b64 s[80:81]
L_k1_pc:
    v_lshrrev_b32 v80, 6, v0
    s_and_b32 s37, s2, 0xf8
    v_add_u32 v80, s37, v80
    v_mul_u32_u24 v81, 2341, v80
    v_lshrrev_b32 v81, 16, v81
    v_mul_u32_u24 v81, 28, v81
    v_sub_u32 v80, v80, v81
    v_lshlrev_b32 v80, 11, v80
    v_and_b32 v81, 15, v0
    v_lshl_add_u32 v80, v81, 7, v80
    v_min_u32 v80, L_text_end-L_k1_pc-4, v80
    s_mov_b64 exec, 0xffff
    global_load_dword a104, v80, s[80:81]
    s_mov_b64 exec, -1
    v_lshrrev_b32 v1, 6, v0
    v_and_b32 v0, 63, v0
    v_readfirstlane_b32 s20, v1
    s_and_b32 s41, s2, 7
    s_lshr_b32 s42, s41, 2
    s_and_b32 s37, s41, 3
    s_lshr_b32 s40, s2, 5
    s_lshl_b32 s38, s42, 3
    s_add_u32 s23, s40, s38
    s_bfe_u32 s49, s2, 0x20003
    s_lshr_b32 s70, s2, 3
    s_and_b32 s21, s20, 3
    s_lshr_b32 s22, s20, 2
    s_mov_b32 s45, 0x3f803f80
    s_mov_b32 s6, 2359296
    s_mov_b32 s7, 0x00020000
    s_mov_b32 s11, 0x00020000
    s_mov_b32 s15, 0x00020000
    s_mov_b32 s19, 0x00020000
    s_mov_b32 s59, 0x00020000
    s_mov_b32 s63, 0x00020000
    s_mov_b32 s18, 47647744
    s_mov_b32 s54, 1
    s_waitcnt lgkmcnt(0)
    s_mov_b32 s4, s72
    s_mov_b32 s5, s73
    s_mov_b32 s12, s78
    s_mov_b32 s13, s79
    s_mov_b32 s60, s78
    s_mov_b32 s61, s79
    s_mov_b32 s16, s66
    s_mov_b32 s17, s67
    s_cmp_eq_u32 s49, 3
    s_cbranch_scc1 L_k1_qkv
    s_mov_b32 s8, s76
    s_mov_b32 s9, s77
    s_mov_b32 s10, 5308416
    s_mov_b32 s14, 9216
    s_mov_b32 s25, 9216
    s_mul_i32 s35, s37, 18
    s_mul_i32 s38, s49, 6
    s_add_u32 s35, s35, s38
    s_mov_b32 s36, 0
    s_mov_b32 s34, 6
    s_mov_b32 s24, 0
    s_mov_b32 s53, 47475712
    s_mul_i32 s38, s40, 3
    s_add_u32 s38, s38, s49
    s_mul_i32 s39, s42, 12
    s_add_u32 s39, s39, s38
    s_lshr_b32 s55, s39, 3
    s_mul_i32 s55, s55, 12
    s_and_b32 s39, s39, 7
    s_add_u32 s39, s39, s55
    s_mul_i32 s55, s37, 36
    s_add_u32 s39, s39, s55
    s_add_u32 s39, s39, 58
    s_mov_b32 s55, 4
    s_cmp_eq_u32 s37, 1
    s_cselect_b32 s55, 18, s55
    s_cmp_eq_u32 s37, 2
    s_cselect_b32 s55, 36, s55
    s_cmp_eq_u32 s37, 3
    s_cselect_b32 s55, 46, s55
    s_mul_i32 s46, s42, 5
    s_add_u32 s55, s55, s46
    s_add_u32 s55, s55, s38
    s_sub_u32 s55, s55, 12
    s_cmp_ge_u32 s55, 54
    s_cselect_b32 s55, -1, s55
    s_cmp_ge_u32 s38, 17
    s_cselect_b32 s55, -1, s55
    s_cmp_lt_u32 s38, 12
    s_cselect_b32 s55, s39, s55
    s_branch L_k1_cfg
L_k1_qkv:
    s_mov_b32 s8, s74
    s_mov_b32 s9, s75
    s_mov_b32 s10, 1990656
    s_mov_b32 s14, 0
    s_mov_b32 s25, 3456
    s_mov_b32 s53, 47448064
    s_mov_b32 s55, -1
    s_mul_i32 s35, s37, 7
    s_cmp_eq_u32 s37, 3
    s_cselect_b32 s35, 16, s35
    s_cselect_b32 s34, 6, 7
    s_cselect_b32 s36, 5, 0
    s_cmp_eq_u32 s37, 2
    s_cselect_b32 s36, 2, s36
    s_cmp_ge_u32 s37, 2
    s_cselect_b32 s24, 2, 1
L_k1_cfg:
    s_mul_i32 s26, s25, 192
    s_mul_i32 s38, s20, 24
    s_mul_i32 s27, s38, s25
    s_mov_b32 s44, s35
    s_lshl_b32 s38, s35, 7
    s_lshl_b32 s39, s20, 3
    s_mul_i32 s48, s39, s25
    s_add_u32 s48, s48, s38
    s_add_u32 s39, s35, s36
    s_add_u32 s39, s39, 2
    s_lshl_b32 s28, s39, 7
    s_add_u32 s29, s28, 128
    s_mov_b32 s33, 1
    s_mul_i32 s31, s20, 3072
    s_add_u32 s30, s31, 73728
    s_mov_b32 s32, 73728
    s_lshl_b32 s38, s23, 7
    s_lshl_b32 s39, s20, 4
    s_add_u32 s38, s38, s39
    s_mul_i32 s47, s38, 1152
    v_lshrrev_b32 v92, 3, v0
    v_and_b32 v93, 7, v0
    v_lshrrev_b32 v94, 4, v0
    v_xor_b32 v95, v93, v94
    v_lshlrev_b32 v95, 4, v95
    s_movk_i32 s38, 1152
    v_mad_u32_u24 v30, v92, s38, v95
    v_xor_b32 v95, 64, v95
    v_mad_u32_u24 v31, v92, s38, v95
    v_add_u32 v31, 8192, v31
    v_and_b32 v95, 1, v94
    v_lshlrev_b32 v95, 2, v95
    v_xor_b32 v95, v95, v93
    v_lshlrev_b32 v95, 4, v95
    v_mad_u32_u24 v4, v92, s25, v95
    v_and_b32 v92, 31, v0
    s_lshl_b32 s38, s22, 6
    v_lshlrev_b32 v9, 1, v92
    v_add_u32 v9, s38, v9
    s_lshl_b32 s37, s20, 11
    s_add_u32 m0, s37, 106496
    s_add_u32 s38, s47, 0
    buffer_load_dwordx4 v30, s[4:7], s38 offen lds
    buffer_load_dwordx4 v31, s[4:7], s38 offen offset:1024 lds
    s_lshl_b32 s37, s20, 10
    s_add_u32 m0, s37, 122880
    s_mul_i32 s38, s25, 0
    s_add_u32 s38, s38, s48
    buffer_load_dwordx4 v4, s[8:11], s38 offen lds
    s_add_u32 m0, s37, 131072
    s_add_u32 s38, s38, 128
    buffer_load_dwordx4 v4, s[8:11], s38 offen lds
    s_lshl_b32 s38, s25, 3
    s_sub_u32 s38, s38, 1024
    v_add_u32 v5, s38, v4
    v_add_u32 v6, s38, v5
    v_and_b32 v98, 31, v0
    v_lshrrev_b32 v99, 5, v0
    v_and_b32 v92, 15, v0
    v_lshrrev_b32 v93, 2, v92
    v_lshl_add_u32 v93, v99, 3, v93
    v_bfe_u32 v94, v0, 4, 1
    v_lshlrev_b32 v94, 1, v94
    v_bfe_u32 v95, v0, 1, 1
    v_add_u32 v94, v94, v95
    s_lshl_b32 s38, s22, 2
    v_add_u32 v94, s38, v94
    v_bfe_u32 v95, v0, 3, 1
    v_lshlrev_b32 v95, 2, v95
    v_xor_b32 v94, v94, v95
    v_lshlrev_b32 v93, 7, v93
    v_lshl_add_u32 v93, v94, 4, v93
    v_and_b32 v95, 1, v0
    v_lshl_add_u32 v93, v95, 3, v93
    v_add_u32 v90, 122880, v93
    s_lshl_b32 s38, s21, 11
    v_add_u32 v91, s38, v90
    v_add_u32 v1, 0, v93
    v_add_u32 v2, 24576, v93
    v_add_u32 v3, 49152, v93
    v_bfe_u32 v92, v98, 1, 3
    s_lshl_b32 s38, s21, 12
    s_add_u32 s38, s38, 106496
    v_lshlrev_b32 v94, 7, v98
    v_add_u32 v94, s38, v94
    v_add_u32 v95, 0, v99
    v_xor_b32 v95, v95, v92
    v_lshl_add_u32 v80, v95, 4, v94
    v_add_u32 v95, 2, v99
    v_xor_b32 v95, v95, v92
    v_lshl_add_u32 v81, v95, 4, v94
    v_add_u32 v95, 4, v99
    v_xor_b32 v95, v95, v92
    v_lshl_add_u32 v82, v95, 4, v94
    v_add_u32 v95, 6, v99
    v_xor_b32 v95, v95, v92
    v_lshl_add_u32 v83, v95, 4, v94
    s_lshl_b32 s38, s22, 2
    v_add_u32 v95, 0, v99
    v_add_u32 v95, s38, v95
    v_xor_b32 v95, v95, v92
    v_lshl_add_u32 v84, v95, 4, v94
    v_add_u32 v95, 2, v99
    v_add_u32 v95, s38, v95
    v_xor_b32 v95, v95, v92
    v_lshl_add_u32 v85, v95, 4, v94
    v_mov_b32 v86, 0
    v_mov_b32 v87, 0
    v_mov_b32 v88, 0
    v_mov_b32 v89, 0
    v_mov_b32 v11, 0
    v_mov_b32 v12, 0
    s_lshl_b32 s37, s20, 11
    s_add_u32 m0, s37, 0
    s_add_u32 s38, s47, 128
    buffer_load_dwordx4 v30, s[4:7], s38 offen lds
    buffer_load_dwordx4 v31, s[4:7], s38 offen offset:1024 lds
    s_lshl_b32 s37, s20, 10
    s_add_u32 m0, s37, 16384
    s_mul_i32 s38, s25, 64
    s_add_u32 s38, s38, s48
    buffer_load_dwordx4 v4, s[8:11], s38 offen lds
    s_add_u32 m0, s37, 24576
    s_add_u32 s38, s38, 128
    buffer_load_dwordx4 v4, s[8:11], s38 offen lds
    s_lshl_b32 s38, s22, 10
    s_add_u32 s38, s38, 147456
    v_lshlrev_b32 v14, 5, v98
    v_add_u32 v14, s38, v14
    s_lshl_b32 s38, s21, 3
    v_lshl_add_u32 v13, v99, 2, v14
    v_add_u32 v13, s38, v13
    s_lshl_b32 s38, s21, 7
    s_add_u32 s38, s38, 159744
    v_lshlrev_b32 v29, 4, v99
    v_add_u32 v29, s38, v29
    s_lshl_b32 s38, s23, 2
    s_add_u32 s38, s38, s21
    s_mul_i32 s50, s38, 73728
    s_lshl_b32 s39, s22, 11
    s_add_u32 s50, s50, s39
    s_mul_i32 s51, s38, 36864
    s_lshl_b32 s39, s22, 9
    s_add_u32 s51, s51, s39
    s_add_u32 s51, s51, 4718592
    s_mul_i32 s52, s38, 294912
    s_lshl_b32 s39, s22, 10
    s_add_u32 s52, s52, s39
    s_add_u32 s52, s52, 7077888
    s_movk_i32 s38, 9216
    v_lshlrev_b32 v92, 4, v98
    v_mad_u32_u24 v8, v99, s38, v92
    v_lshlrev_b32 v7, 4, v0
    s_cmp_lg_u32 s24, 0
    s_cbranch_scc1 L_k1_sta_done
    v_and_b32 v92, 15, v98
    v_lshlrev_b32 v92, 4, v92
    v_lshl_add_u32 v92, v99, 8, v92
    v_lshrrev_b32 v93, 4, v98
    s_mov_b32 s38, 147456
    v_mul_lo_u32 v93, v93, s38
    v_add_u32 v7, v92, v93
L_k1_sta_done:
    s_cmp_lt_i32 s55, 54
    s_cselect_b32 s56, s74, s76
    s_cselect_b32 s57, s75, s77
    s_mov_b32 s58, 5308416
    s_cselect_b32 s58, 1990656, s58
    s_cselect_b32 s62, 0, 9216
    s_mov_b32 s68, 9216
    s_cselect_b32 s68, 3456, s68
    s_cselect_b32 s38, 0, 54
    s_sub_u32 s38, s55, s38
    s_lshl_b32 s39, s38, 6
    s_mul_i32 s38, s20, 72
    s_mul_i32 s69, s38, s68
    s_add_u32 s69, s69, s39
    v_lshrrev_b32 v24, 2, v0
    v_and_b32 v25, 3, v0
    v_lshlrev_b32 v25, 4, v25
    v_mad_u32_u24 v92, v24, s68, v25
    v_cmp_gt_u32 vcc, 32, v0
    v_lshlrev_b32 v24, 1, v98
    v_mov_b32 v93, 1073741824
    v_cndmask_b32 v93, v93, v92, vcc
    v_add_u32 v94, s39, v24
    s_lshl_b32 s38, s20, 9
    s_add_u32 s38, s38, 155648
    v_lshrrev_b32 v24, 4, v0
    v_lshlrev_b32 v24, 7, v24
    v_lshl_add_u32 v24, v25, 1, v24
    v_add_u32 v95, s38, v24
    s_lshl_b32 s37, s20, 11
    s_add_u32 m0, s37, 32768
    s_add_u32 s38, s47, 256
    buffer_load_dwordx4 v30, s[4:7], s38 offen lds
    buffer_load_dwordx4 v31, s[4:7], s38 offen offset:1024 lds
    s_lshl_b32 s37, s20, 10
    s_add_u32 m0, s37, 49152
    s_mul_i32 s38, s25, 128
    s_add_u32 s38, s38, s48
    buffer_load_dwordx4 v4, s[8:11], s38 offen lds
    s_add_u32 m0, s37, 57344
    s_add_u32 s38, s38, 128
    buffer_load_dwordx4 v4, s[8:11], s38 offen lds
    s_lshl_b32 s38, s44, 7
    buffer_load_ushort v10, v9, s[12:15], s38 offen
    buffer_load_ushort v28, v9, s[12:15], s38 offen offset:128
    s_waitcnt vmcnt(10)
    s_barrier
    ds_read_b128 a[0:3], v80
    ds_read_b64_tr_b16 v[32:33], v90 offset:0
    ds_read_b64_tr_b16 v[34:35], v90 offset:512
    ds_read_b64_tr_b16 v[36:37], v90 offset:8192
    ds_read_b64_tr_b16 v[38:39], v90 offset:8704
    ds_read_b128 a[4:7], v81
    ds_read_b64_tr_b16 v[40:41], v90 offset:2048
    ds_read_b64_tr_b16 v[42:43], v90 offset:2560
    ds_read_b64_tr_b16 v[44:45], v90 offset:10240
    ds_read_b64_tr_b16 v[46:47], v90 offset:10752
    ds_read_b128 a[8:11], v82
    ds_read_b128 a[12:15], v83
    ds_read_b128 v[104:107], v84
    ds_read_b128 v[108:111], v85
    ds_read_b64_tr_b16 v[96:97], v91 offset:0
    ds_read_b64_tr_b16 v[98:99], v91 offset:512
    ds_read_b64_tr_b16 v[100:101], v91 offset:8192
    ds_read_b64_tr_b16 v[102:103], v91 offset:8704
    s_waitcnt lgkmcnt(13)
    v_mfma_f32_32x32x16_bf16 v[64:79], v[32:35], a[0:3], 0
    s_lshl_b32 s37, s20, 11
    s_add_u32 m0, s37, 73728
    s_add_u32 s38, s47, 384
    buffer_load_dwordx4 v30, s[4:7], s38 offen lds
    v_mfma_f32_32x32x16_bf16 v[48:63], v[36:39], a[0:3], 0
    buffer_load_dwordx4 v31, s[4:7], s38 offen offset:1024 lds
    ds_read_b64_tr_b16 v[32:33], v90 offset:4096
    ds_read_b64_tr_b16 v[34:35], v90 offset:4608
    ds_read_b64_tr_b16 v[36:37], v90 offset:12288
    ds_read_b64_tr_b16 v[38:39], v90 offset:12800
    s_waitcnt lgkmcnt(12)
    v_mfma_f32_32x32x16_bf16 v[64:79], v[40:43], a[4:7], v[64:79]
    s_lshl_b32 s37, s20, 10
    s_add_u32 m0, s37, 90112
    s_mul_i32 s38, s25, 192
    s_add_u32 s38, s38, s48
    buffer_load_dwordx4 v4, s[8:11], s38 offen lds
    v_mfma_f32_32x32x16_bf16 v[48:63], v[44:47], a[4:7], v[48:63]
    s_add_u32 m0, s37, 98304
    s_add_u32 s38, s38, 128
    buffer_load_dwordx4 v4, s[8:11], s38 offen lds
    ds_read_b64_tr_b16 v[40:41], v90 offset:6144
    ds_read_b64_tr_b16 v[42:43], v90 offset:6656
    ds_read_b64_tr_b16 v[44:45], v90 offset:14336
    ds_read_b64_tr_b16 v[46:47], v90 offset:14848
    s_waitcnt lgkmcnt(4)
    v_mfma_f32_32x32x16_bf16 v[64:79], v[32:35], a[8:11], v[64:79]
    v_mfma_f32_32x32x16_bf16 v[48:63], v[36:39], a[8:11], v[48:63]
    v_add_u32 v80, 0xfffe6000, v80
    v_add_u32 v81, 0xfffe6000, v81
    v_add_u32 v82, 0xfffe6000, v82
    v_add_u32 v83, 0xfffe6000, v83
    v_add_u32 v84, 0xfffe6000, v84
    v_add_u32 v85, 0xfffe6000, v85
    v_add_u32 v91, 0xfffe6000, v91
    v_add_u32 v90, 0xfffe6000, v90
    s_waitcnt lgkmcnt(0)
    v_mfma_f32_32x32x16_bf16 v[64:79], v[40:43], a[12:15], v[64:79]
    v_mfma_f32_32x32x16_bf16 v[48:63], v[44:47], a[12:15], v[48:63]
    s_cmp_lt_i32 s55, 0
    s_cbranch_scc1 L_k1_a0
    s_mul_i32 s39, s68, 0
    s_add_u32 s39, s39, s69
    buffer_load_dwordx4 a[108:111], v92, s[56:59], s39 offen
    s_mul_i32 s39, s68, 16
    s_add_u32 s39, s39, s69
    buffer_load_dwordx4 a[112:115], v92, s[56:59], s39 offen
    s_mul_i32 s39, s68, 32
    s_add_u32 s39, s39, s69
    buffer_load_dwordx4 a[116:119], v92, s[56:59], s39 offen
    s_mul_i32 s39, s68, 48
    s_add_u32 s39, s39, s69
    buffer_load_dwordx4 a[120:123], v92, s[56:59], s39 offen
    s_mul_i32 s39, s68, 64
    s_add_u32 s39, s39, s69
    buffer_load_dwordx4 a[124:127], v93, s[56:59], s39 offen
    buffer_load_ushort v94, v94, s[60:63], 0 offen
L_k1_a0:
    s_cmp_lg_u32 s20, 0
    s_cbranch_scc1 L_k1_fz
    v_lshlrev_b32 v24, 15, v0
    v_mov_b32 v25, 0
    s_lshl_b32 s39, s2, 7
    s_add_u32 s39, s39, 47549440
    s_mov_b64 exec, 7
    buffer_store_dword v25, v24, s[16:19], s39 offen sc1
    s_mov_b64 exec, -1
L_k1_fz:
    s_waitcnt vmcnt(10) lgkmcnt(8)
    s_barrier
    ds_read_b128 a[16:19], v80
    ds_read_b64_tr_b16 v[32:33], v90 offset:0
    ds_read_b64_tr_b16 v[34:35], v90 offset:512
    ds_read_b64_tr_b16 v[36:37], v90 offset:8192
    ds_read_b64_tr_b16 v[38:39], v90 offset:8704
    ds_read_b128 a[20:23], v81
    ds_read_b64_tr_b16 v[40:41], v90 offset:2048
    ds_read_b64_tr_b16 v[42:43], v90 offset:2560
    ds_read_b64_tr_b16 v[44:45], v90 offset:10240
    ds_read_b64_tr_b16 v[46:47], v90 offset:10752
    ds_read_b128 a[24:27], v82
    ds_read_b128 a[28:31], v83
    v_dot2_f32_bf16 v86, v104, s45, v86
    v_dot2_f32_bf16 v87, v104, v104, v87
    v_dot2_f32_bf16 v86, v105, s45, v86
    v_dot2_f32_bf16 v87, v105, v105, v87
    v_dot2_f32_bf16 v86, v106, s45, v86
    v_dot2_f32_bf16 v87, v106, v106, v87
    v_dot2_f32_bf16 v86, v107, s45, v86
    v_dot2_f32_bf16 v87, v107, v107, v87
    v_dot2_f32_bf16 v88, v108, s45, v88
    v_dot2_f32_bf16 v89, v108, v108, v89
    v_dot2_f32_bf16 v88, v109, s45, v88
    v_dot2_f32_bf16 v89, v109, v109, v89
    s_lshl_b32 s37, s20, 11
    s_add_u32 m0, s37, 106496
    s_add_u32 s38, s47, 512
    buffer_load_dwordx4 v30, s[4:7], s38 offen lds
    v_dot2_f32_bf16 v88, v110, s45, v88
    v_dot2_f32_bf16 v89, v110, v110, v89
    v_dot2_f32_bf16 v88, v111, s45, v88
    v_dot2_f32_bf16 v89, v111, v111, v89
    v_dot2_f32_bf16 v11, v96, s45, v11
    v_dot2_f32_bf16 v12, v100, s45, v12
    v_dot2_f32_bf16 v11, v97, s45, v11
    v_dot2_f32_bf16 v12, v101, s45, v12
    v_dot2_f32_bf16 v11, v98, s45, v11
    v_dot2_f32_bf16 v12, v102, s45, v12
    v_dot2_f32_bf16 v11, v99, s45, v11
    v_dot2_f32_bf16 v12, v103, s45, v12
    ds_read_b128 v[104:107], v84
    ds_read_b128 v[108:111], v85
    ds_read_b64_tr_b16 v[96:97], v91 offset:0
    ds_read_b64_tr_b16 v[98:99], v91 offset:512
    ds_read_b64_tr_b16 v[100:101], v91 offset:8192
    ds_read_b64_tr_b16 v[102:103], v91 offset:8704
    s_waitcnt lgkmcnt(13)
    v_mfma_f32_32x32x16_bf16 v[64:79], v[32:35], a[16:19], v[64:79]
    buffer_load_dwordx4 v31, s[4:7], s38 offen offset:1024 lds
    v_mfma_f32_32x32x16_bf16 v[48:63], v[36:39], a[16:19], v[48:63]
    s_lshl_b32 s37, s20, 10
    s_add_u32 m0, s37, 122880
    s_mul_i32 s38, s25, 256
    s_add_u32 s38, s38, s48
    buffer_load_dwordx4 v4, s[8:11], s38 offen lds
    ds_read_b64_tr_b16 v[32:33], v90 offset:4096
    ds_read_b64_tr_b16 v[34:35], v90 offset:4608
    ds_read_b64_tr_b16 v[36:37], v90 offset:12288
    ds_read_b64_tr_b16 v[38:39], v90 offset:12800
    s_waitcnt lgkmcnt(12)
    v_mfma_f32_32x32x16_bf16 v[64:79], v[40:43], a[20:23], v[64:79]
    s_add_u32 m0, s37, 131072
    s_add_u32 s38, s38, 128
    buffer_load_dwordx4 v4, s[8:11], s38 offen lds
    v_mfma_f32_32x32x16_bf16 v[48:63], v[44:47], a[20:23], v[48:63]
    ds_read_b64_tr_b16 v[40:41], v90 offset:6144
    ds_read_b64_tr_b16 v[42:43], v90 offset:6656
    ds_read_b64_tr_b16 v[44:45], v90 offset:14336
    ds_read_b64_tr_b16 v[46:47], v90 offset:14848
    s_waitcnt lgkmcnt(4)
    v_mfma_f32_32x32x16_bf16 v[64:79], v[32:35], a[24:27], v[64:79]
    v_mfma_f32_32x32x16_bf16 v[48:63], v[36:39], a[24:27], v[48:63]
    v_add_u32 v80, 0x8000, v80
    v_add_u32 v81, 0x8000, v81
    v_add_u32 v82, 0x8000, v82
    v_add_u32 v83, 0x8000, v83
    v_add_u32 v84, 0x8000, v84
    v_add_u32 v85, 0x8000, v85
    v_add_u32 v91, 0x8000, v91
    v_add_u32 v90, 0x8000, v90
    s_waitcnt lgkmcnt(0)
    v_mfma_f32_32x32x16_bf16 v[64:79], v[40:43], a[28:31], v[64:79]
    v_mfma_f32_32x32x16_bf16 v[48:63], v[44:47], a[28:31], v[48:63]
    s_waitcnt vmcnt(10) lgkmcnt(8)
    s_barrier
    ds_read_b128 a[32:35], v80
    ds_read_b64_tr_b16 v[32:33], v90 offset:0
    ds_read_b64_tr_b16 v[34:35], v90 offset:512
    ds_read_b64_tr_b16 v[36:37], v90 offset:8192
    ds_read_b64_tr_b16 v[38:39], v90 offset:8704
    ds_read_b128 a[36:39], v81
    ds_read_b64_tr_b16 v[40:41], v90 offset:2048
    ds_read_b64_tr_b16 v[42:43], v90 offset:2560
    ds_read_b64_tr_b16 v[44:45], v90 offset:10240
    ds_read_b64_tr_b16 v[46:47], v90 offset:10752
    ds_read_b128 a[40:43], v82
    ds_read_b128 a[44:47], v83
    v_dot2_f32_bf16 v86, v104, s45, v86
    v_dot2_f32_bf16 v87, v104, v104, v87
    v_dot2_f32_bf16 v86, v105, s45, v86
    v_dot2_f32_bf16 v87, v105, v105, v87
    v_dot2_f32_bf16 v86, v106, s45, v86
    v_dot2_f32_bf16 v87, v106, v106, v87
    v_dot2_f32_bf16 v86, v107, s45, v86
    v_dot2_f32_bf16 v87, v107, v107, v87
    v_dot2_f32_bf16 v88, v108, s45, v88
    v_dot2_f32_bf16 v89, v108, v108, v89
    v_dot2_f32_bf16 v88, v109, s45, v88
    v_dot2_f32_bf16 v89, v109, v109, v89
    s_lshl_b32 s37, s20, 11
    s_add_u32 m0, s37, 0
    s_add_u32 s38, s47, 640
    buffer_load_dwordx4 v30, s[4:7], s38 offen lds
    v_dot2_f32_bf16 v88, v110, s45, v88
    v_dot2_f32_bf16 v89, v110, v110, v89
    v_dot2_f32_bf16 v88, v111, s45, v88
    v_dot2_f32_bf16 v89, v111, v111, v89
    v_dot2_f32_bf16 v11, v96, s45, v11
    v_dot2_f32_bf16 v12, v100, s45, v12
    v_dot2_f32_bf16 v11, v97, s45, v11
    v_dot2_f32_bf16 v12, v101, s45, v12
    v_dot2_f32_bf16 v11, v98, s45, v11
    v_dot2_f32_bf16 v12, v102, s45, v12
    v_dot2_f32_bf16 v11, v99, s45, v11
    v_dot2_f32_bf16 v12, v103, s45, v12
    ds_read_b128 v[104:107], v84
    ds_read_b128 v[108:111], v85
    ds_read_b64_tr_b16 v[96:97], v91 offset:0
    ds_read_b64_tr_b16 v[98:99], v91 offset:512
    ds_read_b64_tr_b16 v[100:101], v91 offset:8192
    ds_read_b64_tr_b16 v[102:103], v91 offset:8704
    s_waitcnt lgkmcnt(13)
    v_mfma_f32_32x32x16_bf16 v[64:79], v[32:35], a[32:35], v[64:79]
    buffer_load_dwordx4 v31, s[4:7], s38 offen offset:1024 lds
    v_mfma_f32_32x32x16_bf16 v[48:63], v[36:39], a[32:35], v[48:63]
    s_lshl_b32 s37, s20, 10
    s_add_u32 m0, s37, 16384
    s_mul_i32 s38, s25, 320
    s_add_u32 s38, s38, s48
    buffer_load_dwordx4 v4, s[8:11], s38 offen lds
    ds_read_b64_tr_b16 v[32:33], v90 offset:4096
    ds_read_b64_tr_b16 v[34:35], v90 offset:4608
    ds_read_b64_tr_b16 v[36:37], v90 offset:12288
    ds_read_b64_tr_b16 v[38:39], v90 offset:12800
    s_waitcnt lgkmcnt(12)
    v_mfma_f32_32x32x16_bf16 v[64:79], v[40:43], a[36:39], v[64:79]
    s_add_u32 m0, s37, 24576
    s_add_u32 s38, s38, 128
    buffer_load_dwordx4 v4, s[8:11], s38 offen lds
    v_mfma_f32_32x32x16_bf16 v[48:63], v[44:47], a[36:39], v[48:63]
    ds_read_b64_tr_b16 v[40:41], v90 offset:6144
    ds_read_b64_tr_b16 v[42:43], v90 offset:6656
    ds_read_b64_tr_b16 v[44:45], v90 offset:14336
    ds_read_b64_tr_b16 v[46:47], v90 offset:14848
    s_waitcnt lgkmcnt(4)
    v_mfma_f32_32x32x16_bf16 v[64:79], v[32:35], a[40:43], v[64:79]
    v_mfma_f32_32x32x16_bf16 v[48:63], v[36:39], a[40:43], v[48:63]
    v_add_u32 v80, 0xa000, v80
    v_add_u32 v81, 0xa000, v81
    v_add_u32 v82, 0xa000, v82
    v_add_u32 v83, 0xa000, v83
    v_add_u32 v84, 0xa000, v84
    v_add_u32 v85, 0xa000, v85
    v_add_u32 v91, 0xa000, v91
    v_add_u32 v90, 0xa000, v90
    s_waitcnt lgkmcnt(0)
    v_mfma_f32_32x32x16_bf16 v[64:79], v[40:43], a[44:47], v[64:79]
    v_mfma_f32_32x32x16_bf16 v[48:63], v[44:47], a[44:47], v[48:63]
    s_waitcnt vmcnt(8) lgkmcnt(8)
    s_barrier
    ds_read_b128 a[48:51], v80
    ds_read_b64_tr_b16 v[32:33], v90 offset:0
    ds_read_b64_tr_b16 v[34:35], v90 offset:512
    ds_read_b64_tr_b16 v[36:37], v90 offset:8192
    ds_read_b64_tr_b16 v[38:39], v90 offset:8704
    ds_read_b128 a[52:55], v81
    ds_read_b64_tr_b16 v[40:41], v90 offset:2048
    ds_read_b64_tr_b16 v[42:43], v90 offset:2560
    ds_read_b64_tr_b16 v[44:45], v90 offset:10240
    ds_read_b64_tr_b16 v[46:47], v90 offset:10752
    ds_read_b128 a[56:59], v82
    ds_read_b128 a[60:63], v83
    v_dot2_f32_bf16 v86, v104, s45, v86
    v_dot2_f32_bf16 v87, v104, v104, v87
    v_dot2_f32_bf16 v86, v105, s45, v86
    v_dot2_f32_bf16 v87, v105, v105, v87
    v_dot2_f32_bf16 v86, v106, s45, v86
    v_dot2_f32_bf16 v87, v106, v106, v87
    v_dot2_f32_bf16 v86, v107, s45, v86
    v_dot2_f32_bf16 v87, v107, v107, v87
    v_dot2_f32_bf16 v88, v108, s45, v88
    v_dot2_f32_bf16 v89, v108, v108, v89
    v_dot2_f32_bf16 v88, v109, s45, v88
    v_dot2_f32_bf16 v89, v109, v109, v89
    s_lshl_b32 s37, s20, 11
    s_add_u32 m0, s37, 32768
    s_add_u32 s38, s47, 768
    buffer_load_dwordx4 v30, s[4:7], s38 offen lds
    v_dot2_f32_bf16 v88, v110, s45, v88
    v_dot2_f32_bf16 v89, v110, v110, v89
    v_dot2_f32_bf16 v88, v111, s45, v88
    v_dot2_f32_bf16 v89, v111, v111, v89
    v_dot2_f32_bf16 v11, v96, s45, v11
    v_dot2_f32_bf16 v12, v100, s45, v12
    v_dot2_f32_bf16 v11, v97, s45, v11
    v_dot2_f32_bf16 v12, v101, s45, v12
    v_dot2_f32_bf16 v11, v98, s45, v11
    v_dot2_f32_bf16 v12, v102, s45, v12
    v_dot2_f32_bf16 v11, v99, s45, v11
    v_dot2_f32_bf16 v12, v103, s45, v12
    ds_read_b128 v[104:107], v84
    ds_read_b128 v[108:111], v85
    ds_read_b64_tr_b16 v[96:97], v91 offset:0
    ds_read_b64_tr_b16 v[98:99], v91 offset:512
    ds_read_b64_tr_b16 v[100:101], v91 offset:8192
    ds_read_b64_tr_b16 v[102:103], v91 offset:8704
    s_waitcnt lgkmcnt(13)
    v_mfma_f32_32x32x16_bf16 v[64:79], v[32:35], a[48:51], v[64:79]
    buffer_load_dwordx4 v31, s[4:7], s38 offen offset:1024 lds
    v_mfma_f32_32x32x16_bf16 v[48:63], v[36:39], a[48:51], v[48:63]
    s_lshl_b32 s37, s20, 10
    s_add_u32 m0, s37, 49152
    s_mul_i32 s38, s25, 384
    s_add_u32 s38, s38, s48
    buffer_load_dwordx4 v4, s[8:11], s38 offen lds
    ds_read_b64_tr_b16 v[32:33], v90 offset:4096
    ds_read_b64_tr_b16 v[34:35], v90 offset:4608
    ds_read_b64_tr_b16 v[36:37], v90 offset:12288
    ds_read_b64_tr_b16 v[38:39], v90 offset:12800
    s_waitcnt lgkmcnt(12)
    v_mfma_f32_32x32x16_bf16 v[64:79], v[40:43], a[52:55], v[64:79]
    s_add_u32 m0, s37, 57344
    s_add_u32 s38, s38, 128
    buffer_load_dwordx4 v4, s[8:11], s38 offen lds
    v_mfma_f32_32x32x16_bf16 v[48:63], v[44:47], a[52:55], v[48:63]
    ds_read_b64_tr_b16 v[40:41], v90 offset:6144
    ds_read_b64_tr_b16 v[42:43], v90 offset:6656
    ds_read_b64_tr_b16 v[44:45], v90 offset:14336
    ds_read_b64_tr_b16 v[46:47], v90 offset:14848
    s_waitcnt lgkmcnt(4)
    v_mfma_f32_32x32x16_bf16 v[64:79], v[32:35], a[56:59], v[64:79]
    v_mfma_f32_32x32x16_bf16 v[48:63], v[36:39], a[56:59], v[48:63]
    v_add_u32 v80, 0x8000, v80
    v_add_u32 v81, 0x8000, v81
    v_add_u32 v82, 0x8000, v82
    v_add_u32 v83, 0x8000, v83
    v_add_u32 v84, 0x8000, v84
    v_add_u32 v85, 0x8000, v85
    v_add_u32 v91, 0x8000, v91
    v_add_u32 v90, 0x8000, v90
    s_waitcnt lgkmcnt(0)
    v_mfma_f32_32x32x16_bf16 v[64:79], v[40:43], a[60:63], v[64:79]
    v_mfma_f32_32x32x16_bf16 v[48:63], v[44:47], a[60:63], v[48:63]
    s_cmp_lt_i32 s55, 0
    s_cbranch_scc1 L_k1_a1
    s_waitcnt vmcnt(12)
    v_accvgpr_read_b32 v26, a108
    v_lshlrev_b32 v16, 16, v26
    v_and_b32 v17, 0xffff0000, v26
    v_accvgpr_read_b32 v26, a109
    v_lshlrev_b32 v18, 16, v26
    v_and_b32 v19, 0xffff0000, v26
    v_accvgpr_read_b32 v26, a110
    v_lshlrev_b32 v20, 16, v26
    v_and_b32 v21, 0xffff0000, v26
    v_accvgpr_read_b32 v26, a111
    v_lshlrev_b32 v22, 16, v26
    v_and_b32 v23, 0xffff0000, v26
    v_accvgpr_read_b32 v26, a112
    v_lshlrev_b32 v24, 16, v26
    v_and_b32 v25, 0xffff0000, v26
    v_add_f32 v16, v16, v24
    v_add_f32 v17, v17, v25
    v_accvgpr_read_b32 v26, a113
    v_lshlrev_b32 v24, 16, v26
    v_and_b32 v25, 0xffff0000, v26
    v_add_f32 v18, v18, v24
    v_add_f32 v19, v19, v25
    v_accvgpr_read_b32 v26, a114
    v_lshlrev_b32 v24, 16, v26
    v_and_b32 v25, 0xffff0000, v26
    v_add_f32 v20, v20, v24
    v_add_f32 v21, v21, v25
    v_accvgpr_read_b32 v26, a115
    v_lshlrev_b32 v24, 16, v26
    v_and_b32 v25, 0xffff0000, v26
    v_add_f32 v22, v22, v24
    v_add_f32 v23, v23, v25
    v_accvgpr_read_b32 v26, a116
    v_lshlrev_b32 v24, 16, v26
    v_and_b32 v25, 0xffff0000, v26
    v_add_f32 v16, v16, v24
    v_add_f32 v17, v17, v25
    v_accvgpr_read_b32 v26, a117
    v_lshlrev_b32 v24, 16, v26
    v_and_b32 v25, 0xffff0000, v26
    v_add_f32 v18, v18, v24
    v_add_f32 v19, v19, v25
    v_accvgpr_read_b32 v26, a118
    v_lshlrev_b32 v24, 16, v26
    v_and_b32 v25, 0xffff0000, v26
    v_add_f32 v20, v20, v24
    v_add_f32 v21, v21, v25
    v_accvgpr_read_b32 v26, a119
    v_lshlrev_b32 v24, 16, v26
    v_and_b32 v25, 0xffff0000, v26
    v_add_f32 v22, v22, v24
    v_add_f32 v23, v23, v25
    v_accvgpr_read_b32 v26, a120
    v_lshlrev_b32 v24, 16, v26
    v_and_b32 v25, 0xffff0000, v26
    v_add_f32 v16, v16, v24
    v_add_f32 v17, v17, v25
    v_accvgpr_read_b32 v26, a121
    v_lshlrev_b32 v24, 16, v26
    v_and_b32 v25, 0xffff0000, v26
    v_add_f32 v18, v18, v24
    v_add_f32 v19, v19, v25
    v_accvgpr_read_b32 v26, a122
    v_lshlrev_b32 v24, 16, v26
    v_and_b32 v25, 0xffff0000, v26
    v_add_f32 v20, v20, v24
    v_add_f32 v21, v21, v25
    v_accvgpr_read_b32 v26, a123
    v_lshlrev_b32 v24, 16, v26
    v_and_b32 v25, 0xffff0000, v26
    v_add_f32 v22, v22, v24
    v_add_f32 v23, v23, v25
    v_accvgpr_read_b32 v26, a124
    v_lshlrev_b32 v24, 16, v26
    v_and_b32 v25, 0xffff0000, v26
    v_add_f32 v16, v16, v24
    v_add_f32 v17, v17, v25
    v_accvgpr_read_b32 v26, a125
    v_lshlrev_b32 v24, 16, v26
    v_and_b32 v25, 0xffff0000, v26
    v_add_f32 v18, v18, v24
    v_add_f32 v19, v19, v25
    v_accvgpr_read_b32 v26, a126
    v_lshlrev_b32 v24, 16, v26
    v_and_b32 v25, 0xffff0000, v26
    v_add_f32 v20, v20, v24
    v_add_f32 v21, v21, v25
    v_accvgpr_read_b32 v26, a127
    v_lshlrev_b32 v24, 16, v26
    v_and_b32 v25, 0xffff0000, v26
    v_add_f32 v22, v22, v24
    v_add_f32 v23, v23, v25
    s_nop 1
    v_add_f32_dpp v16, v16, v16 row_ror:4 row_mask:0xf bank_mask:0xf
    v_add_f32_dpp v17, v17, v17 row_ror:4 row_mask:0xf bank_mask:0xf
    v_add_f32_dpp v18, v18, v18 row_ror:4 row_mask:0xf bank_mask:0xf
    v_add_f32_dpp v19, v19, v19 row_ror:4 row_mask:0xf bank_mask:0xf
    v_add_f32_dpp v20, v20, v20 row_ror:4 row_mask:0xf bank_mask:0xf
    v_add_f32_dpp v21, v21, v21 row_ror:4 row_mask:0xf bank_mask:0xf
    v_add_f32_dpp v22, v22, v22 row_ror:4 row_mask:0xf bank_mask:0xf
    v_add_f32_dpp v23, v23, v23 row_ror:4 row_mask:0xf bank_mask:0xf
    v_add_f32_dpp v16, v16, v16 row_ror:8 row_mask:0xf bank_mask:0xf
    v_add_f32_dpp v17, v17, v17 row_ror:8 row_mask:0xf bank_mask:0xf
    v_add_f32_dpp v18, v18, v18 row_ror:8 row_mask:0xf bank_mask:0xf
    v_add_f32_dpp v19, v19, v19 row_ror:8 row_mask:0xf bank_mask:0xf
    v_add_f32_dpp v20, v20, v20 row_ror:8 row_mask:0xf bank_mask:0xf
    v_add_f32_dpp v21, v21, v21 row_ror:8 row_mask:0xf bank_mask:0xf
    v_add_f32_dpp v22, v22, v22 row_ror:8 row_mask:0xf bank_mask:0xf
    v_add_f32_dpp v23, v23, v23 row_ror:8 row_mask:0xf bank_mask:0xf
    ds_write_b128 v95, v[16:19]
    ds_write_b128 v95, v[20:23] offset:16
L_k1_a1:
    s_waitcnt vmcnt(8) lgkmcnt(0)
    s_barrier
    ds_read_b128 a[64:67], v80
    ds_read_b64_tr_b16 v[32:33], v90 offset:0
    ds_read_b64_tr_b16 v[34:35], v90 offset:512
    ds_read_b64_tr_b16 v[36:37], v90 offset:8192
    ds_read_b64_tr_b16 v[38:39], v90 offset:8704
    ds_read_b128 a[68:71], v81
    ds_read_b64_tr_b16 v[40:41], v90 offset:2048
    ds_read_b64_tr_b16 v[42:43], v90 offset:2560
    ds_read_b64_tr_b16 v[44:45], v90 offset:10240
    ds_read_b64_tr_b16 v[46:47], v90 offset:10752
    ds_read_b128 a[72:75], v82
    ds_read_b128 a[76:79], v83
    v_dot2_f32_bf16 v86, v104, s45, v86
    v_dot2_f32_bf16 v87, v104, v104, v87
    v_dot2_f32_bf16 v86, v105, s45, v86
    v_dot2_f32_bf16 v87, v105, v105, v87
    v_dot2_f32_bf16 v86, v106, s45, v86
    v_dot2_f32_bf16 v87, v106, v106, v87
    v_dot2_f32_bf16 v86, v107, s45, v86
    v_dot2_f32_bf16 v87, v107, v107, v87
    v_dot2_f32_bf16 v88, v108, s45, v88
    v_dot2_f32_bf16 v89, v108, v108, v89
    v_dot2_f32_bf16 v88, v109, s45, v88
    v_dot2_f32_bf16 v89, v109, v109, v89
    s_lshl_b32 s37, s20, 11
    s_add_u32 m0, s37, 73728
    s_add_u32 s38, s47, 896
    buffer_load_dwordx4 v30, s[4:7], s38 offen lds
    v_dot2_f32_bf16 v88, v110, s45, v88
    v_dot2_f32_bf16 v89, v110, v110, v89
    v_dot2_f32_bf16 v88, v111, s45, v88
    v_dot2_f32_bf16 v89, v111, v111, v89
    v_dot2_f32_bf16 v11, v96, s45, v11
    v_dot2_f32_bf16 v12, v100, s45, v12
    v_dot2_f32_bf16 v11, v97, s45, v11
    v_dot2_f32_bf16 v12, v101, s45, v12
    v_dot2_f32_bf16 v11, v98, s45, v11
    v_dot2_f32_bf16 v12, v102, s45, v12
    v_dot2_f32_bf16 v11, v99, s45, v11
    v_dot2_f32_bf16 v12, v103, s45, v12
    s_nop 2
    s_cmp_lt_i32 s55, 0
    s_cbranch_scc1 L_k1_a2
    s_cmp_lg_u32 s20, 0
    s_cbranch_scc1 L_k1_a2
    v_and_b32 v15, 31, v0
    v_lshrrev_b32 v24, 5, v0
    v_lshlrev_b32 v15, 2, v15
    v_lshl_add_u32 v15, v24, 11, v15
    v_add_u32 v15, 0x20000, v15
    ds_read_b32 v96, v15 offset:24576
    ds_read_b32 v97, v15 offset:24704
    ds_read_b32 v98, v15 offset:24832
    ds_read_b32 v99, v15 offset:24960
    ds_read_b32 v100, v15 offset:25088
    ds_read_b32 v101, v15 offset:25216
    ds_read_b32 v102, v15 offset:25344
    ds_read_b32 v103, v15 offset:25472
    ds_read_b32 v104, v15 offset:25600
    ds_read_b32 v105, v15 offset:25728
    ds_read_b32 v106, v15 offset:25856
    ds_read_b32 v107, v15 offset:25984
    ds_read_b32 v108, v15 offset:26112
    ds_read_b32 v109, v15 offset:26240
    ds_read_b32 v110, v15 offset:26368
    ds_read_b32 v111, v15 offset:26496
    s_waitcnt lgkmcnt(0)
    v_add_f32 v96, v96, v104
    v_add_f32 v97, v97, v105
    v_add_f32 v98, v98, v106
    v_add_f32 v99, v99, v107
    v_add_f32 v100, v100, v108
    v_add_f32 v101, v101, v109
    v_add_f32 v102, v102, v110
    v_add_f32 v103, v103, v111
    v_add_f32 v96, v96, v100
    v_add_f32 v97, v97, v101
    v_add_f32 v98, v98, v102
    v_add_f32 v99, v99, v103
    v_add_f32 v96, v96, v98
    v_add_f32 v97, v97, v99
    v_add_f32 v96, v96, v97
    v_mov_b32 v97, v96
    s_nop 1
    v_permlane32_swap_b32 v96, v97
    s_nop 1
    v_add_f32 v96, v96, v97
    v_cvt_pk_bf16_f32 v16, v96, v96
    v_lshlrev_b32 v97, 16, v16
    v_sub_f32 v97, v96, v97
    v_cvt_pk_bf16_f32 v98, v97, v97
    v_and_b32 v98, 0xffff, v98
    v_lshl_or_b32 v17, v94, 16, v98
    v_mov_b32 v18, v94
    v_mov_b32 v19, 0
    v_and_b32 v15, 31, v0
    v_lshlrev_b32 v15, 4, v15
    s_lshl_b32 s39, s55, 9
    s_add_u32 s39, s39, 47448064
    buffer_store_dwordx4 v[16:19], v15, s[16:19], s39 offen sc1
L_k1_a2:
    ds_read_b128 v[104:107], v84
    ds_read_b128 v[108:111], v85
    ds_read_b64_tr_b16 v[96:97], v91 offset:0
    ds_read_b64_tr_b16 v[98:99], v91 offset:512
    ds_read_b64_tr_b16 v[100:101], v91 offset:8192
    ds_read_b64_tr_b16 v[102:103], v91 offset:8704
    s_waitcnt lgkmcnt(13)
    v_mfma_f32_32x32x16_bf16 v[64:79], v[32:35], a[64:67], v[64:79]
    buffer_load_dwordx4 v31, s[4:7], s38 offen offset:1024 lds
    v_mfma_f32_32x32x16_bf16 v[48:63], v[36:39], a[64:67], v[48:63]
    s_lshl_b32 s37, s20, 10
    s_add_u32 m0, s37, 90112
    s_mul_i32 s38, s25, 448
    s_add_u32 s38, s38, s48
    buffer_load_dwordx4 v4, s[8:11], s38 offen lds
    ds_read_b64_tr_b16 v[32:33], v90 offset:4096
    ds_read_b64_tr_b16 v[34:35], v90 offset:4608
    ds_read_b64_tr_b16 v[36:37], v90 offset:12288
    ds_read_b64_tr_b16 v[38:39], v90 offset:12800
    s_waitcnt lgkmcnt(12)
    v_mfma_f32_32x32x16_bf16 v[64:79], v[40:43], a[68:71], v[64:79]
    s_add_u32 m0, s37, 98304
    s_add_u32 s38, s38, 128
    buffer_load_dwordx4 v4, s[8:11], s38 offen lds
    v_mfma_f32_32x32x16_bf16 v[48:63], v[44:47], a[68:71], v[48:63]
    ds_read_b64_tr_b16 v[40:41], v90 offset:6144
    ds_read_b64_tr_b16 v[42:43], v90 offset:6656
    ds_read_b64_tr_b16 v[44:45], v90 offset:14336
    ds_read_b64_tr_b16 v[46:47], v90 offset:14848
    s_waitcnt lgkmcnt(4)
    v_mfma_f32_32x32x16_bf16 v[64:79], v[32:35], a[72:75], v[64:79]
    v_mfma_f32_32x32x16_bf16 v[48:63], v[36:39], a[72:75], v[48:63]
    v_add_u32 v80, 0xfffe6000, v80
    v_add_u32 v81, 0xfffe6000, v81
    v_add_u32 v82, 0xfffe6000, v82
    v_add_u32 v83, 0xfffe6000, v83
    v_add_u32 v84, 0xfffe6000, v84
    v_add_u32 v85, 0xfffe6000, v85
    v_add_u32 v91, 0xfffe6000, v91
    v_add_u32 v90, 0xfffe6000, v90
    s_waitcnt lgkmcnt(0)
    v_mfma_f32_32x32x16_bf16 v[64:79], v[40:43], a[76:79], v[64:79]
    v_mfma_f32_32x32x16_bf16 v[48:63], v[44:47], a[76:79], v[48:63]
    s_waitcnt vmcnt(8) lgkmcnt(8)
    s_barrier
    ds_read_b128 a[80:83], v80
    ds_read_b64_tr_b16 v[32:33], v90 offset:0
    ds_read_b64_tr_b16 v[34:35], v90 offset:512
    ds_read_b64_tr_b16 v[36:37], v90 offset:8192
    ds_read_b64_tr_b16 v[38:39], v90 offset:8704
    ds_read_b128 a[84:87], v81
    ds_read_b64_tr_b16 v[40:41], v90 offset:2048
    ds_read_b64_tr_b16 v[42:43], v90 offset:2560
    ds_read_b64_tr_b16 v[44:45], v90 offset:10240
    ds_read_b64_tr_b16 v[46:47], v90 offset:10752
    ds_read_b128 a[88:91], v82
    ds_read_b128 a[92:95], v83
    v_dot2_f32_bf16 v86, v104, s45, v86
    v_dot2_f32_bf16 v87, v104, v104, v87
    v_dot2_f32_bf16 v86, v105, s45, v86
    v_dot2_f32_bf16 v87, v105, v105, v87
    v_dot2_f32_bf16 v86, v106, s45, v86
    v_dot2_f32_bf16 v87, v106, v106, v87
    v_dot2_f32_bf16 v86, v107, s45, v86
    v_dot2_f32_bf16 v87, v107, v107, v87
    v_dot2_f32_bf16 v88, v108, s45, v88
    v_dot2_f32_bf16 v89, v108, v108, v89
    v_dot2_f32_bf16 v88, v109, s45, v88
    v_dot2_f32_bf16 v89, v109, v109, v89
    s_lshl_b32 s37, s20, 11
    s_add_u32 m0, s37, 106496
    s_add_u32 s38, s47, 1024
    buffer_load_dwordx4 v30, s[4:7], s38 offen lds
    v_dot2_f32_bf16 v88, v110, s45, v88
    v_dot2_f32_bf16 v89, v110, v110, v89
    v_dot2_f32_bf16 v88, v111, s45, v88
    v_dot2_f32_bf16 v89, v111, v111, v89
    v_dot2_f32_bf16 v11, v96, s45, v11
    v_dot2_f32_bf16 v12, v100, s45, v12
    v_dot2_f32_bf16 v11, v97, s45, v11
    v_dot2_f32_bf16 v12, v101, s45, v12
    v_dot2_f32_bf16 v11, v98, s45, v11
    v_dot2_f32_bf16 v12, v102, s45, v12
    v_dot2_f32_bf16 v11, v99, s45, v11
    v_dot2_f32_bf16 v12, v103, s45, v12
    ds_read_b128 v[104:107], v84
    ds_read_b128 v[108:111], v85
    ds_read_b64_tr_b16 v[96:97], v91 offset:0
    ds_read_b64_tr_b16 v[98:99], v91 offset:512
    ds_read_b64_tr_b16 v[100:101], v91 offset:8192
    ds_read_b64_tr_b16 v[102:103], v91 offset:8704
    s_cmp_lg_u32 s20, 0
    s_cbranch_scc1 L_k1_a3
    s_waitcnt vmcnt(4)
    v_mov_b32 v15, 0
    v_mov_b32 v24, 1
    s_mov_b64 exec, 1
    global_atomic_add v25, v15, v24, s[64:65] sc0 sc1
    s_mov_b64 exec, -1
L_k1_a3:
    s_waitcnt lgkmcnt(13)
    v_mfma_f32_32x32x16_bf16 v[64:79], v[32:35], a[80:83], v[64:79]
    buffer_load_dwordx4 v31, s[4:7], s38 offen offset:1024 lds
    v_mfma_f32_32x32x16_bf16 v[48:63], v[36:39], a[80:83], v[48:63]
    s_lshl_b32 s37, s20, 10
    s_add_u32 m0, s37, 122880
    s_mul_i32 s38, s25, 512
    s_add_u32 s38, s38, s48
    buffer_load_dwordx4 v4, s[8:11], s38 offen lds
    ds_read_b64_tr_b16 v[32:33], v90 offset:4096
    ds_read_b64_tr_b16 v[34:35], v90 offset:4608
    ds_read_b64_tr_b16 v[36:37], v90 offset:12288
    ds_read_b64_tr_b16 v[38:39], v90 offset:12800
    s_waitcnt lgkmcnt(12)
    v_mfma_f32_32x32x16_bf16 v[64:79], v[40:43], a[84:87], v[64:79]
    s_add_u32 m0, s37, 131072
    s_add_u32 s38, s38, 128
    buffer_load_dwordx4 v4, s[8:11], s38 offen lds
    v_mfma_f32_32x32x16_bf16 v[48:63], v[44:47], a[84:87], v[48:63]
    ds_read_b64_tr_b16 v[40:41], v90 offset:6144
    ds_read_b64_tr_b16 v[42:43], v90 offset:6656
    ds_read_b64_tr_b16 v[44:45], v90 offset:14336
    ds_read_b64_tr_b16 v[46:47], v90 offset:14848
    s_waitcnt lgkmcnt(4)
    v_mfma_f32_32x32x16_bf16 v[64:79], v[32:35], a[88:91], v[64:79]
    v_mfma_f32_32x32x16_bf16 v[48:63], v[36:39], a[88:91], v[48:63]
    v_add_u32 v80, 0x8000, v80
    v_add_u32 v81, 0x8000, v81
    v_add_u32 v82, 0x8000, v82
    v_add_u32 v83, 0x8000, v83
    v_add_u32 v84, 0x8000, v84
    v_add_u32 v85, 0x8000, v85
    v_add_u32 v91, 0x8000, v91
    v_add_u32 v90, 0x8000, v90
    s_waitcnt lgkmcnt(0)
    v_mfma_f32_32x32x16_bf16 v[64:79], v[40:43], a[92:95], v[64:79]
    v_mfma_f32_32x32x16_bf16 v[48:63], v[44:47], a[92:95], v[48:63]
    s_waitcnt vmcnt(8) lgkmcnt(8)
    s_barrier
    ds_read_b128 a[96:99], v80
    ds_read_b64_tr_b16 v[32:33], v90 offset:0
    ds_read_b64_tr_b16 v[34:35], v90 offset:512
    ds_read_b64_tr_b16 v[36:37], v90 offset:8192
    ds_read_b64_tr_b16 v[38:39], v90 offset:8704
    ds_read_b128 a[100:103], v81
    ds_read_b64_tr_b16 v[40:41], v90 offset:2048
    ds_read_b64_tr_b16 v[42:43], v90 offset:2560
    ds_read_b64_tr_b16 v[44:45], v90 offset:10240
    ds_read_b64_tr_b16 v[46:47], v90 offset:10752
    ds_read_b128 a[104:107], v82
    ds_read_b128 a[108:111], v83
    v_dot2_f32_bf16 v86, v104, s45, v86
    v_dot2_f32_bf16 v87, v104, v104, v87
    v_dot2_f32_bf16 v86, v105, s45, v86
    v_dot2_f32_bf16 v87, v105, v105, v87
    v_dot2_f32_bf16 v86, v106, s45, v86
    v_dot2_f32_bf16 v87, v106, v106, v87
    v_dot2_f32_bf16 v86, v107, s45, v86
    v_dot2_f32_bf16 v87, v107, v107, v87
    v_dot2_f32_bf16 v88, v108, s45, v88
    v_dot2_f32_bf16 v89, v108, v108, v89
    v_dot2_f32_bf16 v88, v109, s45, v88
    v_dot2_f32_bf16 v89, v109, v109, v89
    v_dot2_f32_bf16 v88, v110, s45, v88
    v_dot2_f32_bf16 v89, v110, v110, v89
    v_dot2_f32_bf16 v88, v111, s45, v88
    v_dot2_f32_bf16 v89, v111, v111, v89
    v_dot2_f32_bf16 v11, v96, s45, v11
    v_dot2_f32_bf16 v12, v100, s45, v12
    v_dot2_f32_bf16 v11, v97, s45, v11
    v_dot2_f32_bf16 v12, v101, s45, v12
    v_dot2_f32_bf16 v11, v98, s45, v11
    v_dot2_f32_bf16 v12, v102, s45, v12
    v_dot2_f32_bf16 v11, v99, s45, v11
    v_dot2_f32_bf16 v12, v103, s45, v12
    ds_read_b128 v[104:107], v84
    ds_read_b128 v[108:111], v85
    ds_read_b64_tr_b16 v[96:97], v91 offset:0
    ds_read_b64_tr_b16 v[98:99], v91 offset:512
    ds_read_b64_tr_b16 v[100:101], v91 offset:8192
    ds_read_b64_tr_b16 v[102:103], v91 offset:8704
    s_cmp_lg_u32 s20, 0
    s_cbranch_scc1 L_k1_a4
    s_waitcnt vmcnt(3)
    v_readfirstlane_b32 s39, v25
    s_nop 3
    s_cmp_lg_u32 s39, 255
    s_cbranch_scc1 L_k1_a4
    v_mov_b32 v15, 0
    v_mov_b32 v24, 1
    s_mov_b64 exec, 1
    global_store_dword v15, v24, s[64:65] offset:128 sc1
    s_mov_b64 exec, -1
L_k1_a4:
    s_waitcnt lgkmcnt(13)
    v_mfma_f32_32x32x16_bf16 v[64:79], v[32:35], a[96:99], v[64:79]
    v_mfma_f32_32x32x16_bf16 v[48:63], v[36:39], a[96:99], v[48:63]
    ds_read_b64_tr_b16 v[32:33], v90 offset:4096
    ds_read_b64_tr_b16 v[34:35], v90 offset:4608
    ds_read_b64_tr_b16 v[36:37], v90 offset:12288
    ds_read_b64_tr_b16 v[38:39], v90 offset:12800
    s_waitcnt lgkmcnt(12)
    v_mfma_f32_32x32x16_bf16 v[64:79], v[40:43], a[100:103], v[64:79]
    v_mfma_f32_32x32x16_bf16 v[48:63], v[44:47], a[100:103], v[48:63]
    ds_read_b64_tr_b16 v[40:41], v90 offset:6144
    ds_read_b64_tr_b16 v[42:43], v90 offset:6656
    ds_read_b64_tr_b16 v[44:45], v90 offset:14336
    ds_read_b64_tr_b16 v[46:47], v90 offset:14848
    s_waitcnt lgkmcnt(4)
    v_mfma_f32_32x32x16_bf16 v[64:79], v[32:35], a[104:107], v[64:79]
    v_mfma_f32_32x32x16_bf16 v[48:63], v[36:39], a[104:107], v[48:63]
    v_add_u32 v80, 0xa000, v80
    v_add_u32 v81, 0xa000, v81
    v_add_u32 v82, 0xa000, v82
    v_add_u32 v83, 0xa000, v83
    v_add_u32 v84, 0xa000, v84
    v_add_u32 v85, 0xa000, v85
    v_add_u32 v91, 0xa000, v91
    v_add_u32 v90, 0xa000, v90
    s_waitcnt lgkmcnt(0)
    v_mfma_f32_32x32x16_bf16 v[64:79], v[40:43], a[108:111], v[64:79]
    v_mfma_f32_32x32x16_bf16 v[48:63], v[44:47], a[108:111], v[48:63]
    s_waitcnt vmcnt(4) lgkmcnt(8)
    s_barrier
    ds_read_b128 a[112:115], v80
    ds_read_b64_tr_b16 v[32:33], v90 offset:0
    ds_read_b64_tr_b16 v[34:35], v90 offset:512
    ds_read_b64_tr_b16 v[36:37], v90 offset:8192
    ds_read_b64_tr_b16 v[38:39], v90 offset:8704
    ds_read_b128 a[116:119], v81
    ds_read_b64_tr_b16 v[40:41], v90 offset:2048
    ds_read_b64_tr_b16 v[42:43], v90 offset:2560
    ds_read_b64_tr_b16 v[44:45], v90 offset:10240
    ds_read_b64_tr_b16 v[46:47], v90 offset:10752
    ds_read_b128 a[120:123], v82
    ds_read_b128 a[124:127], v83
    v_dot2_f32_bf16 v86, v104, s45, v86
    v_dot2_f32_bf16 v87, v104, v104, v87
    v_dot2_f32_bf16 v86, v105, s45, v86
    v_dot2_f32_bf16 v87, v105, v105, v87
    v_dot2_f32_bf16 v86, v106, s45, v86
    v_dot2_f32_bf16 v87, v106, v106, v87
    v_dot2_f32_bf16 v86, v107, s45, v86
    v_dot2_f32_bf16 v87, v107, v107, v87
    v_dot2_f32_bf16 v88, v108, s45, v88
    v_dot2_f32_bf16 v89, v108, v108, v89
    v_dot2_f32_bf16 v88, v109, s45, v88
    v_dot2_f32_bf16 v89, v109, v109, v89
    s_add_u32 m0, s31, 0
    s_add_u32 s37, s27, s28
    buffer_load_dwordx4 v4, s[8:11], s37 offen offset:0 lds
    v_dot2_f32_bf16 v88, v110, s45, v88
    v_dot2_f32_bf16 v89, v110, v110, v89
    v_dot2_f32_bf16 v88, v111, s45, v88
    v_dot2_f32_bf16 v89, v111, v111, v89
    v_dot2_f32_bf16 v11, v96, s45, v11
    v_dot2_f32_bf16 v12, v100, s45, v12
    v_dot2_f32_bf16 v11, v97, s45, v11
    v_dot2_f32_bf16 v12, v101, s45, v12
    v_dot2_f32_bf16 v11, v98, s45, v11
    v_dot2_f32_bf16 v12, v102, s45, v12
    v_dot2_f32_bf16 v11, v99, s45, v11
    v_dot2_f32_bf16 v12, v103, s45, v12
    ds_read_b128 v[104:107], v84
    ds_read_b128 v[108:111], v85
    ds_read_b64_tr_b16 v[96:97], v91 offset:0
    ds_read_b64_tr_b16 v[98:99], v91 offset:512
    ds_read_b64_tr_b16 v[100:101], v91 offset:8192
    ds_read_b64_tr_b16 v[102:103], v91 offset:8704
    s_waitcnt lgkmcnt(13)
    v_mfma_f32_32x32x16_bf16 v[64:79], v[32:35], a[112:115], v[64:79]
    buffer_load_dwordx4 v5, s[8:11], s37 offen offset:1024 lds
    v_mfma_f32_32x32x16_bf16 v[48:63], v[36:39], a[112:115], v[48:63]
    buffer_load_dwordx4 v6, s[8:11], s37 offen offset:2048 lds
    ds_read_b64_tr_b16 v[32:33], v90 offset:4096
    ds_read_b64_tr_b16 v[34:35], v90 offset:4608
    ds_read_b64_tr_b16 v[36:37], v90 offset:12288
    ds_read_b64_tr_b16 v[38:39], v90 offset:12800
    s_waitcnt lgkmcnt(12)
    v_mfma_f32_32x32x16_bf16 v[64:79], v[40:43], a[116:119], v[64:79]
    s_add_u32 m0, s31, 24576
    s_add_u32 s37, s27, s28
    s_add_u32 s37, s37, s26
    buffer_load_dwordx4 v4, s[8:11], s37 offen offset:0 lds
    v_mfma_f32_32x32x16_bf16 v[48:63], v[44:47], a[116:119], v[48:63]
    buffer_load_dwordx4 v5, s[8:11], s37 offen offset:1024 lds
    ds_read_b64_tr_b16 v[40:41], v90 offset:6144
    ds_read_b64_tr_b16 v[42:43], v90 offset:6656
    ds_read_b64_tr_b16 v[44:45], v90 offset:14336
    ds_read_b64_tr_b16 v[46:47], v90 offset:14848
    s_waitcnt lgkmcnt(4)
    v_mfma_f32_32x32x16_bf16 v[64:79], v[32:35], a[120:123], v[64:79]
    buffer_load_dwordx4 v6, s[8:11], s37 offen offset:2048 lds
    v_mfma_f32_32x32x16_bf16 v[48:63], v[36:39], a[120:123], v[48:63]
    v_add_u32 v80, 0x8000, v80
    v_add_u32 v81, 0x8000, v81
    v_add_u32 v82, 0x8000, v82
    v_add_u32 v83, 0x8000, v83
    v_add_u32 v84, 0x8000, v84
    v_add_u32 v85, 0x8000, v85
    v_add_u32 v91, 0x8000, v91
    v_add_u32 v90, 0x8000, v90
    s_waitcnt lgkmcnt(0)
    v_mfma_f32_32x32x16_bf16 v[64:79], v[40:43], a[124:127], v[64:79]
    v_mfma_f32_32x32x16_bf16 v[48:63], v[44:47], a[124:127], v[48:63]
    s_waitcnt vmcnt(6) lgkmcnt(8)
    s_barrier
    ds_read_b128 v[112:115], v80
    ds_read_b64_tr_b16 v[32:33], v90 offset:0
    ds_read_b64_tr_b16 v[34:35], v90 offset:512
    ds_read_b64_tr_b16 v[36:37], v90 offset:8192
    ds_read_b64_tr_b16 v[38:39], v90 offset:8704
    ds_read_b128 v[116:119], v81
    ds_read_b64_tr_b16 v[40:41], v90 offset:2048
    ds_read_b64_tr_b16 v[42:43], v90 offset:2560
    ds_read_b64_tr_b16 v[44:45], v90 offset:10240
    ds_read_b64_tr_b16 v[46:47], v90 offset:10752
    ds_read_b128 v[120:123], v82
    ds_read_b128 v[124:127], v83
    v_dot2_f32_bf16 v86, v104, s45, v86
    v_dot2_f32_bf16 v87, v104, v104, v87
    v_dot2_f32_bf16 v86, v105, s45, v86
    v_dot2_f32_bf16 v87, v105, v105, v87
    v_dot2_f32_bf16 v86, v106, s45, v86
    v_dot2_f32_bf16 v87, v106, v106, v87
    v_dot2_f32_bf16 v86, v107, s45, v86
    v_dot2_f32_bf16 v87, v107, v107, v87
    v_dot2_f32_bf16 v88, v108, s45, v88
    v_dot2_f32_bf16 v89, v108, v108, v89
    v_dot2_f32_bf16 v88, v109, s45, v88
    v_dot2_f32_bf16 v89, v109, v109, v89
    s_add_u32 m0, s31, 49152
    s_add_u32 s37, s27, s28
    s_add_u32 s37, s37, s26
    s_add_u32 s37, s37, s26
    buffer_load_dwordx4 v4, s[8:11], s37 offen offset:0 lds
    v_dot2_f32_bf16 v88, v110, s45, v88
    v_dot2_f32_bf16 v89, v110, v110, v89
    v_dot2_f32_bf16 v88, v111, s45, v88
    v_dot2_f32_bf16 v89, v111, v111, v89
    v_dot2_f32_bf16 v11, v96, s45, v11
    v_dot2_f32_bf16 v12, v100, s45, v12
    v_dot2_f32_bf16 v11, v97, s45, v11
    v_dot2_f32_bf16 v12, v101, s45, v12
    v_dot2_f32_bf16 v11, v98, s45, v11
    v_dot2_f32_bf16 v12, v102, s45, v12
    v_dot2_f32_bf16 v11, v99, s45, v11
    v_dot2_f32_bf16 v12, v103, s45, v12
    ds_read_b128 v[104:107], v84
    ds_read_b128 v[108:111], v85
    ds_read_b64_tr_b16 v[96:97], v91 offset:0
    ds_read_b64_tr_b16 v[98:99], v91 offset:512
    ds_read_b64_tr_b16 v[100:101], v91 offset:8192
    ds_read_b64_tr_b16 v[102:103], v91 offset:8704
    s_waitcnt lgkmcnt(13)
    v_mfma_f32_32x32x16_bf16 v[64:79], v[32:35], v[112:115], v[64:79]
    buffer_load_dwordx4 v5, s[8:11], s37 offen offset:1024 lds
    v_mfma_f32_32x32x16_bf16 v[48:63], v[36:39], v[112:115], v[48:63]
    buffer_load_dwordx4 v6, s[8:11], s37 offen offset:2048 lds
    ds_read_b64_tr_b16 v[32:33], v90 offset:4096
    ds_read_b64_tr_b16 v[34:35], v90 offset:4608
    ds_read_b64_tr_b16 v[36:37], v90 offset:12288
    ds_read_b64_tr_b16 v[38:39], v90 offset:12800
    s_waitcnt lgkmcnt(12)
    v_mfma_f32_32x32x16_bf16 v[64:79], v[40:43], v[116:119], v[64:79]
    v_mfma_f32_32x32x16_bf16 v[48:63], v[44:47], v[116:119], v[48:63]
    ds_read_b64_tr_b16 v[40:41], v90 offset:6144
    ds_read_b64_tr_b16 v[42:43], v90 offset:6656
    ds_read_b64_tr_b16 v[44:45], v90 offset:14336
    ds_read_b64_tr_b16 v[46:47], v90 offset:14848
    s_waitcnt lgkmcnt(4)
    v_mfma_f32_32x32x16_bf16 v[64:79], v[32:35], v[120:123], v[64:79]
    v_mfma_f32_32x32x16_bf16 v[48:63], v[36:39], v[120:123], v[48:63]
    s_waitcnt lgkmcnt(0)
    v_mfma_f32_32x32x16_bf16 v[64:79], v[40:43], v[124:127], v[64:79]
    v_mfma_f32_32x32x16_bf16 v[48:63], v[44:47], v[124:127], v[48:63]
    s_waitcnt lgkmcnt(8)
    v_dot2_f32_bf16 v86, v104, s45, v86
    v_dot2_f32_bf16 v87, v104, v104, v87
    v_dot2_f32_bf16 v86, v105, s45, v86
    v_dot2_f32_bf16 v87, v105, v105, v87
    v_dot2_f32_bf16 v86, v106, s45, v86
    v_dot2_f32_bf16 v87, v106, v106, v87
    v_dot2_f32_bf16 v86, v107, s45, v86
    v_dot2_f32_bf16 v87, v107, v107, v87
    v_dot2_f32_bf16 v88, v108, s45, v88
    v_dot2_f32_bf16 v89, v108, v108, v89
    v_dot2_f32_bf16 v88, v109, s45, v88
    v_dot2_f32_bf16 v89, v109, v109, v89
    v_dot2_f32_bf16 v88, v110, s45, v88
    v_dot2_f32_bf16 v89, v110, v110, v89
    v_dot2_f32_bf16 v88, v111, s45, v88
    v_dot2_f32_bf16 v89, v111, v111, v89
    v_dot2_f32_bf16 v11, v96, s45, v11
    v_dot2_f32_bf16 v12, v100, s45, v12
    v_dot2_f32_bf16 v11, v97, s45, v11
    v_dot2_f32_bf16 v12, v101, s45, v12
    v_dot2_f32_bf16 v11, v98, s45, v11
    v_dot2_f32_bf16 v12, v102, s45, v12
    v_dot2_f32_bf16 v11, v99, s45, v11
    v_dot2_f32_bf16 v12, v103, s45, v12
    v_and_b32 v82, 31, v0
    v_lshrrev_b32 v83, 5, v0
    s_lshl_b32 s38, s21, 10
    s_add_u32 s38, s38, 151552
    v_lshlrev_b32 v81, 5, v82
    v_add_u32 v81, s38, v81
    s_lshl_b32 s38, s22, 4
    v_lshlrev_b32 v83, 3, v83
    v_add3_u32 v80, v81, v83, s38
    v_add_f32 v86, v86, v88
    v_add_f32 v87, v87, v89
    ds_write_b32 v13, v11
    ds_write_b32 v13, v12 offset:2048
    ds_write_b64 v80, v[86:87]
    s_waitcnt lgkmcnt(0)
    s_barrier
    ds_read_b128 v[104:107], v81
    ds_read_b128 v[108:111], v81 offset:16
    ds_read_b128 v[96:99], v14
    ds_read_b128 v[100:103], v14 offset:16
    ds_read_b128 v[32:35], v14 offset:2048
    ds_read_b128 v[36:39], v14 offset:2064
    s_add_u32 m0, s30, 0
    s_add_u32 s37, s27, s29
    buffer_load_dwordx4 v4, s[8:11], s37 offen offset:0 lds
    buffer_load_dwordx4 v5, s[8:11], s37 offen offset:1024 lds
    buffer_load_dwordx4 v6, s[8:11], s37 offen offset:2048 lds
    s_waitcnt lgkmcnt(0)
    v_add_f32 v104, v104, v106
    v_add_f32 v105, v105, v107
    v_add_f32 v108, v108, v110
    v_add_f32 v109, v109, v111
    v_add_f32 v96, v96, v97
    v_add_f32 v98, v98, v99
    v_add_f32 v104, v104, v108
    v_add_f32 v105, v105, v109
    v_add_f32 v100, v100, v101
    v_add_f32 v102, v102, v103
    v_mul_f32 v92, 0xbae38e39, v104
    v_mul_f32 v93, 0x3ae38e39, v105
    v_add_f32 v96, v96, v98
    v_add_f32 v100, v100, v102
    v_fma_f32 v93, -v92, v92, v93
    v_max_f32 v93, 0, v93
    v_add_f32 v93, 0x3727c5ac, v93
    v_sqrt_f32 v26, v93
    v_add_f32 v96, v96, v100
    v_rcp_f32 v27, v26
    v_cvt_pk_bf16_f32 v94, v92, v92
    v_lshlrev_b32 v95, 16, v94
    v_sub_f32 v95, v92, v95
    v_cvt_pk_bf16_f32 v20, v92, v95
    v_cvt_pk_bf16_f32 v21, v92, v26
    v_and_b32 v95, 0xffff0000, v21
    v_sub_f32 v95, v26, v95
    v_cvt_pk_bf16_f32 v22, v95, 0
    v_cmp_gt_u32 vcc, 32, v0
    s_waitcnt vmcnt(36)
    v_cvt_pk_bf16_f32 v16, v96, v96
    v_lshlrev_b32 v97, 16, v16
    v_sub_f32 v97, v96, v97
    v_cvt_pk_bf16_f32 v98, v97, v97
    v_and_b32 v98, 0xffff, v98
    v_lshl_or_b32 v17, v10, 16, v98
    v_mov_b32 v18, v10
    v_mov_b32 v19, 0
    v_cndmask_b32 v20, 0, v20, vcc
    v_cndmask_b32 v21, 0, v21, vcc
    v_cndmask_b32 v22, 0, v22, vcc
    v_mov_b32 v23, 0
    v_mul_f32 v24, 0xc0135761, v27
    v_mul_f32 v94, v27, v27
    v_mfma_f32_32x32x16_bf16 v[64:79], v[16:19], v[20:23], v[64:79]
    v_mul_f32 v94, v94, v27
    v_mul_f32 v25, 0xbdd2d3e8, v94
    s_lshl_b32 s38, s21, 7
    s_add_u32 s38, s38, 159744
    v_lshlrev_b32 v95, 2, v82
    v_add_u32 v95, s38, v95
    ds_write_b32 v95, v27
    v_add_f32 v32, v32, v33
    v_add_f32 v34, v34, v35
    v_add_f32 v36, v36, v37
    v_add_f32 v38, v38, v39
    v_add_f32 v32, v32, v34
    v_add_f32 v36, v36, v38
    v_add_f32 v32, v32, v36
    v_cvt_pk_bf16_f32 v16, v32, v32
    v_lshlrev_b32 v33, 16, v16
    v_sub_f32 v33, v32, v33
    v_cvt_pk_bf16_f32 v34, v33, v33
    v_and_b32 v34, 0xffff, v34
    v_lshl_or_b32 v17, v28, 16, v34
    v_mov_b32 v18, v28
    v_mov_b32 v19, 0
    s_lshl_b32 s38, s22, 9
    v_lshlrev_b32 v13, 4, v82
    v_add_u32 v13, s38, v13
    v_mov_b32 v12, 0
    s_mov_b32 s43, s44
    s_add_u32 s44, s44, 1
    s_cmp_eq_u32 s24, 0
    s_cbranch_scc1 L_k1_ffn
    s_load_dwordx2 s[72:73], s[0:1], 48
    s_load_dwordx2 s[74:75], s[0:1], 16
    s_lshl_b32 s38, s23, 2
    s_and_b32 s39, s2, 3
    s_add_u32 s38, s38, s39
    s_lshl_b32 s38, s38, 7
    s_add_u32 s68, s38, 47590400
    s_lshl_b32 s69, s23, 7
    s_add_u32 s69, s69, 47606784
    s_lshl_b32 s41, s43, 12
    s_add_u32 s41, s41, s50
    s_cmp_lt_u32 s43, 9
    s_cselect_b32 s46, 0x3eae1a93, 1.0
    v_mul_f32 v28, s46, v27
    v_mul_f32 v80, v64, v28
    v_mul_f32 v81, v65, v28
    v_mul_f32 v82, v66, v28
    v_mul_f32 v83, v67, v28
    v_mul_f32 v84, v68, v28
    v_mul_f32 v85, v69, v28
    v_mul_f32 v86, v70, v28
    v_mul_f32 v87, v71, v28
    v_cvt_pk_bf16_f32 v64, v80, v81
    v_cvt_pk_bf16_f32 v65, v82, v83
    v_cvt_pk_bf16_f32 v66, v84, v85
    v_cvt_pk_bf16_f32 v67, v86, v87
    buffer_store_dwordx4 v[64:67], v7, s[16:19], s41 offen offset:0 sc1
    v_mul_f32 v88, v72, v28
    v_mul_f32 v89, v73, v28
    v_mul_f32 v90, v74, v28
    v_mul_f32 v91, v75, v28
    v_mul_f32 v92, v76, v28
    v_mul_f32 v93, v77, v28
    v_mul_f32 v94, v78, v28
    v_mul_f32 v95, v79, v28
    v_cvt_pk_bf16_f32 v72, v88, v89
    v_cvt_pk_bf16_f32 v73, v90, v91
    v_cvt_pk_bf16_f32 v74, v92, v93
    v_cvt_pk_bf16_f32 v75, v94, v95
    buffer_store_dwordx4 v[72:75], v7, s[16:19], s41 offen offset:1024 sc1
    s_waitcnt lgkmcnt(0)
    s_waitcnt vmcnt(5)
    s_barrier
    ds_read_b64_tr_b16 v[32:33], v1 offset:0
    ds_read_b64_tr_b16 v[34:35], v1 offset:512
    ds_read_b64_tr_b16 v[36:37], v1 offset:2048
    ds_read_b64_tr_b16 v[38:39], v1 offset:2560
    ds_read_b64_tr_b16 v[40:41], v1 offset:4096
    ds_read_b64_tr_b16 v[42:43], v1 offset:4608
    ds_read_b64_tr_b16 v[44:45], v1 offset:6144
    ds_read_b64_tr_b16 v[46:47], v1 offset:6656
    v_mfma_f32_32x32x16_bf16 v[64:79], v[16:19], v[20:23], v[48:63]
    s_mov_b32 s83, 0x00020000
    v_lshlrev_b32 v104, 7, v0
    v_cmp_gt_u32 vcc, 6, v0
    v_mov_b32 v105, 1073741824
    s_lshl_b32 s38, s70, 3
    v_cndmask_b32 v106, v105, v104, vcc
    v_cmp_gt_u32 vcc, 11, v0
    s_add_u32 s38, s38, s20
    s_and_b32 s37, s2, 3
    v_cndmask_b32 v104, v105, v104, vcc
    s_mul_i32 s39, s38, 648
    s_mul_i32 s40, s37, 165888
    s_add_u32 s39, s39, s40
    s_mov_b32 s80, s74
    s_mov_b32 s81, s75
    s_mov_b32 s82, 663552
    buffer_load_dword v105, v106, s[80:83], s39 offen
    s_mul_i32 s55, s38, 1408
    s_mul_i32 s40, s37, 1327104
    s_add_u32 s55, s55, s40
    s_mov_b32 s80, s72
    s_mov_b32 s81, s73
    s_add_u32 s82, s40, 1327104
    s_cmp_eq_u32 s24, 2
    s_cbranch_scc1 L_k1_cd
    s_mov_b32 s49, 5
L_k1_qkloop:
    s_mov_b32 s43, s44
    s_lshr_b32 s44, s28, 7
    s_mov_b32 s28, s29
    s_add_u32 s33, s33, 1
    s_add_u32 s38, s33, 2
    s_cmp_ge_u32 s38, 2
    s_cselect_b32 s39, s36, 0
    s_add_u32 s39, s39, s38
    s_add_u32 s39, s39, s35
    s_lshl_b32 s39, s39, 7
    s_cmp_lt_u32 s38, s34
    s_cselect_b32 s29, s39, 1073741824
    s_mov_b32 s38, s30
    s_mov_b32 s30, s31
    s_mov_b32 s31, s38
    s_lshl_b32 s40, s44, 10
    s_add_u32 s40, s40, s53
    s_lshl_b32 s41, s43, 12
    s_add_u32 s41, s41, s50
    s_cmp_lt_u32 s43, 9
    s_cselect_b32 s46, 0x3eae1a93, 1.0
    s_waitcnt lgkmcnt(4)
    v_mfma_f32_32x32x16_bf16 v[48:63], v[32:35], a[0:3], 0
    ds_read_b64_tr_b16 v[32:33], v1 offset:8192
    ds_read_b64_tr_b16 v[34:35], v1 offset:8704
    v_mfma_f32_32x32x16_bf16 v[48:63], v[36:39], a[4:7], v[48:63]
    v_mul_f32 v28, s46, v27
    ds_read_b64_tr_b16 v[36:37], v1 offset:10240
    ds_read_b64_tr_b16 v[38:39], v1 offset:10752
    s_add_u32 m0, s31, 24576
    s_add_u32 s37, s27, s28
    s_add_u32 s37, s37, s26
    buffer_load_dwordx4 v4, s[8:11], s37 offen offset:0 lds
    s_waitcnt lgkmcnt(4)
    v_mfma_f32_32x32x16_bf16 v[48:63], v[40:43], a[8:11], v[48:63]
    v_mul_f32 v80, v64, v28
    ds_read_b64_tr_b16 v[40:41], v1 offset:12288
    ds_read_b64_tr_b16 v[42:43], v1 offset:12800
    v_mfma_f32_32x32x16_bf16 v[48:63], v[44:47], a[12:15], v[48:63]
    ds_read_b64_tr_b16 v[44:45], v1 offset:14336
    ds_read_b64_tr_b16 v[46:47], v1 offset:14848
    buffer_load_dwordx4 v5, s[8:11], s37 offen offset:1024 lds
    s_waitcnt lgkmcnt(4)
    v_mfma_f32_32x32x16_bf16 v[48:63], v[32:35], a[16:19], v[48:63]
    v_mul_f32 v81, v65, v28
    ds_read_b64_tr_b16 v[32:33], v1 offset:16384
    ds_read_b64_tr_b16 v[34:35], v1 offset:16896
    v_mfma_f32_32x32x16_bf16 v[48:63], v[36:39], a[20:23], v[48:63]
    v_mul_f32 v82, v66, v28
    ds_read_b64_tr_b16 v[36:37], v1 offset:18432
    ds_read_b64_tr_b16 v[38:39], v1 offset:18944
    buffer_load_dwordx4 v6, s[8:11], s37 offen offset:2048 lds
    s_waitcnt lgkmcnt(4)
    v_mfma_f32_32x32x16_bf16 v[48:63], v[40:43], a[24:27], v[48:63]
    v_mul_f32 v83, v67, v28
    ds_read_b64_tr_b16 v[40:41], v1 offset:20480
    ds_read_b64_tr_b16 v[42:43], v1 offset:20992
    v_mfma_f32_32x32x16_bf16 v[48:63], v[44:47], a[28:31], v[48:63]
    v_mul_f32 v84, v68, v28
    ds_read_b64_tr_b16 v[44:45], v1 offset:22528
    ds_read_b64_tr_b16 v[46:47], v1 offset:23040
    s_add_u32 m0, s31, 49152
    s_add_u32 s37, s27, s28
    s_add_u32 s37, s37, s26
    s_add_u32 s37, s37, s26
    buffer_load_dwordx4 v4, s[8:11], s37 offen offset:0 lds
    s_waitcnt lgkmcnt(4)
    v_mfma_f32_32x32x16_bf16 v[48:63], v[32:35], a[32:35], v[48:63]
    v_mul_f32 v85, v69, v28
    ds_read_b64_tr_b16 v[32:33], v2 offset:0
    ds_read_b64_tr_b16 v[34:35], v2 offset:512
    v_mfma_f32_32x32x16_bf16 v[48:63], v[36:39], a[36:39], v[48:63]
    ds_read_b64_tr_b16 v[36:37], v2 offset:2048
    ds_read_b64_tr_b16 v[38:39], v2 offset:2560
    buffer_load_dwordx4 v5, s[8:11], s37 offen offset:1024 lds
    s_waitcnt lgkmcnt(4)
    v_mfma_f32_32x32x16_bf16 v[48:63], v[40:43], a[40:43], v[48:63]
    v_mul_f32 v86, v70, v28
    ds_read_b64_tr_b16 v[40:41], v2 offset:4096
    ds_read_b64_tr_b16 v[42:43], v2 offset:4608
    v_mfma_f32_32x32x16_bf16 v[48:63], v[44:47], a[44:47], v[48:63]
    v_mul_f32 v87, v71, v28
    ds_read_b64_tr_b16 v[44:45], v2 offset:6144
    ds_read_b64_tr_b16 v[46:47], v2 offset:6656
    buffer_load_dwordx4 v6, s[8:11], s37 offen offset:2048 lds
    s_waitcnt lgkmcnt(4)
    v_mfma_f32_32x32x16_bf16 v[48:63], v[32:35], a[48:51], v[48:63]
    v_cvt_pk_bf16_f32 v64, v80, v81
    global_load_dword v11, v12, s[64:65] offset:128 sc1
    ds_read_b64_tr_b16 v[32:33], v2 offset:8192
    ds_read_b64_tr_b16 v[34:35], v2 offset:8704
    v_add_u32 v1, s32, v1
    v_mfma_f32_32x32x16_bf16 v[48:63], v[36:39], a[52:55], v[48:63]
    v_cvt_pk_bf16_f32 v65, v82, v83
    ds_read_b64_tr_b16 v[36:37], v2 offset:10240
    ds_read_b64_tr_b16 v[38:39], v2 offset:10752
    s_waitcnt lgkmcnt(4)
    v_mfma_f32_32x32x16_bf16 v[48:63], v[40:43], a[56:59], v[48:63]
    ds_read_b64_tr_b16 v[40:41], v2 offset:12288
    ds_read_b64_tr_b16 v[42:43], v2 offset:12800
    v_mfma_f32_32x32x16_bf16 v[48:63], v[44:47], a[60:63], v[48:63]
    v_cvt_pk_bf16_f32 v66, v84, v85
    ds_read_b64_tr_b16 v[44:45], v2 offset:14336
    ds_read_b64_tr_b16 v[46:47], v2 offset:14848
    s_waitcnt lgkmcnt(4)
    v_mfma_f32_32x32x16_bf16 v[48:63], v[32:35], a[64:67], v[48:63]
    v_cvt_pk_bf16_f32 v67, v86, v87
    ds_read_b64_tr_b16 v[32:33], v2 offset:16384
    ds_read_b64_tr_b16 v[34:35], v2 offset:16896
    v_mfma_f32_32x32x16_bf16 v[48:63], v[36:39], a[68:71], v[48:63]
    buffer_store_dwordx4 v[64:67], v7, s[16:19], s41 offen offset:0 sc1
    ds_read_b64_tr_b16 v[36:37], v2 offset:18432
    ds_read_b64_tr_b16 v[38:39], v2 offset:18944
    s_waitcnt lgkmcnt(4)
    v_mfma_f32_32x32x16_bf16 v[48:63], v[40:43], a[72:75], v[48:63]
    v_mul_f32 v88, v72, v28
    ds_read_b64_tr_b16 v[40:41], v2 offset:20480
    ds_read_b64_tr_b16 v[42:43], v2 offset:20992
    v_mfma_f32_32x32x16_bf16 v[48:63], v[44:47], a[76:79], v[48:63]
    v_mul_f32 v89, v73, v28
    ds_read_b64_tr_b16 v[44:45], v2 offset:22528
    ds_read_b64_tr_b16 v[46:47], v2 offset:23040
    s_waitcnt lgkmcnt(4)
    v_mfma_f32_32x32x16_bf16 v[48:63], v[32:35], a[80:83], v[48:63]
    ds_read_b64_tr_b16 v[32:33], v3 offset:0
    ds_read_b64_tr_b16 v[34:35], v3 offset:512
    v_mfma_f32_32x32x16_bf16 v[48:63], v[36:39], a[84:87], v[48:63]
    v_mul_f32 v90, v74, v28
    ds_read_b64_tr_b16 v[36:37], v3 offset:2048
    ds_read_b64_tr_b16 v[38:39], v3 offset:2560
    s_waitcnt lgkmcnt(4)
    v_mfma_f32_32x32x16_bf16 v[48:63], v[40:43], a[88:91], v[48:63]
    v_mul_f32 v91, v75, v28
    ds_read_b64_tr_b16 v[40:41], v3 offset:4096
    ds_read_b64_tr_b16 v[42:43], v3 offset:4608
    v_mfma_f32_32x32x16_bf16 v[48:63], v[44:47], a[92:95], v[48:63]
    v_mul_f32 v92, v76, v28
    ds_read_b64_tr_b16 v[44:45], v3 offset:6144
    ds_read_b64_tr_b16 v[46:47], v3 offset:6656
    s_waitcnt lgkmcnt(4)
    v_mfma_f32_32x32x16_bf16 v[48:63], v[32:35], a[96:99], v[48:63]
    v_mul_f32 v93, v77, v28
    s_waitcnt vmcnt(1)
    v_cmp_ne_u32 vcc, 1, v11
    s_cbranch_vccz L_k1_n_qk_polled
L_k1_n_qk_poll:
    s_sleep 8
    global_load_dword v11, v12, s[64:65] offset:128 sc1
    s_waitcnt vmcnt(0)
    v_cmp_ne_u32 vcc, 1, v11
    s_cbranch_vccnz L_k1_n_qk_poll
L_k1_n_qk_polled:
    buffer_load_dwordx4 v[16:19], v13, s[16:19], s40 offen sc1
    ds_read_b64_tr_b16 v[32:33], v3 offset:8192
    ds_read_b64_tr_b16 v[34:35], v3 offset:8704
    v_add_u32 v2, s32, v2
    v_mfma_f32_32x32x16_bf16 v[48:63], v[36:39], a[100:103], v[48:63]
    ds_read_b64_tr_b16 v[36:37], v3 offset:10240
    ds_read_b64_tr_b16 v[38:39], v3 offset:10752
    s_waitcnt lgkmcnt(4)
    v_mfma_f32_32x32x16_bf16 v[48:63], v[40:43], a[104:107], v[48:63]
    v_mul_f32 v94, v78, v28
    buffer_load_dword v105, v104, s[80:83], s55 offen
    s_add_u32 s55, s55, 360448
    ds_read_b64_tr_b16 v[40:41], v3 offset:12288
    ds_read_b64_tr_b16 v[42:43], v3 offset:12800
    v_mfma_f32_32x32x16_bf16 v[48:63], v[44:47], a[108:111], v[48:63]
    v_mul_f32 v95, v79, v28
    ds_read_b64_tr_b16 v[44:45], v3 offset:14336
    ds_read_b64_tr_b16 v[46:47], v3 offset:14848
    s_waitcnt lgkmcnt(4)
    v_mfma_f32_32x32x16_bf16 v[48:63], v[32:35], a[112:115], v[48:63]
    v_cvt_pk_bf16_f32 v72, v88, v89
    ds_read_b64_tr_b16 v[32:33], v3 offset:16384
    ds_read_b64_tr_b16 v[34:35], v3 offset:16896
    v_mfma_f32_32x32x16_bf16 v[48:63], v[36:39], a[116:119], v[48:63]
    v_cvt_pk_bf16_f32 v73, v90, v91
    ds_read_b64_tr_b16 v[36:37], v3 offset:18432
    ds_read_b64_tr_b16 v[38:39], v3 offset:18944
    s_waitcnt lgkmcnt(4)
    v_mfma_f32_32x32x16_bf16 v[48:63], v[40:43], a[120:123], v[48:63]
    v_cvt_pk_bf16_f32 v74, v92, v93
    ds_read_b64_tr_b16 v[40:41], v3 offset:20480
    ds_read_b64_tr_b16 v[42:43], v3 offset:20992
    v_mfma_f32_32x32x16_bf16 v[48:63], v[44:47], a[124:127], v[48:63]
    ds_read_b64_tr_b16 v[44:45], v3 offset:22528
    ds_read_b64_tr_b16 v[46:47], v3 offset:23040
    s_waitcnt lgkmcnt(4)
    v_mfma_f32_32x32x16_bf16 v[48:63], v[32:35], v[112:115], v[48:63]
    v_cvt_pk_bf16_f32 v75, v94, v95
    s_waitcnt vmcnt(4) lgkmcnt(0)
    s_barrier
    ds_read_b64_tr_b16 v[32:33], v1 offset:0
    ds_read_b64_tr_b16 v[34:35], v1 offset:512
    s_add_u32 m0, s30, 0
    s_add_u32 s37, s27, s29
    buffer_load_dwordx4 v4, s[8:11], s37 offen offset:0 lds
    v_mfma_f32_32x32x16_bf16 v[48:63], v[36:39], v[116:119], v[48:63]
    buffer_store_dwordx4 v[72:75], v7, s[16:19], s41 offen offset:1024 sc1
    ds_read_b64_tr_b16 v[36:37], v1 offset:2048
    ds_read_b64_tr_b16 v[38:39], v1 offset:2560
    buffer_load_dwordx4 v5, s[8:11], s37 offen offset:1024 lds
    v_add_u32 v3, s32, v3
    s_waitcnt lgkmcnt(4)
    v_mfma_f32_32x32x16_bf16 v[48:63], v[40:43], v[120:123], v[48:63]
    ds_read_b64_tr_b16 v[40:41], v1 offset:4096
    ds_read_b64_tr_b16 v[42:43], v1 offset:4608
    buffer_load_dwordx4 v6, s[8:11], s37 offen offset:2048 lds
    v_mfma_f32_32x32x16_bf16 v[48:63], v[44:47], v[124:127], v[48:63]
    ds_read_b64_tr_b16 v[44:45], v1 offset:6144
    ds_read_b64_tr_b16 v[46:47], v1 offset:6656
    s_sub_u32 s32, 0, s32
    s_waitcnt vmcnt(5)
    v_mfma_f32_32x32x16_bf16 v[64:79], v[16:19], v[20:23], v[48:63]
    s_sub_u32 s49, s49, 1
    s_cmp_lg_u32 s49, 0
    s_cbranch_scc1 L_k1_qkloop
    s_mov_b32 s43, s44
    s_nop 15
    s_waitcnt vmcnt(0) lgkmcnt(0)
    s_lshl_b32 s41, s43, 12
    s_add_u32 s41, s41, s50
    s_cmp_lt_u32 s43, 9
    s_cselect_b32 s46, 0x3eae1a93, 1.0
    v_mul_f32 v28, s46, v27
    v_mul_f32 v80, v64, v28
    v_mul_f32 v81, v65, v28
    v_mul_f32 v82, v66, v28
    v_mul_f32 v83, v67, v28
    v_mul_f32 v84, v68, v28
    v_mul_f32 v85, v69, v28
    v_mul_f32 v86, v70, v28
    v_mul_f32 v87, v71, v28
    v_cvt_pk_bf16_f32 v64, v80, v81
    v_cvt_pk_bf16_f32 v65, v82, v83
    v_cvt_pk_bf16_f32 v66, v84, v85
    v_cvt_pk_bf16_f32 v67, v86, v87
    buffer_store_dwordx4 v[64:67], v7, s[16:19], s41 offen offset:0 sc1
    v_mul_f32 v88, v72, v28
    v_mul_f32 v89, v73, v28
    v_mul_f32 v90, v74, v28
    v_mul_f32 v91, v75, v28
    v_mul_f32 v92, v76, v28
    v_mul_f32 v93, v77, v28
    v_mul_f32 v94, v78, v28
    v_mul_f32 v95, v79, v28
    v_cvt_pk_bf16_f32 v72, v88, v89
    v_cvt_pk_bf16_f32 v73, v90, v91
    v_cvt_pk_bf16_f32 v74, v92, v93
    v_cvt_pk_bf16_f32 v75, v94, v95
    buffer_store_dwordx4 v[72:75], v7, s[16:19], s41 offen offset:1024 sc1
    s_branch L_k1_fin
L_k1_cd:
    s_mov_b32 s43, s44
    s_lshr_b32 s44, s28, 7
    s_mov_b32 s28, s29
    s_add_u32 s33, s33, 1
    s_add_u32 s38, s33, 2
    s_cmp_ge_u32 s38, 2
    s_cselect_b32 s39, s36, 0
    s_add_u32 s39, s39, s38
    s_add_u32 s39, s39, s35
    s_lshl_b32 s39, s39, 7
    s_cmp_lt_u32 s38, s34
    s_cselect_b32 s29, s39, 1073741824
    s_mov_b32 s38, s30
    s_mov_b32 s30, s31
    s_mov_b32 s31, s38
    s_lshl_b32 s40, s44, 10
    s_add_u32 s40, s40, s53
    s_lshl_b32 s41, s43, 12
    s_add_u32 s41, s41, s50
    s_cmp_lt_u32 s43, 9
    s_cselect_b32 s46, 0x3eae1a93, 1.0
    s_waitcnt lgkmcnt(4)
    v_mfma_f32_32x32x16_bf16 v[48:63], a[0:3], v[32:35], 0
    ds_read_b64_tr_b16 v[32:33], v1 offset:8192
    ds_read_b64_tr_b16 v[34:35], v1 offset:8704
    v_mfma_f32_32x32x16_bf16 v[48:63], a[4:7], v[36:39], v[48:63]
    v_mul_f32 v28, s46, v27
    ds_read_b64_tr_b16 v[36:37], v1 offset:10240
    ds_read_b64_tr_b16 v[38:39], v1 offset:10752
    s_add_u32 m0, s31, 24576
    s_add_u32 s37, s27, s28
    s_add_u32 s37, s37, s26
    buffer_load_dwordx4 v4, s[8:11], s37 offen offset:0 lds
    s_waitcnt lgkmcnt(4)
    v_mfma_f32_32x32x16_bf16 v[48:63], a[8:11], v[40:43], v[48:63]
    v_mul_f32 v80, v64, v28
    ds_read_b64_tr_b16 v[40:41], v1 offset:12288
    ds_read_b64_tr_b16 v[42:43], v1 offset:12800
    v_mfma_f32_32x32x16_bf16 v[48:63], a[12:15], v[44:47], v[48:63]
    ds_read_b64_tr_b16 v[44:45], v1 offset:14336
    ds_read_b64_tr_b16 v[46:47], v1 offset:14848
    buffer_load_dwordx4 v5, s[8:11], s37 offen offset:1024 lds
    s_waitcnt lgkmcnt(4)
    v_mfma_f32_32x32x16_bf16 v[48:63], a[16:19], v[32:35], v[48:63]
    v_mul_f32 v81, v65, v28
    ds_read_b64_tr_b16 v[32:33], v1 offset:16384
    ds_read_b64_tr_b16 v[34:35], v1 offset:16896
    v_mfma_f32_32x32x16_bf16 v[48:63], a[20:23], v[36:39], v[48:63]
    v_mul_f32 v82, v66, v28
    ds_read_b64_tr_b16 v[36:37], v1 offset:18432
    ds_read_b64_tr_b16 v[38:39], v1 offset:18944
    buffer_load_dwordx4 v6, s[8:11], s37 offen offset:2048 lds
    s_waitcnt lgkmcnt(4)
    v_mfma_f32_32x32x16_bf16 v[48:63], a[24:27], v[40:43], v[48:63]
    v_mul_f32 v83, v67, v28
    ds_read_b64_tr_b16 v[40:41], v1 offset:20480
    ds_read_b64_tr_b16 v[42:43], v1 offset:20992
    v_mfma_f32_32x32x16_bf16 v[48:63], a[28:31], v[44:47], v[48:63]
    v_mul_f32 v84, v68, v28
    ds_read_b64_tr_b16 v[44:45], v1 offset:22528
    ds_read_b64_tr_b16 v[46:47], v1 offset:23040
    s_add_u32 m0, s31, 49152
    s_add_u32 s37, s27, s28
    s_add_u32 s37, s37, s26
    s_add_u32 s37, s37, s26
    buffer_load_dwordx4 v4, s[8:11], s37 offen offset:0 lds
    s_waitcnt lgkmcnt(4)
    v_mfma_f32_32x32x16_bf16 v[48:63], a[32:35], v[32:35], v[48:63]
    v_mul_f32 v85, v69, v28
    ds_read_b64_tr_b16 v[32:33], v2 offset:0
    ds_read_b64_tr_b16 v[34:35], v2 offset:512
    v_mfma_f32_32x32x16_bf16 v[48:63], a[36:39], v[36:39], v[48:63]
    ds_read_b64_tr_b16 v[36:37], v2 offset:2048
    ds_read_b64_tr_b16 v[38:39], v2 offset:2560
    buffer_load_dwordx4 v5, s[8:11], s37 offen offset:1024 lds
    s_waitcnt lgkmcnt(4)
    v_mfma_f32_32x32x16_bf16 v[48:63], a[40:43], v[40:43], v[48:63]
    v_mul_f32 v86, v70, v28
    ds_read_b64_tr_b16 v[40:41], v2 offset:4096
    ds_read_b64_tr_b16 v[42:43], v2 offset:4608
    v_mfma_f32_32x32x16_bf16 v[48:63], a[44:47], v[44:47], v[48:63]
    v_mul_f32 v87, v71, v28
    ds_read_b64_tr_b16 v[44:45], v2 offset:6144
    ds_read_b64_tr_b16 v[46:47], v2 offset:6656
    buffer_load_dwordx4 v6, s[8:11], s37 offen offset:2048 lds
    s_waitcnt lgkmcnt(4)
    v_mfma_f32_32x32x16_bf16 v[48:63], a[48:51], v[32:35], v[48:63]
    v_cvt_pk_bf16_f32 v64, v80, v81
    global_load_dword v11, v12, s[64:65] offset:128 sc1
    ds_read_b64_tr_b16 v[32:33], v2 offset:8192
    ds_read_b64_tr_b16 v[34:35], v2 offset:8704
    v_add_u32 v1, s32, v1
    v_mfma_f32_32x32x16_bf16 v[48:63], a[52:55], v[36:39], v[48:63]
    v_cvt_pk_bf16_f32 v65, v82, v83
    ds_read_b64_tr_b16 v[36:37], v2 offset:10240
    ds_read_b64_tr_b16 v[38:39], v2 offset:10752
    s_waitcnt lgkmcnt(4)
    v_mfma_f32_32x32x16_bf16 v[48:63], a[56:59], v[40:43], v[48:63]
    ds_read_b64_tr_b16 v[40:41], v2 offset:12288
    ds_read_b64_tr_b16 v[42:43], v2 offset:12800
    v_mfma_f32_32x32x16_bf16 v[48:63], a[60:63], v[44:47], v[48:63]
    v_cvt_pk_bf16_f32 v66, v84, v85
    ds_read_b64_tr_b16 v[44:45], v2 offset:14336
    ds_read_b64_tr_b16 v[46:47], v2 offset:14848
    s_waitcnt lgkmcnt(4)
    v_mfma_f32_32x32x16_bf16 v[48:63], a[64:67], v[32:35], v[48:63]
    v_cvt_pk_bf16_f32 v67, v86, v87
    ds_read_b64_tr_b16 v[32:33], v2 offset:16384
    ds_read_b64_tr_b16 v[34:35], v2 offset:16896
    v_mfma_f32_32x32x16_bf16 v[48:63], a[68:71], v[36:39], v[48:63]
    buffer_store_dwordx4 v[64:67], v7, s[16:19], s41 offen offset:0 sc1
    ds_read_b64_tr_b16 v[36:37], v2 offset:18432
    ds_read_b64_tr_b16 v[38:39], v2 offset:18944
    s_waitcnt lgkmcnt(4)
    v_mfma_f32_32x32x16_bf16 v[48:63], a[72:75], v[40:43], v[48:63]
    v_mul_f32 v88, v72, v28
    ds_read_b64_tr_b16 v[40:41], v2 offset:20480
    ds_read_b64_tr_b16 v[42:43], v2 offset:20992
    v_mfma_f32_32x32x16_bf16 v[48:63], a[76:79], v[44:47], v[48:63]
    v_mul_f32 v89, v73, v28
    ds_read_b64_tr_b16 v[44:45], v2 offset:22528
    ds_read_b64_tr_b16 v[46:47], v2 offset:23040
    s_waitcnt lgkmcnt(4)
    v_mfma_f32_32x32x16_bf16 v[48:63], a[80:83], v[32:35], v[48:63]
    ds_read_b64_tr_b16 v[32:33], v3 offset:0
    ds_read_b64_tr_b16 v[34:35], v3 offset:512
    v_mfma_f32_32x32x16_bf16 v[48:63], a[84:87], v[36:39], v[48:63]
    v_mul_f32 v90, v74, v28
    ds_read_b64_tr_b16 v[36:37], v3 offset:2048
    ds_read_b64_tr_b16 v[38:39], v3 offset:2560
    s_waitcnt lgkmcnt(4)
    v_mfma_f32_32x32x16_bf16 v[48:63], a[88:91], v[40:43], v[48:63]
    v_mul_f32 v91, v75, v28
    ds_read_b64_tr_b16 v[40:41], v3 offset:4096
    ds_read_b64_tr_b16 v[42:43], v3 offset:4608
    v_mfma_f32_32x32x16_bf16 v[48:63], a[92:95], v[44:47], v[48:63]
    v_mul_f32 v92, v76, v28
    ds_read_b64_tr_b16 v[44:45], v3 offset:6144
    ds_read_b64_tr_b16 v[46:47], v3 offset:6656
    s_waitcnt lgkmcnt(4)
    v_mfma_f32_32x32x16_bf16 v[48:63], a[96:99], v[32:35], v[48:63]
    v_mul_f32 v93, v77, v28
    s_waitcnt vmcnt(1)
    v_cmp_ne_u32 vcc, 1, v11
    s_cbranch_vccz L_k1_s_qk_polled
L_k1_s_qk_poll:
    s_sleep 8
    global_load_dword v11, v12, s[64:65] offset:128 sc1
    s_waitcnt vmcnt(0)
    v_cmp_ne_u32 vcc, 1, v11
    s_cbranch_vccnz L_k1_s_qk_poll
L_k1_s_qk_polled:
    buffer_load_dwordx4 v[16:19], v13, s[16:19], s40 offen sc1
    ds_read_b64_tr_b16 v[32:33], v3 offset:8192
    ds_read_b64_tr_b16 v[34:35], v3 offset:8704
    v_add_u32 v2, s32, v2
    v_mfma_f32_32x32x16_bf16 v[48:63], a[100:103], v[36:39], v[48:63]
    ds_read_b64_tr_b16 v[36:37], v3 offset:10240
    ds_read_b64_tr_b16 v[38:39], v3 offset:10752
    s_waitcnt lgkmcnt(4)
    v_mfma_f32_32x32x16_bf16 v[48:63], a[104:107], v[40:43], v[48:63]
    v_mul_f32 v94, v78, v28
    buffer_load_dword v105, v104, s[80:83], s55 offen
    s_add_u32 s55, s55, 360448
    ds_read_b64_tr_b16 v[40:41], v3 offset:12288
    ds_read_b64_tr_b16 v[42:43], v3 offset:12800
    v_mfma_f32_32x32x16_bf16 v[48:63], a[108:111], v[44:47], v[48:63]
    v_mul_f32 v95, v79, v28
    ds_read_b64_tr_b16 v[44:45], v3 offset:14336
    ds_read_b64_tr_b16 v[46:47], v3 offset:14848
    s_waitcnt lgkmcnt(4)
    v_mfma_f32_32x32x16_bf16 v[48:63], a[112:115], v[32:35], v[48:63]
    v_cvt_pk_bf16_f32 v72, v88, v89
    ds_read_b64_tr_b16 v[32:33], v3 offset:16384
    ds_read_b64_tr_b16 v[34:35], v3 offset:16896
    v_mfma_f32_32x32x16_bf16 v[48:63], a[116:119], v[36:39], v[48:63]
    v_cvt_pk_bf16_f32 v73, v90, v91
    ds_read_b64_tr_b16 v[36:37], v3 offset:18432
    ds_read_b64_tr_b16 v[38:39], v3 offset:18944
    s_waitcnt lgkmcnt(4)
    v_mfma_f32_32x32x16_bf16 v[48:63], a[120:123], v[40:43], v[48:63]
    v_cvt_pk_bf16_f32 v74, v92, v93
    ds_read_b64_tr_b16 v[40:41], v3 offset:20480
    ds_read_b64_tr_b16 v[42:43], v3 offset:20992
    v_mfma_f32_32x32x16_bf16 v[48:63], a[124:127], v[44:47], v[48:63]
    ds_read_b64_tr_b16 v[44:45], v3 offset:22528
    ds_read_b64_tr_b16 v[46:47], v3 offset:23040
    s_waitcnt lgkmcnt(4)
    v_mfma_f32_32x32x16_bf16 v[48:63], v[112:115], v[32:35], v[48:63]
    v_cvt_pk_bf16_f32 v75, v94, v95
    s_waitcnt vmcnt(4) lgkmcnt(0)
    s_barrier
    ds_read_b64_tr_b16 v[32:33], v1 offset:0
    ds_read_b64_tr_b16 v[34:35], v1 offset:512
    s_add_u32 m0, s30, 0
    s_add_u32 s37, s27, s29
    buffer_load_dwordx4 v4, s[8:11], s37 offen offset:0 lds
    v_mfma_f32_32x32x16_bf16 v[48:63], v[116:119], v[36:39], v[48:63]
    buffer_store_dwordx4 v[72:75], v7, s[16:19], s41 offen offset:1024 sc1
    ds_read_b64_tr_b16 v[36:37], v1 offset:2048
    ds_read_b64_tr_b16 v[38:39], v1 offset:2560
    buffer_load_dwordx4 v5, s[8:11], s37 offen offset:1024 lds
    v_add_u32 v3, s32, v3
    s_waitcnt lgkmcnt(4)
    v_mfma_f32_32x32x16_bf16 v[48:63], v[120:123], v[40:43], v[48:63]
    ds_read_b64_tr_b16 v[40:41], v1 offset:4096
    ds_read_b64_tr_b16 v[42:43], v1 offset:4608
    buffer_load_dwordx4 v6, s[8:11], s37 offen offset:2048 lds
    v_mfma_f32_32x32x16_bf16 v[48:63], v[124:127], v[44:47], v[48:63]
    ds_read_b64_tr_b16 v[44:45], v1 offset:6144
    ds_read_b64_tr_b16 v[46:47], v1 offset:6656
    s_sub_u32 s32, 0, s32
    s_waitcnt vmcnt(5)
    v_mfma_f32_32x32x16_bf16 v[64:79], v[20:23], v[16:19], v[48:63]
    s_sub_u32 s49, s34, 3
L_k1_vloop:
    s_mov_b32 s43, s44
    s_lshr_b32 s44, s28, 7
    s_mov_b32 s28, s29
    s_add_u32 s33, s33, 1
    s_add_u32 s38, s33, 2
    s_cmp_ge_u32 s38, 2
    s_cselect_b32 s39, s36, 0
    s_add_u32 s39, s39, s38
    s_add_u32 s39, s39, s35
    s_lshl_b32 s39, s39, 7
    s_cmp_lt_u32 s38, s34
    s_cselect_b32 s29, s39, 1073741824
    s_mov_b32 s38, s30
    s_mov_b32 s30, s31
    s_mov_b32 s31, s38
    s_lshl_b32 s40, s44, 10
    s_add_u32 s40, s40, s53
    s_sub_u32 s41, s43, 18
    s_lshl_b32 s41, s41, 10
    s_add_u32 s41, s41, s51
    s_add_u32 s42, s41, 18432
    s_waitcnt lgkmcnt(4)
    v_mfma_f32_32x32x16_bf16 v[48:63], a[0:3], v[32:35], 0
    ds_read_b64_tr_b16 v[32:33], v1 offset:8192
    ds_read_b64_tr_b16 v[34:35], v1 offset:8704
    v_mfma_f32_32x32x16_bf16 v[48:63], a[4:7], v[36:39], v[48:63]
    ds_read_b128 v[80:83], v29 offset:0
    ds_read_b64_tr_b16 v[36:37], v1 offset:10240
    ds_read_b64_tr_b16 v[38:39], v1 offset:10752
    s_add_u32 m0, s31, 24576
    s_add_u32 s37, s27, s28
    s_add_u32 s37, s37, s26
    buffer_load_dwordx4 v4, s[8:11], s37 offen offset:0 lds
    s_waitcnt lgkmcnt(5)
    v_mfma_f32_32x32x16_bf16 v[48:63], a[8:11], v[40:43], v[48:63]
    ds_read_b128 v[84:87], v29 offset:32
    ds_read_b64_tr_b16 v[40:41], v1 offset:12288
    ds_read_b64_tr_b16 v[42:43], v1 offset:12800
    v_mfma_f32_32x32x16_bf16 v[48:63], a[12:15], v[44:47], v[48:63]
    ds_read_b128 v[88:91], v29 offset:64
    ds_read_b64_tr_b16 v[44:45], v1 offset:14336
    ds_read_b64_tr_b16 v[46:47], v1 offset:14848
    buffer_load_dwordx4 v5, s[8:11], s37 offen offset:1024 lds
    s_waitcnt lgkmcnt(6)
    v_mfma_f32_32x32x16_bf16 v[48:63], a[16:19], v[32:35], v[48:63]
    ds_read_b128 v[92:95], v29 offset:96
    ds_read_b64_tr_b16 v[32:33], v1 offset:16384
    ds_read_b64_tr_b16 v[34:35], v1 offset:16896
    v_mfma_f32_32x32x16_bf16 v[48:63], a[20:23], v[36:39], v[48:63]
    s_waitcnt lgkmcnt(2)
    ds_read_b64_tr_b16 v[36:37], v1 offset:18432
    ds_read_b64_tr_b16 v[38:39], v1 offset:18944
    buffer_load_dwordx4 v6, s[8:11], s37 offen offset:2048 lds
    s_waitcnt lgkmcnt(5)
    v_mfma_f32_32x32x16_bf16 v[48:63], a[24:27], v[40:43], v[48:63]
    v_mul_f32 v80, v64, v80
    ds_read_b64_tr_b16 v[40:41], v1 offset:20480
    ds_read_b64_tr_b16 v[42:43], v1 offset:20992
    v_mfma_f32_32x32x16_bf16 v[48:63], a[28:31], v[44:47], v[48:63]
    v_mul_f32 v81, v65, v81
    ds_read_b64_tr_b16 v[44:45], v1 offset:22528
    ds_read_b64_tr_b16 v[46:47], v1 offset:23040
    s_add_u32 m0, s31, 49152
    s_add_u32 s37, s27, s28
    s_add_u32 s37, s37, s26
    s_add_u32 s37, s37, s26
    buffer_load_dwordx4 v4, s[8:11], s37 offen offset:0 lds
    s_waitcnt lgkmcnt(4)
    v_mfma_f32_32x32x16_bf16 v[48:63], a[32:35], v[32:35], v[48:63]
    v_mul_f32 v82, v66, v82
    ds_read_b64_tr_b16 v[32:33], v2 offset:0
    ds_read_b64_tr_b16 v[34:35], v2 offset:512
    v_mfma_f32_32x32x16_bf16 v[48:63], a[36:39], v[36:39], v[48:63]
    ds_read_b64_tr_b16 v[36:37], v2 offset:2048
    ds_read_b64_tr_b16 v[38:39], v2 offset:2560
    buffer_load_dwordx4 v5, s[8:11], s37 offen offset:1024 lds
    s_waitcnt lgkmcnt(4)
    v_mfma_f32_32x32x16_bf16 v[48:63], a[40:43], v[40:43], v[48:63]
    v_mul_f32 v83, v67, v83
    ds_read_b64_tr_b16 v[40:41], v2 offset:4096
    ds_read_b64_tr_b16 v[42:43], v2 offset:4608
    v_mfma_f32_32x32x16_bf16 v[48:63], a[44:47], v[44:47], v[48:63]
    v_mul_f32 v84, v68, v84
    ds_read_b64_tr_b16 v[44:45], v2 offset:6144
    ds_read_b64_tr_b16 v[46:47], v2 offset:6656
    buffer_load_dwordx4 v6, s[8:11], s37 offen offset:2048 lds
    s_waitcnt lgkmcnt(4)
    v_mfma_f32_32x32x16_bf16 v[48:63], a[48:51], v[32:35], v[48:63]
    v_mul_f32 v85, v69, v85
    global_load_dword v11, v12, s[64:65] offset:128 sc1
    ds_read_b64_tr_b16 v[32:33], v2 offset:8192
    ds_read_b64_tr_b16 v[34:35], v2 offset:8704
    v_add_u32 v1, s32, v1
    v_mfma_f32_32x32x16_bf16 v[48:63], a[52:55], v[36:39], v[48:63]
    v_mul_f32 v86, v70, v86
    ds_read_b64_tr_b16 v[36:37], v2 offset:10240
    ds_read_b64_tr_b16 v[38:39], v2 offset:10752
    s_waitcnt lgkmcnt(4)
    v_mfma_f32_32x32x16_bf16 v[48:63], a[56:59], v[40:43], v[48:63]
    v_mul_f32 v87, v71, v87
    ds_read_b64_tr_b16 v[40:41], v2 offset:12288
    ds_read_b64_tr_b16 v[42:43], v2 offset:12800
    v_mfma_f32_32x32x16_bf16 v[48:63], a[60:63], v[44:47], v[48:63]
    v_cvt_pk_bf16_f32 v64, v80, v81
    ds_read_b64_tr_b16 v[44:45], v2 offset:14336
    ds_read_b64_tr_b16 v[46:47], v2 offset:14848
    s_waitcnt lgkmcnt(4)
    v_mfma_f32_32x32x16_bf16 v[48:63], a[64:67], v[32:35], v[48:63]
    v_cvt_pk_bf16_f32 v65, v82, v83
    ds_read_b64_tr_b16 v[32:33], v2 offset:16384
    ds_read_b64_tr_b16 v[34:35], v2 offset:16896
    v_mfma_f32_32x32x16_bf16 v[48:63], a[68:71], v[36:39], v[48:63]
    v_cvt_pk_bf16_f32 v66, v84, v85
    ds_read_b64_tr_b16 v[36:37], v2 offset:18432
    ds_read_b64_tr_b16 v[38:39], v2 offset:18944
    s_waitcnt lgkmcnt(4)
    v_mfma_f32_32x32x16_bf16 v[48:63], a[72:75], v[40:43], v[48:63]
    v_cvt_pk_bf16_f32 v67, v86, v87
    ds_read_b64_tr_b16 v[40:41], v2 offset:20480
    ds_read_b64_tr_b16 v[42:43], v2 offset:20992
    v_mfma_f32_32x32x16_bf16 v[48:63], a[76:79], v[44:47], v[48:63]
    buffer_store_dwordx4 v[64:67], v8, s[16:19], s41 offen offset:0 sc1
    ds_read_b64_tr_b16 v[44:45], v2 offset:22528
    ds_read_b64_tr_b16 v[46:47], v2 offset:23040
    s_waitcnt lgkmcnt(4)
    v_mfma_f32_32x32x16_bf16 v[48:63], a[80:83], v[32:35], v[48:63]
    v_mul_f32 v88, v72, v88
    ds_read_b64_tr_b16 v[32:33], v3 offset:0
    ds_read_b64_tr_b16 v[34:35], v3 offset:512
    v_mfma_f32_32x32x16_bf16 v[48:63], a[84:87], v[36:39], v[48:63]
    v_mul_f32 v89, v73, v89
    ds_read_b64_tr_b16 v[36:37], v3 offset:2048
    ds_read_b64_tr_b16 v[38:39], v3 offset:2560
    s_waitcnt lgkmcnt(4)
    v_mfma_f32_32x32x16_bf16 v[48:63], a[88:91], v[40:43], v[48:63]
    v_mul_f32 v90, v74, v90
    ds_read_b64_tr_b16 v[40:41], v3 offset:4096
    ds_read_b64_tr_b16 v[42:43], v3 offset:4608
    v_mfma_f32_32x32x16_bf16 v[48:63], a[92:95], v[44:47], v[48:63]
    v_mul_f32 v91, v75, v91
    ds_read_b64_tr_b16 v[44:45], v3 offset:6144
    ds_read_b64_tr_b16 v[46:47], v3 offset:6656
    s_waitcnt lgkmcnt(4)
    v_mfma_f32_32x32x16_bf16 v[48:63], a[96:99], v[32:35], v[48:63]
    v_mul_f32 v92, v76, v92
    s_waitcnt vmcnt(1)
    v_cmp_ne_u32 vcc, 1, v11
    s_cbranch_vccz L_k1_s_v_polled
L_k1_s_v_poll:
    s_sleep 8
    global_load_dword v11, v12, s[64:65] offset:128 sc1
    s_waitcnt vmcnt(0)
    v_cmp_ne_u32 vcc, 1, v11
    s_cbranch_vccnz L_k1_s_v_poll
L_k1_s_v_polled:
    buffer_load_dwordx4 v[16:19], v13, s[16:19], s40 offen sc1
    ds_read_b64_tr_b16 v[32:33], v3 offset:8192
    ds_read_b64_tr_b16 v[34:35], v3 offset:8704
    v_add_u32 v2, s32, v2
    v_mfma_f32_32x32x16_bf16 v[48:63], a[100:103], v[36:39], v[48:63]
    ds_read_b64_tr_b16 v[36:37], v3 offset:10240
    ds_read_b64_tr_b16 v[38:39], v3 offset:10752
    s_waitcnt lgkmcnt(4)
    v_mfma_f32_32x32x16_bf16 v[48:63], a[104:107], v[40:43], v[48:63]
    v_mul_f32 v93, v77, v93
    buffer_load_dword v105, v104, s[80:83], s55 offen
    s_add_u32 s55, s55, 360448
    ds_read_b64_tr_b16 v[40:41], v3 offset:12288
    ds_read_b64_tr_b16 v[42:43], v3 offset:12800
    v_mfma_f32_32x32x16_bf16 v[48:63], a[108:111], v[44:47], v[48:63]
    v_mul_f32 v94, v78, v94
    ds_read_b64_tr_b16 v[44:45], v3 offset:14336
    ds_read_b64_tr_b16 v[46:47], v3 offset:14848
    s_waitcnt lgkmcnt(4)
    v_mfma_f32_32x32x16_bf16 v[48:63], a[112:115], v[32:35], v[48:63]
    v_mul_f32 v95, v79, v95
    ds_read_b64_tr_b16 v[32:33], v3 offset:16384
    ds_read_b64_tr_b16 v[34:35], v3 offset:16896
    v_mfma_f32_32x32x16_bf16 v[48:63], a[116:119], v[36:39], v[48:63]
    v_cvt_pk_bf16_f32 v72, v88, v89
    ds_read_b64_tr_b16 v[36:37], v3 offset:18432
    ds_read_b64_tr_b16 v[38:39], v3 offset:18944
    s_waitcnt lgkmcnt(4)
    v_mfma_f32_32x32x16_bf16 v[48:63], a[120:123], v[40:43], v[48:63]
    v_cvt_pk_bf16_f32 v73, v90, v91
    ds_read_b64_tr_b16 v[40:41], v3 offset:20480
    ds_read_b64_tr_b16 v[42:43], v3 offset:20992
    v_mfma_f32_32x32x16_bf16 v[48:63], a[124:127], v[44:47], v[48:63]
    v_cvt_pk_bf16_f32 v74, v92, v93
    ds_read_b64_tr_b16 v[44:45], v3 offset:22528
    ds_read_b64_tr_b16 v[46:47], v3 offset:23040
    s_waitcnt lgkmcnt(4)
    v_mfma_f32_32x32x16_bf16 v[48:63], v[112:115], v[32:35], v[48:63]
    v_cvt_pk_bf16_f32 v75, v94, v95
    s_waitcnt vmcnt(4) lgkmcnt(0)
    s_barrier
    ds_read_b64_tr_b16 v[32:33], v1 offset:0
    ds_read_b64_tr_b16 v[34:35], v1 offset:512
    s_add_u32 m0, s30, 0
    s_add_u32 s37, s27, s29
    buffer_load_dwordx4 v4, s[8:11], s37 offen offset:0 lds
    v_mfma_f32_32x32x16_bf16 v[48:63], v[116:119], v[36:39], v[48:63]
    buffer_store_dwordx4 v[72:75], v8, s[16:19], s42 offen offset:0 sc1
    ds_read_b64_tr_b16 v[36:37], v1 offset:2048
    ds_read_b64_tr_b16 v[38:39], v1 offset:2560
    buffer_load_dwordx4 v5, s[8:11], s37 offen offset:1024 lds
    v_add_u32 v3, s32, v3
    s_waitcnt lgkmcnt(4)
    v_mfma_f32_32x32x16_bf16 v[48:63], v[120:123], v[40:43], v[48:63]
    ds_read_b64_tr_b16 v[40:41], v1 offset:4096
    ds_read_b64_tr_b16 v[42:43], v1 offset:4608
    buffer_load_dwordx4 v6, s[8:11], s37 offen offset:2048 lds
    v_mfma_f32_32x32x16_bf16 v[48:63], v[124:127], v[44:47], v[48:63]
    ds_read_b64_tr_b16 v[44:45], v1 offset:6144
    ds_read_b64_tr_b16 v[46:47], v1 offset:6656
    s_sub_u32 s32, 0, s32
    s_waitcnt vmcnt(5)
    v_mfma_f32_32x32x16_bf16 v[64:79], v[20:23], v[16:19], v[48:63]
    s_sub_u32 s49, s49, 1
    s_cmp_lg_u32 s49, 0
    s_cbranch_scc1 L_k1_vloop
    s_mov_b32 s43, s44
    s_nop 15
    s_waitcnt vmcnt(0) lgkmcnt(0)
    s_sub_u32 s41, s43, 18
    s_lshl_b32 s41, s41, 10
    s_add_u32 s41, s41, s51
    s_add_u32 s42, s41, 18432
    ds_read_b128 v[80:83], v29 offset:0
    ds_read_b128 v[84:87], v29 offset:32
    ds_read_b128 v[88:91], v29 offset:64
    ds_read_b128 v[92:95], v29 offset:96
    s_waitcnt lgkmcnt(0)
    v_mul_f32 v80, v64, v80
    v_mul_f32 v81, v65, v81
    v_mul_f32 v82, v66, v82
    v_mul_f32 v83, v67, v83
    v_mul_f32 v84, v68, v84
    v_mul_f32 v85, v69, v85
    v_mul_f32 v86, v70, v86
    v_mul_f32 v87, v71, v87
    v_cvt_pk_bf16_f32 v64, v80, v81
    v_cvt_pk_bf16_f32 v65, v82, v83
    v_cvt_pk_bf16_f32 v66, v84, v85
    v_cvt_pk_bf16_f32 v67, v86, v87
    buffer_store_dwordx4 v[64:67], v8, s[16:19], s41 offen offset:0 sc1
    v_mul_f32 v88, v72, v88
    v_mul_f32 v89, v73, v89
    v_mul_f32 v90, v74, v90
    v_mul_f32 v91, v75, v91
    v_mul_f32 v92, v76, v92
    v_mul_f32 v93, v77, v93
    v_mul_f32 v94, v78, v94
    v_mul_f32 v95, v79, v95
    v_cvt_pk_bf16_f32 v72, v88, v89
    v_cvt_pk_bf16_f32 v73, v90, v91
    v_cvt_pk_bf16_f32 v74, v92, v93
    v_cvt_pk_bf16_f32 v75, v94, v95
    buffer_store_dwordx4 v[72:75], v8, s[16:19], s42 offen offset:0 sc1
    s_branch L_k1_fin
L_k1_ffn:
    s_load_dwordx2 s[72:73], s[0:1], 48
    s_load_dwordx2 s[74:75], s[0:1], 16
    s_lshl_b32 s38, s23, 2
    s_and_b32 s39, s2, 3
    s_add_u32 s38, s38, s39
    s_lshl_b32 s38, s38, 7
    s_add_u32 s68, s38, 47590400
    s_add_u32 s69, s38, 47598592
    s_lshl_b32 s41, s43, 11
    s_add_u32 s41, s41, s52
    v_mul_f32 v80, v64, v64
    v_mul_f32 v81, v65, v65
    v_mul_f32 v82, v66, v66
    v_mul_f32 v83, v67, v67
    v_mul_f32 v84, v68, v68
    v_mul_f32 v85, v69, v69
    v_mul_f32 v86, v70, v70
    v_mul_f32 v87, v71, v71
    v_fma_f32 v80, v80, v25, v24
    v_fma_f32 v81, v81, v25, v24
    v_fma_f32 v82, v82, v25, v24
    v_fma_f32 v83, v83, v25, v24
    v_fma_f32 v84, v84, v25, v24
    v_fma_f32 v85, v85, v25, v24
    v_fma_f32 v86, v86, v25, v24
    v_fma_f32 v87, v87, v25, v24
    v_mul_f32 v80, v80, v64
    v_mul_f32 v81, v81, v65
    v_mul_f32 v82, v82, v66
    v_mul_f32 v83, v83, v67
    v_mul_f32 v84, v84, v68
    v_mul_f32 v85, v85, v69
    v_mul_f32 v86, v86, v70
    v_mul_f32 v87, v87, v71
    v_exp_f32 v80, v80
    v_mul_f32 v88, v72, v72
    v_mul_f32 v89, v73, v73
    v_exp_f32 v81, v81
    v_mul_f32 v90, v74, v74
    v_exp_f32 v82, v82
    v_mul_f32 v91, v75, v75
    v_mul_f32 v92, v76, v76
    v_exp_f32 v83, v83
    v_mul_f32 v93, v77, v77
    v_exp_f32 v84, v84
    v_mul_f32 v94, v78, v78
    v_mul_f32 v95, v79, v79
    v_exp_f32 v85, v85
    v_fma_f32 v88, v88, v25, v24
    v_exp_f32 v86, v86
    v_fma_f32 v89, v89, v25, v24
    v_fma_f32 v90, v90, v25, v24
    v_exp_f32 v87, v87
    v_fma_f32 v91, v91, v25, v24
    v_fma_f32 v80, v80, v26, v26
    v_fma_f32 v81, v81, v26, v26
    v_fma_f32 v82, v82, v26, v26
    v_fma_f32 v83, v83, v26, v26
    v_fma_f32 v84, v84, v26, v26
    v_fma_f32 v85, v85, v26, v26
    v_fma_f32 v86, v86, v26, v26
    v_fma_f32 v87, v87, v26, v26
    v_rcp_f32 v80, v80
    v_fma_f32 v92, v92, v25, v24
    v_fma_f32 v93, v93, v25, v24
    v_rcp_f32 v81, v81
    v_fma_f32 v94, v94, v25, v24
    v_rcp_f32 v82, v82
    v_fma_f32 v95, v95, v25, v24
    v_mul_f32 v88, v88, v72
    v_rcp_f32 v83, v83
    v_mul_f32 v89, v89, v73
    v_rcp_f32 v84, v84
    v_mul_f32 v90, v90, v74
    v_mul_f32 v91, v91, v75
    v_rcp_f32 v85, v85
    v_mul_f32 v92, v92, v76
    v_rcp_f32 v86, v86
    v_mul_f32 v93, v93, v77
    v_mul_f32 v94, v94, v78
    v_rcp_f32 v87, v87
    v_mul_f32 v95, v95, v79
    v_exp_f32 v88, v88
    v_mul_f32 v80, v80, v64
    v_mul_f32 v81, v81, v65
    v_exp_f32 v89, v89
    v_mul_f32 v82, v82, v66
    v_mul_f32 v83, v83, v67
    v_exp_f32 v90, v90
    v_mul_f32 v84, v84, v68
    v_exp_f32 v91, v91
    v_mul_f32 v85, v85, v69
    v_mul_f32 v86, v86, v70
    v_exp_f32 v92, v92
    v_mul_f32 v87, v87, v71
    v_cvt_pk_bf16_f32 v64, v80, v81
    v_exp_f32 v93, v93
    v_cvt_pk_bf16_f32 v65, v82, v83
    v_exp_f32 v94, v94
    v_cvt_pk_bf16_f32 v66, v84, v85
    v_cvt_pk_bf16_f32 v67, v86, v87
    v_exp_f32 v95, v95
    buffer_store_dwordx4 v[64:67], v7, s[16:19], s41 offen offset:0 sc1
    v_fma_f32 v88, v88, v26, v26
    v_fma_f32 v89, v89, v26, v26
    v_fma_f32 v90, v90, v26, v26
    v_fma_f32 v91, v91, v26, v26
    v_fma_f32 v92, v92, v26, v26
    v_fma_f32 v93, v93, v26, v26
    v_fma_f32 v94, v94, v26, v26
    v_fma_f32 v95, v95, v26, v26
    v_rcp_f32 v88, v88
    v_rcp_f32 v89, v89
    v_rcp_f32 v90, v90
    v_rcp_f32 v91, v91
    v_rcp_f32 v92, v92
    v_rcp_f32 v93, v93
    v_rcp_f32 v94, v94
    v_rcp_f32 v95, v95
    s_nop 0
    v_mul_f32 v88, v88, v72
    v_mul_f32 v89, v89, v73
    v_mul_f32 v90, v90, v74
    v_mul_f32 v91, v91, v75
    v_mul_f32 v92, v92, v76
    v_mul_f32 v93, v93, v77
    v_mul_f32 v94, v94, v78
    v_mul_f32 v95, v95, v79
    v_cvt_pk_bf16_f32 v72, v88, v89
    v_cvt_pk_bf16_f32 v73, v90, v91
    v_cvt_pk_bf16_f32 v74, v92, v93
    v_cvt_pk_bf16_f32 v75, v94, v95
    buffer_store_dwordx4 v[72:75], v7, s[16:19], s41 offen offset:512 sc1
    s_waitcnt lgkmcnt(0)
    s_waitcnt vmcnt(5)
    s_barrier
    ds_read_b64_tr_b16 v[32:33], v1 offset:0
    ds_read_b64_tr_b16 v[34:35], v1 offset:512
    ds_read_b64_tr_b16 v[36:37], v1 offset:2048
    ds_read_b64_tr_b16 v[38:39], v1 offset:2560
    ds_read_b64_tr_b16 v[40:41], v1 offset:4096
    ds_read_b64_tr_b16 v[42:43], v1 offset:4608
    ds_read_b64_tr_b16 v[44:45], v1 offset:6144
    ds_read_b64_tr_b16 v[46:47], v1 offset:6656
    v_mfma_f32_32x32x16_bf16 v[64:79], v[16:19], v[20:23], v[48:63]
    s_mov_b32 s83, 0x00020000
    v_lshlrev_b32 v104, 7, v0
    v_cmp_gt_u32 vcc, 6, v0
    v_mov_b32 v105, 1073741824
    s_lshl_b32 s38, s70, 3
    v_cndmask_b32 v106, v105, v104, vcc
    v_cmp_gt_u32 vcc, 11, v0
    s_add_u32 s38, s38, s20
    s_and_b32 s37, s2, 3
    v_cndmask_b32 v104, v105, v104, vcc
    s_mul_i32 s39, s38, 648
    s_mul_i32 s40, s37, 165888
    s_add_u32 s39, s39, s40
    s_mov_b32 s80, s74
    s_mov_b32 s81, s75
    s_mov_b32 s82, 663552
    buffer_load_dword v105, v106, s[80:83], s39 offen
    s_mul_i32 s55, s38, 1408
    s_mul_i32 s40, s37, 1327104
    s_add_u32 s55, s55, s40
    s_mov_b32 s80, s72
    s_mov_b32 s81, s73
    s_add_u32 s82, s40, 1327104
    s_mov_b32 s49, 4
L_k1_floop:
    s_mov_b32 s43, s44
    s_lshr_b32 s44, s28, 7
    s_mov_b32 s28, s29
    s_add_u32 s33, s33, 1
    s_add_u32 s38, s33, 2
    s_cmp_ge_u32 s38, 2
    s_cselect_b32 s39, s36, 0
    s_add_u32 s39, s39, s38
    s_add_u32 s39, s39, s35
    s_lshl_b32 s39, s39, 7
    s_cmp_lt_u32 s38, s34
    s_cselect_b32 s29, s39, 1073741824
    s_mov_b32 s38, s30
    s_mov_b32 s30, s31
    s_mov_b32 s31, s38
    s_lshl_b32 s40, s44, 10
    s_add_u32 s40, s40, s53
    s_lshl_b32 s41, s43, 11
    s_add_u32 s41, s41, s52
    s_waitcnt lgkmcnt(4)
    v_mfma_f32_32x32x16_bf16 v[48:63], v[32:35], a[0:3], 0
    ds_read_b64_tr_b16 v[32:33], v1 offset:8192
    ds_read_b64_tr_b16 v[34:35], v1 offset:8704
    v_mfma_f32_32x32x16_bf16 v[48:63], v[36:39], a[4:7], v[48:63]
    v_mul_f32 v80, v64, v64
    v_mul_f32 v81, v65, v65
    v_mul_f32 v82, v66, v66
    v_mul_f32 v83, v67, v67
    v_mul_f32 v84, v68, v68
    ds_read_b64_tr_b16 v[36:37], v1 offset:10240
    ds_read_b64_tr_b16 v[38:39], v1 offset:10752
    s_add_u32 m0, s31, 24576
    s_add_u32 s37, s27, s28
    s_add_u32 s37, s37, s26
    buffer_load_dwordx4 v4, s[8:11], s37 offen offset:0 lds
    s_waitcnt lgkmcnt(4)
    v_mfma_f32_32x32x16_bf16 v[48:63], v[40:43], a[8:11], v[48:63]
    v_mul_f32 v85, v69, v69
    v_mul_f32 v86, v70, v70
    v_mul_f32 v87, v71, v71
    v_fma_f32 v80, v80, v25, v24
    ds_read_b64_tr_b16 v[40:41], v1 offset:12288
    ds_read_b64_tr_b16 v[42:43], v1 offset:12800
    v_mfma_f32_32x32x16_bf16 v[48:63], v[44:47], a[12:15], v[48:63]
    v_fma_f32 v81, v81, v25, v24
    v_fma_f32 v82, v82, v25, v24
    v_fma_f32 v83, v83, v25, v24
    v_fma_f32 v84, v84, v25, v24
    v_fma_f32 v85, v85, v25, v24
    ds_read_b64_tr_b16 v[44:45], v1 offset:14336
    ds_read_b64_tr_b16 v[46:47], v1 offset:14848
    buffer_load_dwordx4 v5, s[8:11], s37 offen offset:1024 lds
    s_waitcnt lgkmcnt(4)
    v_mfma_f32_32x32x16_bf16 v[48:63], v[32:35], a[16:19], v[48:63]
    v_fma_f32 v86, v86, v25, v24
    v_fma_f32 v87, v87, v25, v24
    v_mul_f32 v80, v80, v64
    v_mul_f32 v81, v81, v65
    v_mul_f32 v82, v82, v66
    ds_read_b64_tr_b16 v[32:33], v1 offset:16384
    ds_read_b64_tr_b16 v[34:35], v1 offset:16896
    v_mfma_f32_32x32x16_bf16 v[48:63], v[36:39], a[20:23], v[48:63]
    v_mul_f32 v83, v83, v67
    v_mul_f32 v84, v84, v68
    v_mul_f32 v85, v85, v69
    v_mul_f32 v86, v86, v70
    ds_read_b64_tr_b16 v[36:37], v1 offset:18432
    ds_read_b64_tr_b16 v[38:39], v1 offset:18944
    buffer_load_dwordx4 v6, s[8:11], s37 offen offset:2048 lds
    s_waitcnt lgkmcnt(4)
    v_mfma_f32_32x32x16_bf16 v[48:63], v[40:43], a[24:27], v[48:63]
    v_mul_f32 v87, v87, v71
    v_exp_f32 v80, v80
    v_mul_f32 v88, v72, v72
    v_mul_f32 v89, v73, v73
    ds_read_b64_tr_b16 v[40:41], v1 offset:20480
    ds_read_b64_tr_b16 v[42:43], v1 offset:20992
    v_mfma_f32_32x32x16_bf16 v[48:63], v[44:47], a[28:31], v[48:63]
    v_exp_f32 v81, v81
    v_mul_f32 v90, v74, v74
    v_exp_f32 v82, v82
    ds_read_b64_tr_b16 v[44:45], v1 offset:22528
    ds_read_b64_tr_b16 v[46:47], v1 offset:23040
    s_add_u32 m0, s31, 49152
    s_add_u32 s37, s27, s28
    s_add_u32 s37, s37, s26
    s_add_u32 s37, s37, s26
    buffer_load_dwordx4 v4, s[8:11], s37 offen offset:0 lds
    s_waitcnt lgkmcnt(4)
    v_mfma_f32_32x32x16_bf16 v[48:63], v[32:35], a[32:35], v[48:63]
    v_mul_f32 v91, v75, v75
    v_mul_f32 v92, v76, v76
    v_exp_f32 v83, v83
    v_mul_f32 v93, v77, v77
    ds_read_b64_tr_b16 v[32:33], v2 offset:0
    ds_read_b64_tr_b16 v[34:35], v2 offset:512
    v_mfma_f32_32x32x16_bf16 v[48:63], v[36:39], a[36:39], v[48:63]
    v_exp_f32 v84, v84
    v_mul_f32 v94, v78, v78
    v_mul_f32 v95, v79, v79
    ds_read_b64_tr_b16 v[36:37], v2 offset:2048
    ds_read_b64_tr_b16 v[38:39], v2 offset:2560
    buffer_load_dwordx4 v5, s[8:11], s37 offen offset:1024 lds
    s_waitcnt lgkmcnt(4)
    v_mfma_f32_32x32x16_bf16 v[48:63], v[40:43], a[40:43], v[48:63]
    v_exp_f32 v85, v85
    v_fma_f32 v88, v88, v25, v24
    v_exp_f32 v86, v86
    ds_read_b64_tr_b16 v[40:41], v2 offset:4096
    ds_read_b64_tr_b16 v[42:43], v2 offset:4608
    v_mfma_f32_32x32x16_bf16 v[48:63], v[44:47], a[44:47], v[48:63]
    v_fma_f32 v89, v89, v25, v24
    v_fma_f32 v90, v90, v25, v24
    v_exp_f32 v87, v87
    v_fma_f32 v91, v91, v25, v24
    ds_read_b64_tr_b16 v[44:45], v2 offset:6144
    ds_read_b64_tr_b16 v[46:47], v2 offset:6656
    buffer_load_dwordx4 v6, s[8:11], s37 offen offset:2048 lds
    s_waitcnt lgkmcnt(4)
    v_mfma_f32_32x32x16_bf16 v[48:63], v[32:35], a[48:51], v[48:63]
    v_fma_f32 v80, v80, v26, v26
    v_fma_f32 v81, v81, v26, v26
    v_fma_f32 v82, v82, v26, v26
    v_fma_f32 v83, v83, v26, v26
    global_load_dword v11, v12, s[64:65] offset:128 sc1
    ds_read_b64_tr_b16 v[32:33], v2 offset:8192
    ds_read_b64_tr_b16 v[34:35], v2 offset:8704
    v_add_u32 v1, s32, v1
    v_mfma_f32_32x32x16_bf16 v[48:63], v[36:39], a[52:55], v[48:63]
    v_fma_f32 v84, v84, v26, v26
    v_fma_f32 v85, v85, v26, v26
    v_fma_f32 v86, v86, v26, v26
    v_fma_f32 v87, v87, v26, v26
    v_rcp_f32 v80, v80
    ds_read_b64_tr_b16 v[36:37], v2 offset:10240
    ds_read_b64_tr_b16 v[38:39], v2 offset:10752
    s_waitcnt lgkmcnt(4)
    v_mfma_f32_32x32x16_bf16 v[48:63], v[40:43], a[56:59], v[48:63]
    v_fma_f32 v92, v92, v25, v24
    v_fma_f32 v93, v93, v25, v24
    v_rcp_f32 v81, v81
    ds_read_b64_tr_b16 v[40:41], v2 offset:12288
    ds_read_b64_tr_b16 v[42:43], v2 offset:12800
    v_mfma_f32_32x32x16_bf16 v[48:63], v[44:47], a[60:63], v[48:63]
    v_fma_f32 v94, v94, v25, v24
    v_rcp_f32 v82, v82
    v_fma_f32 v95, v95, v25, v24
    ds_read_b64_tr_b16 v[44:45], v2 offset:14336
    ds_read_b64_tr_b16 v[46:47], v2 offset:14848
    s_waitcnt lgkmcnt(4)
    v_mfma_f32_32x32x16_bf16 v[48:63], v[32:35], a[64:67], v[48:63]
    v_mul_f32 v88, v88, v72
    v_rcp_f32 v83, v83
    v_mul_f32 v89, v89, v73
    v_rcp_f32 v84, v84
    ds_read_b64_tr_b16 v[32:33], v2 offset:16384
    ds_read_b64_tr_b16 v[34:35], v2 offset:16896
    v_mfma_f32_32x32x16_bf16 v[48:63], v[36:39], a[68:71], v[48:63]
    v_mul_f32 v90, v90, v74
    v_mul_f32 v91, v91, v75
    v_rcp_f32 v85, v85
    ds_read_b64_tr_b16 v[36:37], v2 offset:18432
    ds_read_b64_tr_b16 v[38:39], v2 offset:18944
    s_waitcnt lgkmcnt(4)
    v_mfma_f32_32x32x16_bf16 v[48:63], v[40:43], a[72:75], v[48:63]
    v_mul_f32 v92, v92, v76
    v_rcp_f32 v86, v86
    v_mul_f32 v93, v93, v77
    v_mul_f32 v94, v94, v78
    ds_read_b64_tr_b16 v[40:41], v2 offset:20480
    ds_read_b64_tr_b16 v[42:43], v2 offset:20992
    v_mfma_f32_32x32x16_bf16 v[48:63], v[44:47], a[76:79], v[48:63]
    v_rcp_f32 v87, v87
    v_mul_f32 v95, v95, v79
    v_exp_f32 v88, v88
    ds_read_b64_tr_b16 v[44:45], v2 offset:22528
    ds_read_b64_tr_b16 v[46:47], v2 offset:23040
    s_waitcnt lgkmcnt(4)
    v_mfma_f32_32x32x16_bf16 v[48:63], v[32:35], a[80:83], v[48:63]
    v_mul_f32 v80, v80, v64
    v_mul_f32 v81, v81, v65
    v_exp_f32 v89, v89
    ds_read_b64_tr_b16 v[32:33], v3 offset:0
    ds_read_b64_tr_b16 v[34:35], v3 offset:512
    v_mfma_f32_32x32x16_bf16 v[48:63], v[36:39], a[84:87], v[48:63]
    v_mul_f32 v82, v82, v66
    v_mul_f32 v83, v83, v67
    v_exp_f32 v90, v90
    v_mul_f32 v84, v84, v68
    ds_read_b64_tr_b16 v[36:37], v3 offset:2048
    ds_read_b64_tr_b16 v[38:39], v3 offset:2560
    s_waitcnt lgkmcnt(4)
    v_mfma_f32_32x32x16_bf16 v[48:63], v[40:43], a[88:91], v[48:63]
    v_exp_f32 v91, v91
    v_mul_f32 v85, v85, v69
    v_mul_f32 v86, v86, v70
    ds_read_b64_tr_b16 v[40:41], v3 offset:4096
    ds_read_b64_tr_b16 v[42:43], v3 offset:4608
    v_mfma_f32_32x32x16_bf16 v[48:63], v[44:47], a[92:95], v[48:63]
    v_exp_f32 v92, v92
    v_mul_f32 v87, v87, v71
    v_cvt_pk_bf16_f32 v64, v80, v81
    v_exp_f32 v93, v93
    ds_read_b64_tr_b16 v[44:45], v3 offset:6144
    ds_read_b64_tr_b16 v[46:47], v3 offset:6656
    s_waitcnt lgkmcnt(4)
    v_mfma_f32_32x32x16_bf16 v[48:63], v[32:35], a[96:99], v[48:63]
    v_cvt_pk_bf16_f32 v65, v82, v83
    v_exp_f32 v94, v94
    v_cvt_pk_bf16_f32 v66, v84, v85
    s_waitcnt vmcnt(0)
    v_cmp_ne_u32 vcc, 1, v11
    s_cbranch_vccz L_k1_n_ffn_polled
L_k1_n_ffn_poll:
    s_sleep 8
    global_load_dword v11, v12, s[64:65] offset:128 sc1
    s_waitcnt vmcnt(0)
    v_cmp_ne_u32 vcc, 1, v11
    s_cbranch_vccnz L_k1_n_ffn_poll
L_k1_n_ffn_polled:
    s_cmp_lg_u32 s33, 5
    s_cbranch_scc1 L_k1_n_ffn_se
    v_mov_b32 v96, 0
    v_mov_b32 v97, 1
    s_mov_b64 exec, 1
    buffer_atomic_add v97, v96, s[16:19], s68 offen sc1
    s_mov_b64 exec, -1
L_k1_n_ffn_se:
    buffer_load_dwordx4 v[16:19], v13, s[16:19], s40 offen sc1
    ds_read_b64_tr_b16 v[32:33], v3 offset:8192
    ds_read_b64_tr_b16 v[34:35], v3 offset:8704
    v_add_u32 v2, s32, v2
    v_mfma_f32_32x32x16_bf16 v[48:63], v[36:39], a[100:103], v[48:63]
    v_cvt_pk_bf16_f32 v67, v86, v87
    v_exp_f32 v95, v95
    buffer_store_dwordx4 v[64:67], v7, s[16:19], s41 offen offset:0 sc1
    ds_read_b64_tr_b16 v[36:37], v3 offset:10240
    ds_read_b64_tr_b16 v[38:39], v3 offset:10752
    s_waitcnt lgkmcnt(4)
    v_mfma_f32_32x32x16_bf16 v[48:63], v[40:43], a[104:107], v[48:63]
    v_fma_f32 v88, v88, v26, v26
    v_fma_f32 v89, v89, v26, v26
    v_fma_f32 v90, v90, v26, v26
    v_fma_f32 v91, v91, v26, v26
    v_fma_f32 v92, v92, v26, v26
    buffer_load_dword v105, v104, s[80:83], s55 offen
    s_add_u32 s55, s55, 360448
    ds_read_b64_tr_b16 v[40:41], v3 offset:12288
    ds_read_b64_tr_b16 v[42:43], v3 offset:12800
    v_mfma_f32_32x32x16_bf16 v[48:63], v[44:47], a[108:111], v[48:63]
    v_fma_f32 v93, v93, v26, v26
    v_fma_f32 v94, v94, v26, v26
    v_fma_f32 v95, v95, v26, v26
    v_rcp_f32 v88, v88
    ds_read_b64_tr_b16 v[44:45], v3 offset:14336
    ds_read_b64_tr_b16 v[46:47], v3 offset:14848
    s_waitcnt lgkmcnt(4)
    v_mfma_f32_32x32x16_bf16 v[48:63], v[32:35], a[112:115], v[48:63]
    v_rcp_f32 v89, v89
    v_rcp_f32 v90, v90
    ds_read_b64_tr_b16 v[32:33], v3 offset:16384
    ds_read_b64_tr_b16 v[34:35], v3 offset:16896
    v_mfma_f32_32x32x16_bf16 v[48:63], v[36:39], a[116:119], v[48:63]
    v_rcp_f32 v91, v91
    v_rcp_f32 v92, v92
    v_rcp_f32 v93, v93
    ds_read_b64_tr_b16 v[36:37], v3 offset:18432
    ds_read_b64_tr_b16 v[38:39], v3 offset:18944
    s_waitcnt lgkmcnt(4)
    v_mfma_f32_32x32x16_bf16 v[48:63], v[40:43], a[120:123], v[48:63]
    v_rcp_f32 v94, v94
    v_rcp_f32 v95, v95
    ds_read_b64_tr_b16 v[40:41], v3 offset:20480
    ds_read_b64_tr_b16 v[42:43], v3 offset:20992
    v_mfma_f32_32x32x16_bf16 v[48:63], v[44:47], a[124:127], v[48:63]
    s_nop 0
    v_mul_f32 v88, v88, v72
    v_mul_f32 v89, v89, v73
    v_mul_f32 v90, v90, v74
    v_mul_f32 v91, v91, v75
    ds_read_b64_tr_b16 v[44:45], v3 offset:22528
    ds_read_b64_tr_b16 v[46:47], v3 offset:23040
    s_waitcnt lgkmcnt(4)
    v_mfma_f32_32x32x16_bf16 v[48:63], v[32:35], v[112:115], v[48:63]
    v_mul_f32 v92, v92, v76
    v_mul_f32 v93, v93, v77
    v_mul_f32 v94, v94, v78
    v_mul_f32 v95, v95, v79
    s_waitcnt vmcnt(4) lgkmcnt(0)
    s_barrier
    ds_read_b64_tr_b16 v[32:33], v1 offset:0
    ds_read_b64_tr_b16 v[34:35], v1 offset:512
    s_add_u32 m0, s30, 0
    s_add_u32 s37, s27, s29
    buffer_load_dwordx4 v4, s[8:11], s37 offen offset:0 lds
    v_mfma_f32_32x32x16_bf16 v[48:63], v[36:39], v[116:119], v[48:63]
    v_cvt_pk_bf16_f32 v72, v88, v89
    v_cvt_pk_bf16_f32 v73, v90, v91
    v_cvt_pk_bf16_f32 v74, v92, v93
    v_cvt_pk_bf16_f32 v75, v94, v95
    buffer_store_dwordx4 v[72:75], v7, s[16:19], s41 offen offset:512 sc1
    ds_read_b64_tr_b16 v[36:37], v1 offset:2048
    ds_read_b64_tr_b16 v[38:39], v1 offset:2560
    buffer_load_dwordx4 v5, s[8:11], s37 offen offset:1024 lds
    v_add_u32 v3, s32, v3
    s_waitcnt lgkmcnt(4)
    v_mfma_f32_32x32x16_bf16 v[48:63], v[40:43], v[120:123], v[48:63]
    ds_read_b64_tr_b16 v[40:41], v1 offset:4096
    ds_read_b64_tr_b16 v[42:43], v1 offset:4608
    buffer_load_dwordx4 v6, s[8:11], s37 offen offset:2048 lds
    v_mfma_f32_32x32x16_bf16 v[48:63], v[44:47], v[124:127], v[48:63]
    ds_read_b64_tr_b16 v[44:45], v1 offset:6144
    ds_read_b64_tr_b16 v[46:47], v1 offset:6656
    s_sub_u32 s32, 0, s32
    s_waitcnt vmcnt(6)
    v_mfma_f32_32x32x16_bf16 v[64:79], v[16:19], v[20:23], v[48:63]
    s_sub_u32 s49, s49, 1
    s_cmp_lg_u32 s49, 0
    s_cbranch_scc1 L_k1_floop
    s_mov_b32 s43, s44
    s_nop 15
    s_waitcnt vmcnt(0) lgkmcnt(0)
    s_lshl_b32 s41, s43, 11
    s_add_u32 s41, s41, s52
    v_mul_f32 v80, v64, v64
    v_mul_f32 v81, v65, v65
    v_mul_f32 v82, v66, v66
    v_mul_f32 v83, v67, v67
    v_mul_f32 v84, v68, v68
    v_mul_f32 v85, v69, v69
    v_mul_f32 v86, v70, v70
    v_mul_f32 v87, v71, v71
    v_fma_f32 v80, v80, v25, v24
    v_fma_f32 v81, v81, v25, v24
    v_fma_f32 v82, v82, v25, v24
    v_fma_f32 v83, v83, v25, v24
    v_fma_f32 v84, v84, v25, v24
    v_fma_f32 v85, v85, v25, v24
    v_fma_f32 v86, v86, v25, v24
    v_fma_f32 v87, v87, v25, v24
    v_mul_f32 v80, v80, v64
    v_mul_f32 v81, v81, v65
    v_mul_f32 v82, v82, v66
    v_mul_f32 v83, v83, v67
    v_mul_f32 v84, v84, v68
    v_mul_f32 v85, v85, v69
    v_mul_f32 v86, v86, v70
    v_mul_f32 v87, v87, v71
    v_exp_f32 v80, v80
    v_mul_f32 v88, v72, v72
    v_mul_f32 v89, v73, v73
    v_exp_f32 v81, v81
    v_mul_f32 v90, v74, v74
    v_exp_f32 v82, v82
    v_mul_f32 v91, v75, v75
    v_mul_f32 v92, v76, v76
    v_exp_f32 v83, v83
    v_mul_f32 v93, v77, v77
    v_exp_f32 v84, v84
    v_mul_f32 v94, v78, v78
    v_mul_f32 v95, v79, v79
    v_exp_f32 v85, v85
    v_fma_f32 v88, v88, v25, v24
    v_exp_f32 v86, v86
    v_fma_f32 v89, v89, v25, v24
    v_fma_f32 v90, v90, v25, v24
    v_exp_f32 v87, v87
    v_fma_f32 v91, v91, v25, v24
    v_fma_f32 v80, v80, v26, v26
    v_fma_f32 v81, v81, v26, v26
    v_fma_f32 v82, v82, v26, v26
    v_fma_f32 v83, v83, v26, v26
    v_fma_f32 v84, v84, v26, v26
    v_fma_f32 v85, v85, v26, v26
    v_fma_f32 v86, v86, v26, v26
    v_fma_f32 v87, v87, v26, v26
    v_rcp_f32 v80, v80
    v_fma_f32 v92, v92, v25, v24
    v_fma_f32 v93, v93, v25, v24
    v_rcp_f32 v81, v81
    v_fma_f32 v94, v94, v25, v24
    v_rcp_f32 v82, v82
    v_fma_f32 v95, v95, v25, v24
    v_mul_f32 v88, v88, v72
    v_rcp_f32 v83, v83
    v_mul_f32 v89, v89, v73
    v_rcp_f32 v84, v84
    v_mul_f32 v90, v90, v74
    v_mul_f32 v91, v91, v75
    v_rcp_f32 v85, v85
    v_mul_f32 v92, v92, v76
    v_rcp_f32 v86, v86
    v_mul_f32 v93, v93, v77
    v_mul_f32 v94, v94, v78
    v_rcp_f32 v87, v87
    v_mul_f32 v95, v95, v79
    v_exp_f32 v88, v88
    v_mul_f32 v80, v80, v64
    v_mul_f32 v81, v81, v65
    v_exp_f32 v89, v89
    v_mul_f32 v82, v82, v66
    v_mul_f32 v83, v83, v67
    v_exp_f32 v90, v90
    v_mul_f32 v84, v84, v68
    v_exp_f32 v91, v91
    v_mul_f32 v85, v85, v69
    v_mul_f32 v86, v86, v70
    v_exp_f32 v92, v92
    v_mul_f32 v87, v87, v71
    v_cvt_pk_bf16_f32 v64, v80, v81
    v_exp_f32 v93, v93
    v_cvt_pk_bf16_f32 v65, v82, v83
    v_exp_f32 v94, v94
    v_cvt_pk_bf16_f32 v66, v84, v85
    v_cvt_pk_bf16_f32 v67, v86, v87
    v_exp_f32 v95, v95
    buffer_store_dwordx4 v[64:67], v7, s[16:19], s41 offen offset:0 sc1
    v_fma_f32 v88, v88, v26, v26
    v_fma_f32 v89, v89, v26, v26
    v_fma_f32 v90, v90, v26, v26
    v_fma_f32 v91, v91, v26, v26
    v_fma_f32 v92, v92, v26, v26
    v_fma_f32 v93, v93, v26, v26
    v_fma_f32 v94, v94, v26, v26
    v_fma_f32 v95, v95, v26, v26
    v_rcp_f32 v88, v88
    v_rcp_f32 v89, v89
    v_rcp_f32 v90, v90
    v_rcp_f32 v91, v91
    v_rcp_f32 v92, v92
    v_rcp_f32 v93, v93
    v_rcp_f32 v94, v94
    v_rcp_f32 v95, v95
    s_nop 0
    v_mul_f32 v88, v88, v72
    v_mul_f32 v89, v89, v73
    v_mul_f32 v90, v90, v74
    v_mul_f32 v91, v91, v75
    v_mul_f32 v92, v92, v76
    v_mul_f32 v93, v93, v77
    v_mul_f32 v94, v94, v78
    v_mul_f32 v95, v95, v79
    v_cvt_pk_bf16_f32 v72, v88, v89
    v_cvt_pk_bf16_f32 v73, v90, v91
    v_cvt_pk_bf16_f32 v74, v92, v93
    v_cvt_pk_bf16_f32 v75, v94, v95
    buffer_store_dwordx4 v[72:75], v7, s[16:19], s41 offen offset:512 sc1
L_k1_fin:
    s_mov_b32 s80, s69
    s_mov_b32 s81, s68
    s_mov_b32 s28, s20
    s_load_dwordx2 s[62:63], s[0:1], 80
    s_load_dwordx2 s[64:65], s[0:1], 0
    s_load_dwordx2 s[66:67], s[0:1], 16
    s_load_dwordx4 s[68:71], s[0:1], 48
    s_load_dwordx2 s[72:73], s[0:1], 64
    v_mov_b32 v29, 147456
    v_mov_b32 v30, 0
    v_mov_b32 v31, 1
    ds_write_b32 v29, v30
    s_and_b32 s31, s2, 3
    s_bfe_u32 s32, s2, 0x10002
    s_bfe_u32 s30, s2, 0x20003
    s_lshr_b32 s29, s2, 5
    s_lshl_b32 s32, s32, 3
    s_add_u32 s29, s29, s32
    s_mov_b32 s6, 5308416
    s_mov_b32 s7, 0x00020000
    s_mov_b32 s10, 663552
    s_mov_b32 s11, 0x00020000
    s_mov_b32 s14, 47647744
    s_mov_b32 s15, 0x00020000
    s_mov_b32 s18, 2359296
    s_mov_b32 s19, 0x00020000
    s_mov_b32 s22, 1152
    s_mov_b32 s23, 0x00020000
    s_mov_b32 s26, 2359296
    s_mov_b32 s27, 0x00020000
    s_lshl_b32 s33, s29, 2
    s_add_u32 s55, s33, s31
    s_lshl_b32 s55, s55, 7
    s_add_u32 s55, s55, 47549440
    s_waitcnt vmcnt(0) lgkmcnt(0)
    s_barrier
    s_mov_b32 s12, s62
    s_mov_b32 s13, s63
    s_mov_b32 s16, s64
    s_mov_b32 s17, s65
    s_mov_b32 s8, s66
    s_mov_b32 s9, s67
    s_mov_b32 s4, s68
    s_mov_b32 s5, s69
    s_mov_b32 s20, s70
    s_mov_b32 s21, s71
    s_mov_b32 s24, s72
    s_mov_b32 s25, s73
    s_cmp_ge_u32 s28, 4
    s_cbranch_scc1 L_k2_att
    v_mov_b32 v25, 0
    buffer_load_dword a127, v25, s[12:15], s81 offen offset:0 sc1
    s_mul_i32 s39, s28, 9216
    s_mul_i32 s58, s30, 288
    s_mul_i32 s35, s31, 1327104
    s_add_u32 s35, s35, s58
    s_mul_i32 s32, s28, 36864
    s_add_u32 s35, s35, s32
    s_movk_i32 s33, 3641
    s_movk_i32 s34, 1152
    v_add_u32 v25, 0, v0
    v_mul_u32_u24 v26, s33, v25
    v_lshrrev_b32 v10, 16, v26
    v_mul_u32_u24 v26, 18, v10
    v_sub_u32 v26, v25, v26
    v_lshlrev_b32 v26, 4, v26
    v_mad_u32_u24 v1, v10, s34, v26
    v_add_u32 v25, 64, v0
    v_mul_u32_u24 v26, s33, v25
    v_lshrrev_b32 v11, 16, v26
    v_mul_u32_u24 v26, 18, v11
    v_sub_u32 v26, v25, v26
    v_lshlrev_b32 v26, 4, v26
    v_mad_u32_u24 v2, v11, s34, v26
    v_subrev_u32 v2, 1024, v2
    v_add_u32 v25, 128, v0
    v_mul_u32_u24 v26, s33, v25
    v_lshrrev_b32 v12, 16, v26
    v_mul_u32_u24 v26, 18, v12
    v_sub_u32 v26, v25, v26
    v_lshlrev_b32 v26, 4, v26
    v_mad_u32_u24 v3, v12, s34, v26
    v_subrev_u32 v3, 2048, v3
    v_add_u32 v25, 192, v0
    v_mul_u32_u24 v26, s33, v25
    v_lshrrev_b32 v13, 16, v26
    v_mul_u32_u24 v26, 18, v13
    v_sub_u32 v26, v25, v26
    v_lshlrev_b32 v26, 4, v26
    v_mad_u32_u24 v4, v13, s34, v26
    v_subrev_u32 v4, 3072, v4
    v_add_u32 v25, 256, v0
    v_mul_u32_u24 v26, s33, v25
    v_lshrrev_b32 v14, 16, v26
    v_mul_u32_u24 v26, 18, v14
    v_sub_u32 v26, v25, v26
    v_lshlrev_b32 v26, 4, v26
    v_mad_u32_u24 v5, v14, s34, v26
    v_add_u32 v25, 320, v0
    v_mul_u32_u24 v26, s33, v25
    v_lshrrev_b32 v15, 16, v26
    v_mul_u32_u24 v26, 18, v15
    v_sub_u32 v26, v25, v26
    v_lshlrev_b32 v26, 4, v26
    v_mad_u32_u24 v6, v15, s34, v26
    v_subrev_u32 v6, 1024, v6
    v_add_u32 v25, 384, v0
    v_mul_u32_u24 v26, s33, v25
    v_lshrrev_b32 v16, 16, v26
    v_mul_u32_u24 v26, 18, v16
    v_sub_u32 v26, v25, v26
    v_lshlrev_b32 v26, 4, v26
    v_mad_u32_u24 v7, v16, s34, v26
    v_subrev_u32 v7, 2048, v7
    v_add_u32 v25, 448, v0
    v_mul_u32_u24 v26, s33, v25
    v_lshrrev_b32 v17, 16, v26
    v_mul_u32_u24 v26, 18, v17
    v_sub_u32 v26, v25, v26
    v_lshlrev_b32 v26, 4, v26
    v_mad_u32_u24 v8, v17, s34, v26
    v_subrev_u32 v8, 3072, v8
    v_add_u32 v25, 512, v0
    v_mul_u32_u24 v26, s33, v25
    v_lshrrev_b32 v18, 16, v26
    v_mul_u32_u24 v26, 18, v18
    v_sub_u32 v26, v25, v26
    v_lshlrev_b32 v26, 4, v26
    v_mad_u32_u24 v9, v18, s34, v26
    s_lshl_b32 s32, s29, 3
    s_lshl_b32 s33, s28, 1
    s_add_u32 s41, s32, s33
    s_mul_i32 s37, s41, 147456
    s_mul_i32 s33, s31, 36864
    s_add_u32 s37, s37, s33
    s_add_u32 s37, s37, 7077888
    v_lshlrev_b32 v23, 4, v0
    v_add_u32 v24, 147456, v23
    s_add_u32 s54, s35, 0
    s_add_u32 m0, s39, 0
    s_nop 0
    buffer_load_dwordx4 v1, s[4:7], s54 offen offset:0 lds
    buffer_load_dwordx4 v2, s[4:7], s54 offen offset:1024 lds
    buffer_load_dwordx4 v3, s[4:7], s54 offen offset:2048 lds
    buffer_load_dwordx4 v4, s[4:7], s54 offen offset:3072 lds
    s_add_u32 m0, s39, 4096
    s_nop 0
    buffer_load_dwordx4 v5, s[4:7], s54 offen offset:0 lds
    buffer_load_dwordx4 v6, s[4:7], s54 offen offset:1024 lds
    buffer_load_dwordx4 v7, s[4:7], s54 offen offset:2048 lds
    buffer_load_dwordx4 v8, s[4:7], s54 offen offset:3072 lds
    s_add_u32 m0, s39, 8192
    s_nop 0
    buffer_load_dwordx4 v9, s[4:7], s54 offen offset:0 lds
    s_waitcnt vmcnt(9)
    v_accvgpr_read_b32 v26, a127
    v_mov_b32 v25, 0
    v_cmp_ne_u32 vcc, 24, v26
    s_cbranch_vccz L_k2_he_ok
L_k2_he:
    s_sleep 2
    buffer_load_dword v26, v25, s[12:15], s81 offen sc1
    s_waitcnt vmcnt(0)
    v_cmp_ne_u32 vcc, 24, v26
    s_cbranch_vccnz L_k2_he
L_k2_he_ok:
    s_add_u32 s81, s81, 24576
    s_add_u32 s32, s37, 0
    buffer_load_dwordx4 a[0:3], v23, s[12:15], s32 offen sc1
    buffer_load_dwordx4 a[4:7], v24, s[12:15], s32 offen sc1
    s_add_u32 s32, s37, 1024
    buffer_load_dwordx4 a[8:11], v23, s[12:15], s32 offen sc1
    buffer_load_dwordx4 a[12:15], v24, s[12:15], s32 offen sc1
    s_add_u32 s32, s37, 2048
    buffer_load_dwordx4 a[16:19], v23, s[12:15], s32 offen sc1
    buffer_load_dwordx4 a[20:23], v24, s[12:15], s32 offen sc1
    s_add_u32 s32, s37, 3072
    buffer_load_dwordx4 a[24:27], v23, s[12:15], s32 offen sc1
    buffer_load_dwordx4 a[28:31], v24, s[12:15], s32 offen sc1
    s_movk_i32 s34, 2304
    v_lshrrev_b32 v25, 4, v10
    v_mad_u32_u24 v10, v25, s34, v1
    v_lshrrev_b32 v25, 4, v11
    v_mad_u32_u24 v11, v25, s34, v2
    v_lshrrev_b32 v25, 4, v12
    v_mad_u32_u24 v12, v25, s34, v3
    v_lshrrev_b32 v25, 4, v13
    v_mad_u32_u24 v13, v25, s34, v4
    v_lshrrev_b32 v25, 4, v14
    v_mad_u32_u24 v14, v25, s34, v5
    v_lshrrev_b32 v25, 4, v15
    v_mad_u32_u24 v15, v25, s34, v6
    v_lshrrev_b32 v25, 4, v16
    v_mad_u32_u24 v16, v25, s34, v7
    v_lshrrev_b32 v25, 4, v17
    v_mad_u32_u24 v17, v25, s34, v8
    v_lshrrev_b32 v25, 4, v18
    v_mad_u32_u24 v18, v25, s34, v9
    s_mul_i32 s36, s31, 165888
    s_add_u32 s36, s36, s58
    s_mul_i32 s33, s28, 41472
    s_add_u32 s36, s36, s33
    s_mul_i32 s38, s41, 20480
    s_mul_i32 s33, s31, 5120
    s_add_u32 s38, s38, s33
    s_add_u32 s38, s38, 25952256
    s_mul_i32 s57, s41, 18432
    s_add_u32 s57, s57, s58
    v_bfe_u32 v25, v0, 5, 1
    v_bfe_u32 v26, v0, 4, 1
    v_bfe_u32 v27, v0, 2, 2
    v_lshl_add_u32 v27, v26, 2, v27
    v_lshl_add_u32 v27, v25, 4, v27
    v_and_b32 v25, 3, v0
    v_lshlrev_b32 v25, 3, v25
    s_movk_i32 s33, 288
    v_mad_u32_u24 v19, v27, s33, v25
    v_add_u32 v20, 36864, v19
    v_add_u32 v21, 73728, v19
    v_add_u32 v22, 110592, v19
    v_and_b32 v25, 15, v0
    v_lshrrev_b32 v127, 4, v0
    v_lshlrev_b32 v127, 3, v127
    s_movk_i32 s33, 1152
    v_mad_u32_u24 v126, v25, s33, v127
    s_lshl_b32 s33, s29, 2
    s_add_u32 s33, s33, s30
    s_lshl_b32 s33, s33, 2
    s_add_u32 s33, s33, s28
    s_lshl_b32 s56, s33, 7
    s_add_u32 s56, s56, 47557632
    s_mul_i32 s40, s33, 36864
    s_add_u32 s40, s40, 28573696
    s_waitcnt vmcnt(8)
    s_mov_b64 exec, 1
    ds_add_u32 v29, v31
    s_mov_b64 exec, -1
    ds_read_b32 v30, v29
    s_waitcnt lgkmcnt(0)
    v_cmp_gt_u32 vcc, 4, v30
    s_cbranch_vccz L_k2_c0_ok
L_k2_c0:
    ds_read_b32 v30, v29
    s_waitcnt lgkmcnt(0)
    v_cmp_gt_u32 vcc, 4, v30
    s_cbranch_vccnz L_k2_c0
L_k2_c0_ok:
    ds_read_b64_tr_b16 v[32:33], v19 offset:0
    ds_read_b64_tr_b16 v[34:35], v19 offset:2304
    ds_read_b64_tr_b16 v[36:37], v19 offset:32
    ds_read_b64_tr_b16 v[38:39], v19 offset:2336
    ds_read_b64_tr_b16 v[40:41], v19 offset:64
    ds_read_b64_tr_b16 v[42:43], v19 offset:2368
    ds_read_b64_tr_b16 v[44:45], v19 offset:96
    ds_read_b64_tr_b16 v[46:47], v19 offset:2400
    s_waitcnt vmcnt(6) lgkmcnt(6)
    v_mfma_f32_16x16x32_bf16 v[52:55], v[32:35], a[0:3], 0
    ds_read_b64_tr_b16 v[48:49], v19 offset:128
    v_mfma_f32_16x16x32_bf16 v[88:91], v[32:35], a[4:7], 0
    ds_read_b64_tr_b16 v[50:51], v19 offset:2432
    s_add_u32 s54, s35, 147456
    s_add_u32 m0, s39, 36864
    s_nop 0
    buffer_load_dwordx4 v1, s[4:7], s54 offen offset:0 lds
    s_add_u32 s32, s37, 4096
    buffer_load_dwordx4 a[32:35], v23, s[12:15], s32 offen sc1
    buffer_load_dwordx4 a[36:39], v24, s[12:15], s32 offen sc1
    s_waitcnt lgkmcnt(6)
    v_mfma_f32_16x16x32_bf16 v[56:59], v[36:39], a[0:3], 0
    ds_read_b64_tr_b16 v[32:33], v19 offset:160
    v_mfma_f32_16x16x32_bf16 v[92:95], v[36:39], a[4:7], 0
    ds_read_b64_tr_b16 v[34:35], v19 offset:2464
    buffer_load_dwordx4 v2, s[4:7], s54 offen offset:1024 lds
    s_waitcnt lgkmcnt(6)
    v_mfma_f32_16x16x32_bf16 v[60:63], v[40:43], a[0:3], 0
    ds_read_b64_tr_b16 v[36:37], v19 offset:192
    v_mfma_f32_16x16x32_bf16 v[96:99], v[40:43], a[4:7], 0
    ds_read_b64_tr_b16 v[38:39], v19 offset:2496
    buffer_load_dwordx4 v3, s[4:7], s54 offen offset:2048 lds
    s_add_u32 s32, s37, 5120
    buffer_load_dwordx4 a[40:43], v23, s[12:15], s32 offen sc1
    buffer_load_dwordx4 a[44:47], v24, s[12:15], s32 offen sc1
    s_waitcnt lgkmcnt(6)
    v_mfma_f32_16x16x32_bf16 v[64:67], v[44:47], a[0:3], 0
    ds_read_b64_tr_b16 v[40:41], v19 offset:224
    v_mfma_f32_16x16x32_bf16 v[100:103], v[44:47], a[4:7], 0
    ds_read_b64_tr_b16 v[42:43], v19 offset:2528
    buffer_load_dwordx4 v4, s[4:7], s54 offen offset:3072 lds
    s_waitcnt lgkmcnt(6)
    v_mfma_f32_16x16x32_bf16 v[68:71], v[48:51], a[0:3], 0
    ds_read_b64_tr_b16 v[44:45], v19 offset:256
    v_mfma_f32_16x16x32_bf16 v[104:107], v[48:51], a[4:7], 0
    ds_read_b64_tr_b16 v[46:47], v19 offset:2560
    s_add_u32 m0, s39, 40960
    s_nop 0
    buffer_load_dwordx4 v5, s[4:7], s54 offen offset:0 lds
    s_add_u32 s32, s37, 6144
    buffer_load_dwordx4 a[48:51], v23, s[12:15], s32 offen sc1
    buffer_load_dwordx4 a[52:55], v24, s[12:15], s32 offen sc1
    s_waitcnt lgkmcnt(6)
    v_mfma_f32_16x16x32_bf16 v[72:75], v[32:35], a[0:3], 0
    ds_read_b64_tr_b16 v[48:49], v19 offset:9216
    v_mfma_f32_16x16x32_bf16 v[108:111], v[32:35], a[4:7], 0
    ds_read_b64_tr_b16 v[50:51], v19 offset:11520
    buffer_load_dwordx4 v6, s[4:7], s54 offen offset:1024 lds
    s_waitcnt lgkmcnt(6)
    v_mfma_f32_16x16x32_bf16 v[76:79], v[36:39], a[0:3], 0
    ds_read_b64_tr_b16 v[32:33], v19 offset:9248
    v_mfma_f32_16x16x32_bf16 v[112:115], v[36:39], a[4:7], 0
    ds_read_b64_tr_b16 v[34:35], v19 offset:11552
    buffer_load_dwordx4 v7, s[4:7], s54 offen offset:2048 lds
    s_add_u32 s32, s37, 7168
    buffer_load_dwordx4 a[56:59], v23, s[12:15], s32 offen sc1
    buffer_load_dwordx4 a[60:63], v24, s[12:15], s32 offen sc1
    s_waitcnt lgkmcnt(6)
    v_mfma_f32_16x16x32_bf16 v[80:83], v[40:43], a[0:3], 0
    ds_read_b64_tr_b16 v[36:37], v19 offset:9280
    v_mfma_f32_16x16x32_bf16 v[116:119], v[40:43], a[4:7], 0
    ds_read_b64_tr_b16 v[38:39], v19 offset:11584
    buffer_load_dwordx4 v8, s[4:7], s54 offen offset:3072 lds
    s_waitcnt lgkmcnt(6)
    v_mfma_f32_16x16x32_bf16 v[84:87], v[44:47], a[0:3], 0
    ds_read_b64_tr_b16 v[40:41], v19 offset:9312
    v_mfma_f32_16x16x32_bf16 v[120:123], v[44:47], a[4:7], 0
    ds_read_b64_tr_b16 v[42:43], v19 offset:11616
    s_add_u32 m0, s39, 45056
    s_nop 0
    buffer_load_dwordx4 v9, s[4:7], s54 offen offset:0 lds
    s_add_u32 s32, s37, 16384
    buffer_load_dwordx4 a[0:3], v23, s[12:15], s32 offen sc1
    buffer_load_dwordx4 a[4:7], v24, s[12:15], s32 offen sc1
    s_waitcnt vmcnt(23) lgkmcnt(6)
    v_mfma_f32_16x16x32_bf16 v[52:55], v[48:51], a[8:11], v[52:55]
    ds_read_b64_tr_b16 v[44:45], v19 offset:9344
    v_mfma_f32_16x16x32_bf16 v[88:91], v[48:51], a[12:15], v[88:91]
    ds_read_b64_tr_b16 v[46:47], v19 offset:11648
    s_add_u32 s54, s35, 442368
    s_add_u32 m0, s39, 73728
    s_nop 0
    buffer_load_dwordx4 v1, s[4:7], s54 offen offset:0 lds
    s_add_u32 s32, s37, 12288
    buffer_load_dwordx4 a[64:67], v23, s[12:15], s32 offen sc1
    buffer_load_dwordx4 a[68:71], v24, s[12:15], s32 offen sc1
    s_waitcnt lgkmcnt(6)
    v_mfma_f32_16x16x32_bf16 v[56:59], v[32:35], a[8:11], v[56:59]
    ds_read_b64_tr_b16 v[48:49], v19 offset:9376
    v_mfma_f32_16x16x32_bf16 v[92:95], v[32:35], a[12:15], v[92:95]
    ds_read_b64_tr_b16 v[50:51], v19 offset:11680
    buffer_load_dwordx4 v2, s[4:7], s54 offen offset:1024 lds
    s_waitcnt lgkmcnt(6)
    v_mfma_f32_16x16x32_bf16 v[60:63], v[36:39], a[8:11], v[60:63]
    ds_read_b64_tr_b16 v[32:33], v19 offset:9408
    v_mfma_f32_16x16x32_bf16 v[96:99], v[36:39], a[12:15], v[96:99]
    ds_read_b64_tr_b16 v[34:35], v19 offset:11712
    buffer_load_dwordx4 v3, s[4:7], s54 offen offset:2048 lds
    s_add_u32 s32, s37, 13312
    buffer_load_dwordx4 a[72:75], v23, s[12:15], s32 offen sc1
    buffer_load_dwordx4 a[76:79], v24, s[12:15], s32 offen sc1
    s_waitcnt lgkmcnt(6)
    v_mfma_f32_16x16x32_bf16 v[64:67], v[40:43], a[8:11], v[64:67]
    ds_read_b64_tr_b16 v[36:37], v19 offset:9440
    v_mfma_f32_16x16x32_bf16 v[100:103], v[40:43], a[12:15], v[100:103]
    ds_read_b64_tr_b16 v[38:39], v19 offset:11744
    buffer_load_dwordx4 v4, s[4:7], s54 offen offset:3072 lds
    s_waitcnt lgkmcnt(6)
    v_mfma_f32_16x16x32_bf16 v[68:71], v[44:47], a[8:11], v[68:71]
    ds_read_b64_tr_b16 v[40:41], v19 offset:9472
    v_mfma_f32_16x16x32_bf16 v[104:107], v[44:47], a[12:15], v[104:107]
    ds_read_b64_tr_b16 v[42:43], v19 offset:11776
    s_add_u32 m0, s39, 77824
    s_nop 0
    buffer_load_dwordx4 v5, s[4:7], s54 offen offset:0 lds
    s_add_u32 s32, s37, 14336
    buffer_load_dwordx4 a[80:83], v23, s[12:15], s32 offen sc1
    buffer_load_dwordx4 a[84:87], v24, s[12:15], s32 offen sc1
    s_waitcnt lgkmcnt(6)
    v_mfma_f32_16x16x32_bf16 v[72:75], v[48:51], a[8:11], v[72:75]
    ds_read_b64_tr_b16 v[44:45], v19 offset:18432
    v_mfma_f32_16x16x32_bf16 v[108:111], v[48:51], a[12:15], v[108:111]
    ds_read_b64_tr_b16 v[46:47], v19 offset:20736
    buffer_load_dwordx4 v6, s[4:7], s54 offen offset:1024 lds
    s_waitcnt lgkmcnt(6)
    v_mfma_f32_16x16x32_bf16 v[76:79], v[32:35], a[8:11], v[76:79]
    ds_read_b64_tr_b16 v[48:49], v19 offset:18464
    v_mfma_f32_16x16x32_bf16 v[112:115], v[32:35], a[12:15], v[112:115]
    ds_read_b64_tr_b16 v[50:51], v19 offset:20768
    buffer_load_dwordx4 v7, s[4:7], s54 offen offset:2048 lds
    s_add_u32 s32, s37, 15360
    buffer_load_dwordx4 a[88:91], v23, s[12:15], s32 offen sc1
    buffer_load_dwordx4 a[92:95], v24, s[12:15], s32 offen sc1
    s_waitcnt lgkmcnt(6)
    v_mfma_f32_16x16x32_bf16 v[80:83], v[36:39], a[8:11], v[80:83]
    ds_read_b64_tr_b16 v[32:33], v19 offset:18496
    v_mfma_f32_16x16x32_bf16 v[116:119], v[36:39], a[12:15], v[116:119]
    ds_read_b64_tr_b16 v[34:35], v19 offset:20800
    buffer_load_dwordx4 v8, s[4:7], s54 offen offset:3072 lds
    s_waitcnt lgkmcnt(6)
    v_mfma_f32_16x16x32_bf16 v[84:87], v[40:43], a[8:11], v[84:87]
    ds_read_b64_tr_b16 v[36:37], v19 offset:18528
    v_mfma_f32_16x16x32_bf16 v[120:123], v[40:43], a[12:15], v[120:123]
    ds_read_b64_tr_b16 v[38:39], v19 offset:20832
    s_add_u32 m0, s39, 81920
    s_nop 0
    buffer_load_dwordx4 v9, s[4:7], s54 offen offset:0 lds
    s_add_u32 s32, s37, 17408
    buffer_load_dwordx4 a[8:11], v23, s[12:15], s32 offen sc1
    buffer_load_dwordx4 a[12:15], v24, s[12:15], s32 offen sc1
    s_waitcnt vmcnt(40) lgkmcnt(6)
    v_mfma_f32_16x16x32_bf16 v[52:55], v[44:47], a[16:19], v[52:55]
    ds_read_b64_tr_b16 v[40:41], v19 offset:18560
    v_mfma_f32_16x16x32_bf16 v[88:91], v[44:47], a[20:23], v[88:91]
    ds_read_b64_tr_b16 v[42:43], v19 offset:20864
    s_waitcnt lgkmcnt(6)
    v_mfma_f32_16x16x32_bf16 v[56:59], v[48:51], a[16:19], v[56:59]
    ds_read_b64_tr_b16 v[44:45], v19 offset:18592
    v_mfma_f32_16x16x32_bf16 v[92:95], v[48:51], a[20:23], v[92:95]
    ds_read_b64_tr_b16 v[46:47], v19 offset:20896
    s_waitcnt lgkmcnt(6)
    v_mfma_f32_16x16x32_bf16 v[60:63], v[32:35], a[16:19], v[60:63]
    ds_read_b64_tr_b16 v[48:49], v19 offset:18624
    v_mfma_f32_16x16x32_bf16 v[96:99], v[32:35], a[20:23], v[96:99]
    ds_read_b64_tr_b16 v[50:51], v19 offset:20928
    s_waitcnt lgkmcnt(6)
    v_mfma_f32_16x16x32_bf16 v[64:67], v[36:39], a[16:19], v[64:67]
    ds_read_b64_tr_b16 v[32:33], v19 offset:18656
    v_mfma_f32_16x16x32_bf16 v[100:103], v[36:39], a[20:23], v[100:103]
    ds_read_b64_tr_b16 v[34:35], v19 offset:20960
    s_waitcnt lgkmcnt(6)
    v_mfma_f32_16x16x32_bf16 v[68:71], v[40:43], a[16:19], v[68:71]
    ds_read_b64_tr_b16 v[36:37], v19 offset:18688
    v_mfma_f32_16x16x32_bf16 v[104:107], v[40:43], a[20:23], v[104:107]
    ds_read_b64_tr_b16 v[38:39], v19 offset:20992
    s_waitcnt vmcnt(21)
    s_mov_b64 exec, 1
    ds_add_u32 v29, v31
    s_mov_b64 exec, -1
    s_waitcnt lgkmcnt(7)
    v_mfma_f32_16x16x32_bf16 v[72:75], v[44:47], a[16:19], v[72:75]
    ds_read_b64_tr_b16 v[40:41], v19 offset:27648
    v_mfma_f32_16x16x32_bf16 v[108:111], v[44:47], a[20:23], v[108:111]
    ds_read_b64_tr_b16 v[42:43], v19 offset:29952
    s_waitcnt lgkmcnt(7)
    v_mfma_f32_16x16x32_bf16 v[76:79], v[48:51], a[16:19], v[76:79]
    ds_read_b64_tr_b16 v[44:45], v19 offset:27680
    v_mfma_f32_16x16x32_bf16 v[112:115], v[48:51], a[20:23], v[112:115]
    ds_read_b64_tr_b16 v[46:47], v19 offset:29984
    s_waitcnt lgkmcnt(7)
    v_mfma_f32_16x16x32_bf16 v[80:83], v[32:35], a[16:19], v[80:83]
    ds_read_b64_tr_b16 v[48:49], v19 offset:27712
    v_mfma_f32_16x16x32_bf16 v[116:119], v[32:35], a[20:23], v[116:119]
    ds_read_b64_tr_b16 v[50:51], v19 offset:30016
    s_waitcnt lgkmcnt(7)
    v_mfma_f32_16x16x32_bf16 v[84:87], v[36:39], a[16:19], v[84:87]
    ds_read_b64_tr_b16 v[32:33], v19 offset:27744
    v_mfma_f32_16x16x32_bf16 v[120:123], v[36:39], a[20:23], v[120:123]
    ds_read_b64_tr_b16 v[34:35], v19 offset:30048
    s_add_u32 s32, s37, 18432
    buffer_load_dwordx4 a[16:19], v23, s[12:15], s32 offen sc1
    buffer_load_dwordx4 a[20:23], v24, s[12:15], s32 offen sc1
    s_waitcnt vmcnt(40) lgkmcnt(6)
    v_mfma_f32_16x16x32_bf16 v[52:55], v[40:43], a[24:27], v[52:55]
    ds_read_b64_tr_b16 v[36:37], v19 offset:27776
    v_mfma_f32_16x16x32_bf16 v[88:91], v[40:43], a[28:31], v[88:91]
    ds_read_b64_tr_b16 v[38:39], v19 offset:30080
    s_waitcnt lgkmcnt(6)
    v_mfma_f32_16x16x32_bf16 v[56:59], v[44:47], a[24:27], v[56:59]
    ds_read_b64_tr_b16 v[40:41], v19 offset:27808
    v_mfma_f32_16x16x32_bf16 v[92:95], v[44:47], a[28:31], v[92:95]
    ds_read_b64_tr_b16 v[42:43], v19 offset:30112
    s_waitcnt lgkmcnt(6)
    v_mfma_f32_16x16x32_bf16 v[60:63], v[48:51], a[24:27], v[60:63]
    ds_read_b64_tr_b16 v[44:45], v19 offset:27840
    v_mfma_f32_16x16x32_bf16 v[96:99], v[48:51], a[28:31], v[96:99]
    ds_read_b64_tr_b16 v[46:47], v19 offset:30144
    ds_read_b32 v30, v29
    s_waitcnt lgkmcnt(7)
    v_mfma_f32_16x16x32_bf16 v[64:67], v[32:35], a[24:27], v[64:67]
    ds_read_b64_tr_b16 v[48:49], v19 offset:27872
    v_mfma_f32_16x16x32_bf16 v[100:103], v[32:35], a[28:31], v[100:103]
    ds_read_b64_tr_b16 v[50:51], v19 offset:30176
    s_waitcnt lgkmcnt(7)
    v_mfma_f32_16x16x32_bf16 v[68:71], v[36:39], a[24:27], v[68:71]
    ds_read_b64_tr_b16 v[32:33], v19 offset:27904
    v_mfma_f32_16x16x32_bf16 v[104:107], v[36:39], a[28:31], v[104:107]
    ds_read_b64_tr_b16 v[34:35], v19 offset:30208
    s_waitcnt lgkmcnt(7)
    v_mfma_f32_16x16x32_bf16 v[72:75], v[40:43], a[24:27], v[72:75]
    s_waitcnt lgkmcnt(4)
    v_cmp_gt_u32 vcc, 8, v30
    s_cbranch_vccz L_k2_c1_ok
L_k2_c1:
    ds_read_b32 v30, v29
    s_waitcnt lgkmcnt(0)
    v_cmp_gt_u32 vcc, 8, v30
    s_cbranch_vccnz L_k2_c1
L_k2_c1_ok:
    ds_read_b64_tr_b16 v[36:37], v20 offset:0
    v_mfma_f32_16x16x32_bf16 v[108:111], v[40:43], a[28:31], v[108:111]
    ds_read_b64_tr_b16 v[38:39], v20 offset:2304
    s_add_u32 s54, s35, 589824
    s_add_u32 m0, s39, 110592
    s_nop 0
    buffer_load_dwordx4 v1, s[4:7], s54 offen offset:0 lds
    s_waitcnt lgkmcnt(7)
    v_mfma_f32_16x16x32_bf16 v[76:79], v[44:47], a[24:27], v[76:79]
    ds_read_b64_tr_b16 v[40:41], v20 offset:32
    v_mfma_f32_16x16x32_bf16 v[112:115], v[44:47], a[28:31], v[112:115]
    ds_read_b64_tr_b16 v[42:43], v20 offset:2336
    buffer_load_dwordx4 v2, s[4:7], s54 offen offset:1024 lds
    s_waitcnt lgkmcnt(6)
    v_mfma_f32_16x16x32_bf16 v[80:83], v[48:51], a[24:27], v[80:83]
    ds_read_b64_tr_b16 v[44:45], v20 offset:64
    v_mfma_f32_16x16x32_bf16 v[116:119], v[48:51], a[28:31], v[116:119]
    ds_read_b64_tr_b16 v[46:47], v20 offset:2368
    buffer_load_dwordx4 v3, s[4:7], s54 offen offset:2048 lds
    s_waitcnt lgkmcnt(6)
    v_mfma_f32_16x16x32_bf16 v[84:87], v[32:35], a[24:27], v[84:87]
    ds_read_b64_tr_b16 v[48:49], v20 offset:96
    v_mfma_f32_16x16x32_bf16 v[120:123], v[32:35], a[28:31], v[120:123]
    ds_read_b64_tr_b16 v[50:51], v20 offset:2400
    buffer_load_dwordx4 v4, s[4:7], s54 offen offset:3072 lds
    s_add_u32 s32, s37, 19456
    buffer_load_dwordx4 a[24:27], v23, s[12:15], s32 offen sc1
    buffer_load_dwordx4 a[28:31], v24, s[12:15], s32 offen sc1
    s_waitcnt vmcnt(43) lgkmcnt(6)
    v_mfma_f32_16x16x32_bf16 v[52:55], v[36:39], a[32:35], v[52:55]
    ds_read_b64_tr_b16 v[32:33], v20 offset:128
    v_mfma_f32_16x16x32_bf16 v[88:91], v[36:39], a[36:39], v[88:91]
    ds_read_b64_tr_b16 v[34:35], v20 offset:2432
    s_add_u32 m0, s39, 114688
    s_nop 0
    buffer_load_dwordx4 v5, s[4:7], s54 offen offset:0 lds
    s_waitcnt lgkmcnt(6)
    v_mfma_f32_16x16x32_bf16 v[56:59], v[40:43], a[32:35], v[56:59]
    ds_read_b64_tr_b16 v[36:37], v20 offset:160
    v_mfma_f32_16x16x32_bf16 v[92:95], v[40:43], a[36:39], v[92:95]
    ds_read_b64_tr_b16 v[38:39], v20 offset:2464
    s_waitcnt lgkmcnt(6)
    v_mfma_f32_16x16x32_bf16 v[60:63], v[44:47], a[32:35], v[60:63]
    ds_read_b64_tr_b16 v[40:41], v20 offset:192
    v_mfma_f32_16x16x32_bf16 v[96:99], v[44:47], a[36:39], v[96:99]
    ds_read_b64_tr_b16 v[42:43], v20 offset:2496
    buffer_load_dwordx4 v6, s[4:7], s54 offen offset:1024 lds
    s_waitcnt lgkmcnt(6)
    v_mfma_f32_16x16x32_bf16 v[64:67], v[48:51], a[32:35], v[64:67]
    ds_read_b64_tr_b16 v[44:45], v20 offset:224
    v_mfma_f32_16x16x32_bf16 v[100:103], v[48:51], a[36:39], v[100:103]
    ds_read_b64_tr_b16 v[46:47], v20 offset:2528
    s_waitcnt lgkmcnt(6)
    v_mfma_f32_16x16x32_bf16 v[68:71], v[32:35], a[32:35], v[68:71]
    ds_read_b64_tr_b16 v[48:49], v20 offset:256
    v_mfma_f32_16x16x32_bf16 v[104:107], v[32:35], a[36:39], v[104:107]
    ds_read_b64_tr_b16 v[50:51], v20 offset:2560
    buffer_load_dwordx4 v7, s[4:7], s54 offen offset:2048 lds
    s_waitcnt lgkmcnt(6)
    v_mfma_f32_16x16x32_bf16 v[72:75], v[36:39], a[32:35], v[72:75]
    ds_read_b64_tr_b16 v[32:33], v20 offset:9216
    v_mfma_f32_16x16x32_bf16 v[108:111], v[36:39], a[36:39], v[108:111]
    ds_read_b64_tr_b16 v[34:35], v20 offset:11520
    s_waitcnt lgkmcnt(6)
    v_mfma_f32_16x16x32_bf16 v[76:79], v[40:43], a[32:35], v[76:79]
    ds_read_b64_tr_b16 v[36:37], v20 offset:9248
    v_mfma_f32_16x16x32_bf16 v[112:115], v[40:43], a[36:39], v[112:115]
    ds_read_b64_tr_b16 v[38:39], v20 offset:11552
    buffer_load_dwordx4 v8, s[4:7], s54 offen offset:3072 lds
    s_waitcnt lgkmcnt(6)
    v_mfma_f32_16x16x32_bf16 v[80:83], v[44:47], a[32:35], v[80:83]
    ds_read_b64_tr_b16 v[40:41], v20 offset:9280
    v_mfma_f32_16x16x32_bf16 v[116:119], v[44:47], a[36:39], v[116:119]
    ds_read_b64_tr_b16 v[42:43], v20 offset:11584
    s_waitcnt lgkmcnt(6)
    v_mfma_f32_16x16x32_bf16 v[84:87], v[48:51], a[32:35], v[84:87]
    ds_read_b64_tr_b16 v[44:45], v20 offset:9312
    v_mfma_f32_16x16x32_bf16 v[120:123], v[48:51], a[36:39], v[120:123]
    ds_read_b64_tr_b16 v[46:47], v20 offset:11616
    s_add_u32 m0, s39, 118784
    s_nop 0
    buffer_load_dwordx4 v9, s[4:7], s54 offen offset:0 lds
    s_add_u32 s32, s37, 24576
    buffer_load_dwordx4 a[32:35], v23, s[12:15], s32 offen sc1
    buffer_load_dwordx4 a[36:39], v24, s[12:15], s32 offen sc1
    s_waitcnt vmcnt(46) lgkmcnt(6)
    v_mfma_f32_16x16x32_bf16 v[52:55], v[32:35], a[40:43], v[52:55]
    ds_read_b64_tr_b16 v[48:49], v20 offset:9344
    v_mfma_f32_16x16x32_bf16 v[88:91], v[32:35], a[44:47], v[88:91]
    ds_read_b64_tr_b16 v[50:51], v20 offset:11648
    s_waitcnt lgkmcnt(6)
    v_mfma_f32_16x16x32_bf16 v[56:59], v[36:39], a[40:43], v[56:59]
    ds_read_b64_tr_b16 v[32:33], v20 offset:9376
    v_mfma_f32_16x16x32_bf16 v[92:95], v[36:39], a[44:47], v[92:95]
    ds_read_b64_tr_b16 v[34:35], v20 offset:11680
    s_waitcnt lgkmcnt(6)
    v_mfma_f32_16x16x32_bf16 v[60:63], v[40:43], a[40:43], v[60:63]
    ds_read_b64_tr_b16 v[36:37], v20 offset:9408
    v_mfma_f32_16x16x32_bf16 v[96:99], v[40:43], a[44:47], v[96:99]
    ds_read_b64_tr_b16 v[38:39], v20 offset:11712
    s_waitcnt lgkmcnt(6)
    v_mfma_f32_16x16x32_bf16 v[64:67], v[44:47], a[40:43], v[64:67]
    ds_read_b64_tr_b16 v[40:41], v20 offset:9440
    v_mfma_f32_16x16x32_bf16 v[100:103], v[44:47], a[44:47], v[100:103]
    ds_read_b64_tr_b16 v[42:43], v20 offset:11744
    s_waitcnt lgkmcnt(6)
    v_mfma_f32_16x16x32_bf16 v[68:71], v[48:51], a[40:43], v[68:71]
    ds_read_b64_tr_b16 v[44:45], v20 offset:9472
    v_mfma_f32_16x16x32_bf16 v[104:107], v[48:51], a[44:47], v[104:107]
    ds_read_b64_tr_b16 v[46:47], v20 offset:11776
    s_waitcnt lgkmcnt(6)
    v_mfma_f32_16x16x32_bf16 v[72:75], v[32:35], a[40:43], v[72:75]
    ds_read_b64_tr_b16 v[48:49], v20 offset:18432
    v_mfma_f32_16x16x32_bf16 v[108:111], v[32:35], a[44:47], v[108:111]
    ds_read_b64_tr_b16 v[50:51], v20 offset:20736
    s_waitcnt lgkmcnt(6)
    v_mfma_f32_16x16x32_bf16 v[76:79], v[36:39], a[40:43], v[76:79]
    ds_read_b64_tr_b16 v[32:33], v20 offset:18464
    v_mfma_f32_16x16x32_bf16 v[112:115], v[36:39], a[44:47], v[112:115]
    ds_read_b64_tr_b16 v[34:35], v20 offset:20768
    s_waitcnt lgkmcnt(6)
    v_mfma_f32_16x16x32_bf16 v[80:83], v[40:43], a[40:43], v[80:83]
    ds_read_b64_tr_b16 v[36:37], v20 offset:18496
    v_mfma_f32_16x16x32_bf16 v[116:119], v[40:43], a[44:47], v[116:119]
    ds_read_b64_tr_b16 v[38:39], v20 offset:20800
    s_waitcnt lgkmcnt(6)
    v_mfma_f32_16x16x32_bf16 v[84:87], v[44:47], a[40:43], v[84:87]
    ds_read_b64_tr_b16 v[40:41], v20 offset:18528
    v_mfma_f32_16x16x32_bf16 v[120:123], v[44:47], a[44:47], v[120:123]
    ds_read_b64_tr_b16 v[42:43], v20 offset:20832
    s_add_u32 s32, s37, 25600
    buffer_load_dwordx4 a[40:43], v23, s[12:15], s32 offen sc1
    buffer_load_dwordx4 a[44:47], v24, s[12:15], s32 offen sc1
    s_waitcnt vmcnt(44) lgkmcnt(6)
    v_mfma_f32_16x16x32_bf16 v[52:55], v[48:51], a[48:51], v[52:55]
    ds_read_b64_tr_b16 v[44:45], v20 offset:18560
    v_mfma_f32_16x16x32_bf16 v[88:91], v[48:51], a[52:55], v[88:91]
    ds_read_b64_tr_b16 v[46:47], v20 offset:20864
    s_waitcnt lgkmcnt(6)
    v_mfma_f32_16x16x32_bf16 v[56:59], v[32:35], a[48:51], v[56:59]
    ds_read_b64_tr_b16 v[48:49], v20 offset:18592
    v_mfma_f32_16x16x32_bf16 v[92:95], v[32:35], a[52:55], v[92:95]
    ds_read_b64_tr_b16 v[50:51], v20 offset:20896
    s_waitcnt lgkmcnt(6)
    v_mfma_f32_16x16x32_bf16 v[60:63], v[36:39], a[48:51], v[60:63]
    ds_read_b64_tr_b16 v[32:33], v20 offset:18624
    v_mfma_f32_16x16x32_bf16 v[96:99], v[36:39], a[52:55], v[96:99]
    ds_read_b64_tr_b16 v[34:35], v20 offset:20928
    s_waitcnt lgkmcnt(6)
    v_mfma_f32_16x16x32_bf16 v[64:67], v[40:43], a[48:51], v[64:67]
    ds_read_b64_tr_b16 v[36:37], v20 offset:18656
    v_mfma_f32_16x16x32_bf16 v[100:103], v[40:43], a[52:55], v[100:103]
    ds_read_b64_tr_b16 v[38:39], v20 offset:20960
    s_waitcnt lgkmcnt(6)
    v_mfma_f32_16x16x32_bf16 v[68:71], v[44:47], a[48:51], v[68:71]
    ds_read_b64_tr_b16 v[40:41], v20 offset:18688
    v_mfma_f32_16x16x32_bf16 v[104:107], v[44:47], a[52:55], v[104:107]
    ds_read_b64_tr_b16 v[42:43], v20 offset:20992
    s_waitcnt vmcnt(19)
    s_mov_b64 exec, 1
    ds_add_u32 v29, v31
    s_mov_b64 exec, -1
    s_waitcnt lgkmcnt(7)
    v_mfma_f32_16x16x32_bf16 v[72:75], v[48:51], a[48:51], v[72:75]
    ds_read_b64_tr_b16 v[44:45], v20 offset:27648
    v_mfma_f32_16x16x32_bf16 v[108:111], v[48:51], a[52:55], v[108:111]
    ds_read_b64_tr_b16 v[46:47], v20 offset:29952
    s_waitcnt lgkmcnt(7)
    v_mfma_f32_16x16x32_bf16 v[76:79], v[32:35], a[48:51], v[76:79]
    ds_read_b64_tr_b16 v[48:49], v20 offset:27680
    v_mfma_f32_16x16x32_bf16 v[112:115], v[32:35], a[52:55], v[112:115]
    ds_read_b64_tr_b16 v[50:51], v20 offset:29984
    s_waitcnt lgkmcnt(7)
    v_mfma_f32_16x16x32_bf16 v[80:83], v[36:39], a[48:51], v[80:83]
    ds_read_b64_tr_b16 v[32:33], v20 offset:27712
    v_mfma_f32_16x16x32_bf16 v[116:119], v[36:39], a[52:55], v[116:119]
    ds_read_b64_tr_b16 v[34:35], v20 offset:30016
    s_waitcnt lgkmcnt(7)
    v_mfma_f32_16x16x32_bf16 v[84:87], v[40:43], a[48:51], v[84:87]
    ds_read_b64_tr_b16 v[36:37], v20 offset:27744
    v_mfma_f32_16x16x32_bf16 v[120:123], v[40:43], a[52:55], v[120:123]
    ds_read_b64_tr_b16 v[38:39], v20 offset:30048
    s_add_u32 s32, s37, 26624
    buffer_load_dwordx4 a[48:51], v23, s[12:15], s32 offen sc1
    buffer_load_dwordx4 a[52:55], v24, s[12:15], s32 offen sc1
    s_waitcnt vmcnt(42) lgkmcnt(6)
    v_mfma_f32_16x16x32_bf16 v[52:55], v[44:47], a[56:59], v[52:55]
    ds_read_b64_tr_b16 v[40:41], v20 offset:27776
    v_mfma_f32_16x16x32_bf16 v[88:91], v[44:47], a[60:63], v[88:91]
    ds_read_b64_tr_b16 v[42:43], v20 offset:30080
    s_waitcnt lgkmcnt(6)
    v_mfma_f32_16x16x32_bf16 v[56:59], v[48:51], a[56:59], v[56:59]
    ds_read_b64_tr_b16 v[44:45], v20 offset:27808
    v_mfma_f32_16x16x32_bf16 v[92:95], v[48:51], a[60:63], v[92:95]
    ds_read_b64_tr_b16 v[46:47], v20 offset:30112
    s_waitcnt lgkmcnt(6)
    v_mfma_f32_16x16x32_bf16 v[60:63], v[32:35], a[56:59], v[60:63]
    ds_read_b64_tr_b16 v[48:49], v20 offset:27840
    v_mfma_f32_16x16x32_bf16 v[96:99], v[32:35], a[60:63], v[96:99]
    ds_read_b64_tr_b16 v[50:51], v20 offset:30144
    ds_read_b32 v30, v29
    s_waitcnt lgkmcnt(7)
    v_mfma_f32_16x16x32_bf16 v[64:67], v[36:39], a[56:59], v[64:67]
    ds_read_b64_tr_b16 v[32:33], v20 offset:27872
    v_mfma_f32_16x16x32_bf16 v[100:103], v[36:39], a[60:63], v[100:103]
    ds_read_b64_tr_b16 v[34:35], v20 offset:30176
    s_waitcnt lgkmcnt(7)
    v_mfma_f32_16x16x32_bf16 v[68:71], v[40:43], a[56:59], v[68:71]
    ds_read_b64_tr_b16 v[36:37], v20 offset:27904
    v_mfma_f32_16x16x32_bf16 v[104:107], v[40:43], a[60:63], v[104:107]
    ds_read_b64_tr_b16 v[38:39], v20 offset:30208
    s_waitcnt lgkmcnt(7)
    v_mfma_f32_16x16x32_bf16 v[72:75], v[44:47], a[56:59], v[72:75]
    s_waitcnt lgkmcnt(4)
    v_cmp_gt_u32 vcc, 12, v30
    s_cbranch_vccz L_k2_c2_ok
L_k2_c2:
    ds_read_b32 v30, v29
    s_waitcnt lgkmcnt(0)
    v_cmp_gt_u32 vcc, 12, v30
    s_cbranch_vccnz L_k2_c2
L_k2_c2_ok:
    ds_read_b64_tr_b16 v[40:41], v21 offset:0
    v_mfma_f32_16x16x32_bf16 v[108:111], v[44:47], a[60:63], v[108:111]
    ds_read_b64_tr_b16 v[42:43], v21 offset:2304
    s_add_u32 s54, s35, 884736
    s_add_u32 m0, s39, 0
    s_nop 0
    buffer_load_dwordx4 v1, s[4:7], s54 offen offset:0 lds
    s_waitcnt lgkmcnt(7)
    v_mfma_f32_16x16x32_bf16 v[76:79], v[48:51], a[56:59], v[76:79]
    ds_read_b64_tr_b16 v[44:45], v21 offset:32
    v_mfma_f32_16x16x32_bf16 v[112:115], v[48:51], a[60:63], v[112:115]
    ds_read_b64_tr_b16 v[46:47], v21 offset:2336
    s_waitcnt lgkmcnt(6)
    v_mfma_f32_16x16x32_bf16 v[80:83], v[32:35], a[56:59], v[80:83]
    ds_read_b64_tr_b16 v[48:49], v21 offset:64
    v_mfma_f32_16x16x32_bf16 v[116:119], v[32:35], a[60:63], v[116:119]
    ds_read_b64_tr_b16 v[50:51], v21 offset:2368
    buffer_load_dwordx4 v2, s[4:7], s54 offen offset:1024 lds
    s_waitcnt lgkmcnt(6)
    v_mfma_f32_16x16x32_bf16 v[84:87], v[36:39], a[56:59], v[84:87]
    ds_read_b64_tr_b16 v[32:33], v21 offset:96
    v_mfma_f32_16x16x32_bf16 v[120:123], v[36:39], a[60:63], v[120:123]
    ds_read_b64_tr_b16 v[34:35], v21 offset:2400
    s_add_u32 s32, s37, 27648
    buffer_load_dwordx4 a[56:59], v23, s[12:15], s32 offen sc1
    buffer_load_dwordx4 a[60:63], v24, s[12:15], s32 offen sc1
    s_waitcnt vmcnt(39) lgkmcnt(6)
    v_mfma_f32_16x16x32_bf16 v[52:55], v[40:43], a[64:67], v[52:55]
    ds_read_b64_tr_b16 v[36:37], v21 offset:128
    v_mfma_f32_16x16x32_bf16 v[88:91], v[40:43], a[68:71], v[88:91]
    ds_read_b64_tr_b16 v[38:39], v21 offset:2432
    buffer_load_dwordx4 v3, s[4:7], s54 offen offset:2048 lds
    s_waitcnt lgkmcnt(6)
    v_mfma_f32_16x16x32_bf16 v[56:59], v[44:47], a[64:67], v[56:59]
    ds_read_b64_tr_b16 v[40:41], v21 offset:160
    v_mfma_f32_16x16x32_bf16 v[92:95], v[44:47], a[68:71], v[92:95]
    ds_read_b64_tr_b16 v[42:43], v21 offset:2464
    s_waitcnt lgkmcnt(6)
    v_mfma_f32_16x16x32_bf16 v[60:63], v[48:51], a[64:67], v[60:63]
    ds_read_b64_tr_b16 v[44:45], v21 offset:192
    v_mfma_f32_16x16x32_bf16 v[96:99], v[48:51], a[68:71], v[96:99]
    ds_read_b64_tr_b16 v[46:47], v21 offset:2496
    buffer_load_dwordx4 v4, s[4:7], s54 offen offset:3072 lds
    s_waitcnt lgkmcnt(6)
    v_mfma_f32_16x16x32_bf16 v[64:67], v[32:35], a[64:67], v[64:67]
    ds_read_b64_tr_b16 v[48:49], v21 offset:224
    v_mfma_f32_16x16x32_bf16 v[100:103], v[32:35], a[68:71], v[100:103]
    ds_read_b64_tr_b16 v[50:51], v21 offset:2528
    s_waitcnt lgkmcnt(6)
    v_mfma_f32_16x16x32_bf16 v[68:71], v[36:39], a[64:67], v[68:71]
    ds_read_b64_tr_b16 v[32:33], v21 offset:256
    v_mfma_f32_16x16x32_bf16 v[104:107], v[36:39], a[68:71], v[104:107]
    ds_read_b64_tr_b16 v[34:35], v21 offset:2560
    s_add_u32 m0, s39, 4096
    s_nop 0
    buffer_load_dwordx4 v5, s[4:7], s54 offen offset:0 lds
    s_waitcnt lgkmcnt(6)
    v_mfma_f32_16x16x32_bf16 v[72:75], v[40:43], a[64:67], v[72:75]
    ds_read_b64_tr_b16 v[36:37], v21 offset:9216
    v_mfma_f32_16x16x32_bf16 v[108:111], v[40:43], a[68:71], v[108:111]
    ds_read_b64_tr_b16 v[38:39], v21 offset:11520
    s_waitcnt lgkmcnt(6)
    v_mfma_f32_16x16x32_bf16 v[76:79], v[44:47], a[64:67], v[76:79]
    ds_read_b64_tr_b16 v[40:41], v21 offset:9248
    v_mfma_f32_16x16x32_bf16 v[112:115], v[44:47], a[68:71], v[112:115]
    ds_read_b64_tr_b16 v[42:43], v21 offset:11552
    buffer_load_dwordx4 v6, s[4:7], s54 offen offset:1024 lds
    s_waitcnt lgkmcnt(6)
    v_mfma_f32_16x16x32_bf16 v[80:83], v[48:51], a[64:67], v[80:83]
    ds_read_b64_tr_b16 v[44:45], v21 offset:9280
    v_mfma_f32_16x16x32_bf16 v[116:119], v[48:51], a[68:71], v[116:119]
    ds_read_b64_tr_b16 v[46:47], v21 offset:11584
    s_waitcnt lgkmcnt(6)
    v_mfma_f32_16x16x32_bf16 v[84:87], v[32:35], a[64:67], v[84:87]
    ds_read_b64_tr_b16 v[48:49], v21 offset:9312
    v_mfma_f32_16x16x32_bf16 v[120:123], v[32:35], a[68:71], v[120:123]
    ds_read_b64_tr_b16 v[50:51], v21 offset:11616
    buffer_load_dwordx4 v7, s[4:7], s54 offen offset:2048 lds
    s_add_u32 s32, s37, 28672
    buffer_load_dwordx4 a[64:67], v23, s[12:15], s32 offen sc1
    buffer_load_dwordx4 a[68:71], v24, s[12:15], s32 offen sc1
    s_waitcnt vmcnt(42) lgkmcnt(6)
    v_mfma_f32_16x16x32_bf16 v[52:55], v[36:39], a[72:75], v[52:55]
    ds_read_b64_tr_b16 v[32:33], v21 offset:9344
    v_mfma_f32_16x16x32_bf16 v[88:91], v[36:39], a[76:79], v[88:91]
    ds_read_b64_tr_b16 v[34:35], v21 offset:11648
    s_waitcnt lgkmcnt(6)
    v_mfma_f32_16x16x32_bf16 v[56:59], v[40:43], a[72:75], v[56:59]
    ds_read_b64_tr_b16 v[36:37], v21 offset:9376
    v_mfma_f32_16x16x32_bf16 v[92:95], v[40:43], a[76:79], v[92:95]
    ds_read_b64_tr_b16 v[38:39], v21 offset:11680
    buffer_load_dwordx4 v8, s[4:7], s54 offen offset:3072 lds
    s_waitcnt lgkmcnt(6)
    v_mfma_f32_16x16x32_bf16 v[60:63], v[44:47], a[72:75], v[60:63]
    ds_read_b64_tr_b16 v[40:41], v21 offset:9408
    v_mfma_f32_16x16x32_bf16 v[96:99], v[44:47], a[76:79], v[96:99]
    ds_read_b64_tr_b16 v[42:43], v21 offset:11712
    s_waitcnt lgkmcnt(6)
    v_mfma_f32_16x16x32_bf16 v[64:67], v[48:51], a[72:75], v[64:67]
    ds_read_b64_tr_b16 v[44:45], v21 offset:9440
    v_mfma_f32_16x16x32_bf16 v[100:103], v[48:51], a[76:79], v[100:103]
    ds_read_b64_tr_b16 v[46:47], v21 offset:11744
    s_add_u32 m0, s39, 8192
    s_nop 0
    buffer_load_dwordx4 v9, s[4:7], s54 offen offset:0 lds
    s_waitcnt lgkmcnt(6)
    v_mfma_f32_16x16x32_bf16 v[68:71], v[32:35], a[72:75], v[68:71]
    ds_read_b64_tr_b16 v[48:49], v21 offset:9472
    v_mfma_f32_16x16x32_bf16 v[104:107], v[32:35], a[76:79], v[104:107]
    ds_read_b64_tr_b16 v[50:51], v21 offset:11776
    s_waitcnt lgkmcnt(6)
    v_mfma_f32_16x16x32_bf16 v[72:75], v[36:39], a[72:75], v[72:75]
    ds_read_b64_tr_b16 v[32:33], v21 offset:18432
    v_mfma_f32_16x16x32_bf16 v[108:111], v[36:39], a[76:79], v[108:111]
    ds_read_b64_tr_b16 v[34:35], v21 offset:20736
    s_waitcnt lgkmcnt(6)
    v_mfma_f32_16x16x32_bf16 v[76:79], v[40:43], a[72:75], v[76:79]
    ds_read_b64_tr_b16 v[36:37], v21 offset:18464
    v_mfma_f32_16x16x32_bf16 v[112:115], v[40:43], a[76:79], v[112:115]
    ds_read_b64_tr_b16 v[38:39], v21 offset:20768
    s_waitcnt lgkmcnt(6)
    v_mfma_f32_16x16x32_bf16 v[80:83], v[44:47], a[72:75], v[80:83]
    ds_read_b64_tr_b16 v[40:41], v21 offset:18496
    v_mfma_f32_16x16x32_bf16 v[116:119], v[44:47], a[76:79], v[116:119]
    ds_read_b64_tr_b16 v[42:43], v21 offset:20800
    s_waitcnt lgkmcnt(6)
    v_mfma_f32_16x16x32_bf16 v[84:87], v[48:51], a[72:75], v[84:87]
    ds_read_b64_tr_b16 v[44:45], v21 offset:18528
    v_mfma_f32_16x16x32_bf16 v[120:123], v[48:51], a[76:79], v[120:123]
    ds_read_b64_tr_b16 v[46:47], v21 offset:20832
    v_mov_b32 v25, 0
    buffer_load_dword a127, v25, s[12:15], s81 offen offset:0 sc1
    s_add_u32 s32, s37, 29696
    buffer_load_dwordx4 a[72:75], v23, s[12:15], s32 offen sc1
    buffer_load_dwordx4 a[76:79], v24, s[12:15], s32 offen sc1
    s_waitcnt vmcnt(43) lgkmcnt(6)
    v_mfma_f32_16x16x32_bf16 v[52:55], v[32:35], a[80:83], v[52:55]
    ds_read_b64_tr_b16 v[48:49], v21 offset:18560
    v_mfma_f32_16x16x32_bf16 v[88:91], v[32:35], a[84:87], v[88:91]
    ds_read_b64_tr_b16 v[50:51], v21 offset:20864
    s_waitcnt lgkmcnt(6)
    v_mfma_f32_16x16x32_bf16 v[56:59], v[36:39], a[80:83], v[56:59]
    ds_read_b64_tr_b16 v[32:33], v21 offset:18592
    v_mfma_f32_16x16x32_bf16 v[92:95], v[36:39], a[84:87], v[92:95]
    ds_read_b64_tr_b16 v[34:35], v21 offset:20896
    s_waitcnt lgkmcnt(6)
    v_mfma_f32_16x16x32_bf16 v[60:63], v[40:43], a[80:83], v[60:63]
    ds_read_b64_tr_b16 v[36:37], v21 offset:18624
    v_mfma_f32_16x16x32_bf16 v[96:99], v[40:43], a[84:87], v[96:99]
    ds_read_b64_tr_b16 v[38:39], v21 offset:20928
    s_waitcnt lgkmcnt(6)
    v_mfma_f32_16x16x32_bf16 v[64:67], v[44:47], a[80:83], v[64:67]
    ds_read_b64_tr_b16 v[40:41], v21 offset:18656
    v_mfma_f32_16x16x32_bf16 v[100:103], v[44:47], a[84:87], v[100:103]
    ds_read_b64_tr_b16 v[42:43], v21 offset:20960
    s_waitcnt lgkmcnt(6)
    v_mfma_f32_16x16x32_bf16 v[68:71], v[48:51], a[80:83], v[68:71]
    ds_read_b64_tr_b16 v[44:45], v21 offset:18688
    v_mfma_f32_16x16x32_bf16 v[104:107], v[48:51], a[84:87], v[104:107]
    ds_read_b64_tr_b16 v[46:47], v21 offset:20992
    s_waitcnt vmcnt(22)
    s_mov_b64 exec, 1
    ds_add_u32 v29, v31
    s_mov_b64 exec, -1
    s_waitcnt lgkmcnt(7)
    v_mfma_f32_16x16x32_bf16 v[72:75], v[32:35], a[80:83], v[72:75]
    ds_read_b64_tr_b16 v[48:49], v21 offset:27648
    v_mfma_f32_16x16x32_bf16 v[108:111], v[32:35], a[84:87], v[108:111]
    ds_read_b64_tr_b16 v[50:51], v21 offset:29952
    s_waitcnt lgkmcnt(7)
    v_mfma_f32_16x16x32_bf16 v[76:79], v[36:39], a[80:83], v[76:79]
    ds_read_b64_tr_b16 v[32:33], v21 offset:27680
    v_mfma_f32_16x16x32_bf16 v[112:115], v[36:39], a[84:87], v[112:115]
    ds_read_b64_tr_b16 v[34:35], v21 offset:29984
    s_waitcnt lgkmcnt(7)
    v_mfma_f32_16x16x32_bf16 v[80:83], v[40:43], a[80:83], v[80:83]
    ds_read_b64_tr_b16 v[36:37], v21 offset:27712
    v_mfma_f32_16x16x32_bf16 v[116:119], v[40:43], a[84:87], v[116:119]
    ds_read_b64_tr_b16 v[38:39], v21 offset:30016
    s_lshl_b32 s33, s31, 2
    s_add_u32 s33, s33, 0
    s_cmp_ge_u32 s33, 9
    s_cselect_b32 s34, 9, 0
    s_sub_u32 s33, s33, s34
    s_lshl_b32 s33, s33, 5
    s_lshl_b32 s34, s34, 11
    s_add_u32 s34, s34, s33
    s_add_u32 s34, s34, s57
    s_add_u32 s33, s33, s58
    buffer_load_dwordx2 a[96:97], v126, s[16:19], s34 offen
    buffer_load_dwordx2 a[98:99], v127, s[20:23], s33 offen
    s_lshl_b32 s33, s31, 2
    s_add_u32 s33, s33, 1
    s_cmp_ge_u32 s33, 9
    s_cselect_b32 s34, 9, 0
    s_sub_u32 s33, s33, s34
    s_lshl_b32 s33, s33, 5
    s_lshl_b32 s34, s34, 11
    s_add_u32 s34, s34, s33
    s_add_u32 s34, s34, s57
    s_add_u32 s33, s33, s58
    buffer_load_dwordx2 a[100:101], v126, s[16:19], s34 offen
    buffer_load_dwordx2 a[102:103], v127, s[20:23], s33 offen
    s_waitcnt lgkmcnt(7)
    v_mfma_f32_16x16x32_bf16 v[84:87], v[44:47], a[80:83], v[84:87]
    ds_read_b64_tr_b16 v[40:41], v21 offset:27744
    v_mfma_f32_16x16x32_bf16 v[120:123], v[44:47], a[84:87], v[120:123]
    ds_read_b64_tr_b16 v[42:43], v21 offset:30048
    s_add_u32 s32, s37, 30720
    buffer_load_dwordx4 a[80:83], v23, s[12:15], s32 offen sc1
    buffer_load_dwordx4 a[84:87], v24, s[12:15], s32 offen sc1
    s_waitcnt vmcnt(45) lgkmcnt(6)
    v_mfma_f32_16x16x32_bf16 v[52:55], v[48:51], a[88:91], v[52:55]
    ds_read_b64_tr_b16 v[44:45], v21 offset:27776
    v_mfma_f32_16x16x32_bf16 v[88:91], v[48:51], a[92:95], v[88:91]
    ds_read_b64_tr_b16 v[46:47], v21 offset:30080
    s_waitcnt lgkmcnt(6)
    v_mfma_f32_16x16x32_bf16 v[56:59], v[32:35], a[88:91], v[56:59]
    ds_read_b64_tr_b16 v[48:49], v21 offset:27808
    v_mfma_f32_16x16x32_bf16 v[92:95], v[32:35], a[92:95], v[92:95]
    ds_read_b64_tr_b16 v[50:51], v21 offset:30112
    s_waitcnt lgkmcnt(6)
    v_mfma_f32_16x16x32_bf16 v[60:63], v[36:39], a[88:91], v[60:63]
    ds_read_b64_tr_b16 v[32:33], v21 offset:27840
    v_mfma_f32_16x16x32_bf16 v[96:99], v[36:39], a[92:95], v[96:99]
    ds_read_b64_tr_b16 v[34:35], v21 offset:30144
    ds_read_b32 v30, v29
    s_waitcnt lgkmcnt(7)
    v_mfma_f32_16x16x32_bf16 v[64:67], v[40:43], a[88:91], v[64:67]
    ds_read_b64_tr_b16 v[36:37], v21 offset:27872
    v_mfma_f32_16x16x32_bf16 v[100:103], v[40:43], a[92:95], v[100:103]
    ds_read_b64_tr_b16 v[38:39], v21 offset:30176
    s_waitcnt lgkmcnt(7)
    v_mfma_f32_16x16x32_bf16 v[68:71], v[44:47], a[88:91], v[68:71]
    ds_read_b64_tr_b16 v[40:41], v21 offset:27904
    v_mfma_f32_16x16x32_bf16 v[104:107], v[44:47], a[92:95], v[104:107]
    ds_read_b64_tr_b16 v[42:43], v21 offset:30208
    s_waitcnt lgkmcnt(7)
    v_mfma_f32_16x16x32_bf16 v[72:75], v[48:51], a[88:91], v[72:75]
    s_waitcnt lgkmcnt(4)
    v_cmp_gt_u32 vcc, 16, v30
    s_cbranch_vccz L_k2_c3_ok
L_k2_c3:
    ds_read_b32 v30, v29
    s_waitcnt lgkmcnt(0)
    v_cmp_gt_u32 vcc, 16, v30
    s_cbranch_vccnz L_k2_c3
L_k2_c3_ok:
    ds_read_b64_tr_b16 v[44:45], v22 offset:0
    v_mfma_f32_16x16x32_bf16 v[108:111], v[48:51], a[92:95], v[108:111]
    ds_read_b64_tr_b16 v[46:47], v22 offset:2304
    s_add_u32 s54, s35, 1032192
    s_add_u32 m0, s39, 36864
    s_nop 0
    buffer_load_dwordx4 v1, s[4:7], s54 offen offset:0 lds
    s_waitcnt lgkmcnt(7)
    v_mfma_f32_16x16x32_bf16 v[76:79], v[32:35], a[88:91], v[76:79]
    ds_read_b64_tr_b16 v[48:49], v22 offset:32
    v_mfma_f32_16x16x32_bf16 v[112:115], v[32:35], a[92:95], v[112:115]
    ds_read_b64_tr_b16 v[50:51], v22 offset:2336
    s_waitcnt lgkmcnt(6)
    v_mfma_f32_16x16x32_bf16 v[80:83], v[36:39], a[88:91], v[80:83]
    ds_read_b64_tr_b16 v[32:33], v22 offset:64
    v_mfma_f32_16x16x32_bf16 v[116:119], v[36:39], a[92:95], v[116:119]
    ds_read_b64_tr_b16 v[34:35], v22 offset:2368
    buffer_load_dwordx4 v2, s[4:7], s54 offen offset:1024 lds
    s_waitcnt lgkmcnt(6)
    v_mfma_f32_16x16x32_bf16 v[84:87], v[40:43], a[88:91], v[84:87]
    ds_read_b64_tr_b16 v[36:37], v22 offset:96
    v_mfma_f32_16x16x32_bf16 v[120:123], v[40:43], a[92:95], v[120:123]
    ds_read_b64_tr_b16 v[38:39], v22 offset:2400
    s_add_u32 s32, s37, 31744
    buffer_load_dwordx4 a[88:91], v23, s[12:15], s32 offen sc1
    buffer_load_dwordx4 a[92:95], v24, s[12:15], s32 offen sc1
    s_waitcnt vmcnt(62) lgkmcnt(6)
    v_mfma_f32_16x16x32_bf16 v[52:55], v[44:47], a[0:3], v[52:55]
    ds_read_b64_tr_b16 v[40:41], v22 offset:128
    v_mfma_f32_16x16x32_bf16 v[88:91], v[44:47], a[4:7], v[88:91]
    ds_read_b64_tr_b16 v[42:43], v22 offset:2432
    buffer_load_dwordx4 v3, s[4:7], s54 offen offset:2048 lds
    s_waitcnt lgkmcnt(6)
    v_mfma_f32_16x16x32_bf16 v[56:59], v[48:51], a[0:3], v[56:59]
    ds_read_b64_tr_b16 v[44:45], v22 offset:160
    v_mfma_f32_16x16x32_bf16 v[92:95], v[48:51], a[4:7], v[92:95]
    ds_read_b64_tr_b16 v[46:47], v22 offset:2464
    s_waitcnt lgkmcnt(6)
    v_mfma_f32_16x16x32_bf16 v[60:63], v[32:35], a[0:3], v[60:63]
    ds_read_b64_tr_b16 v[48:49], v22 offset:192
    v_mfma_f32_16x16x32_bf16 v[96:99], v[32:35], a[4:7], v[96:99]
    ds_read_b64_tr_b16 v[50:51], v22 offset:2496
    buffer_load_dwordx4 v4, s[4:7], s54 offen offset:3072 lds
    s_waitcnt lgkmcnt(6)
    v_mfma_f32_16x16x32_bf16 v[64:67], v[36:39], a[0:3], v[64:67]
    ds_read_b64_tr_b16 v[32:33], v22 offset:224
    v_mfma_f32_16x16x32_bf16 v[100:103], v[36:39], a[4:7], v[100:103]
    ds_read_b64_tr_b16 v[34:35], v22 offset:2528
    s_waitcnt lgkmcnt(6)
    v_mfma_f32_16x16x32_bf16 v[68:71], v[40:43], a[0:3], v[68:71]
    ds_read_b64_tr_b16 v[36:37], v22 offset:256
    v_mfma_f32_16x16x32_bf16 v[104:107], v[40:43], a[4:7], v[104:107]
    ds_read_b64_tr_b16 v[38:39], v22 offset:2560
    s_add_u32 m0, s39, 40960
    s_nop 0
    buffer_load_dwordx4 v5, s[4:7], s54 offen offset:0 lds
    s_waitcnt lgkmcnt(6)
    v_mfma_f32_16x16x32_bf16 v[72:75], v[44:47], a[0:3], v[72:75]
    ds_read_b64_tr_b16 v[40:41], v22 offset:9216
    v_mfma_f32_16x16x32_bf16 v[108:111], v[44:47], a[4:7], v[108:111]
    ds_read_b64_tr_b16 v[42:43], v22 offset:11520
    s_waitcnt lgkmcnt(6)
    v_mfma_f32_16x16x32_bf16 v[76:79], v[48:51], a[0:3], v[76:79]
    ds_read_b64_tr_b16 v[44:45], v22 offset:9248
    v_mfma_f32_16x16x32_bf16 v[112:115], v[48:51], a[4:7], v[112:115]
    ds_read_b64_tr_b16 v[46:47], v22 offset:11552
    buffer_load_dwordx4 v6, s[4:7], s54 offen offset:1024 lds
    s_waitcnt lgkmcnt(6)
    v_mfma_f32_16x16x32_bf16 v[80:83], v[32:35], a[0:3], v[80:83]
    ds_read_b64_tr_b16 v[48:49], v22 offset:9280
    v_mfma_f32_16x16x32_bf16 v[116:119], v[32:35], a[4:7], v[116:119]
    ds_read_b64_tr_b16 v[50:51], v22 offset:11584
    s_waitcnt lgkmcnt(6)
    v_mfma_f32_16x16x32_bf16 v[84:87], v[36:39], a[0:3], v[84:87]
    ds_read_b64_tr_b16 v[32:33], v22 offset:9312
    v_mfma_f32_16x16x32_bf16 v[120:123], v[36:39], a[4:7], v[120:123]
    ds_read_b64_tr_b16 v[34:35], v22 offset:11616
    buffer_load_dwordx4 v7, s[4:7], s54 offen offset:2048 lds
    s_waitcnt vmcnt(17)
    v_accvgpr_read_b32 v26, a127
    v_mov_b32 v25, 0
    v_cmp_ne_u32 vcc, 1, v26
    s_cbranch_vccz L_k2_hl_ok
L_k2_hl:
    s_sleep 2
    buffer_load_dword v26, v25, s[12:15], s81 offen sc1
    s_waitcnt vmcnt(0)
    v_cmp_ne_u32 vcc, 1, v26
    s_cbranch_vccnz L_k2_hl
L_k2_hl_ok:
    s_add_u32 s32, s37, 8192
    buffer_load_dwordx4 a[0:3], v23, s[12:15], s32 offen sc1
    buffer_load_dwordx4 a[4:7], v24, s[12:15], s32 offen sc1
    s_waitcnt vmcnt(52) lgkmcnt(6)
    v_mfma_f32_16x16x32_bf16 v[52:55], v[40:43], a[8:11], v[52:55]
    ds_read_b64_tr_b16 v[36:37], v22 offset:9344
    v_mfma_f32_16x16x32_bf16 v[88:91], v[40:43], a[12:15], v[88:91]
    ds_read_b64_tr_b16 v[38:39], v22 offset:11648
    s_waitcnt lgkmcnt(6)
    v_mfma_f32_16x16x32_bf16 v[56:59], v[44:47], a[8:11], v[56:59]
    ds_read_b64_tr_b16 v[40:41], v22 offset:9376
    v_mfma_f32_16x16x32_bf16 v[92:95], v[44:47], a[12:15], v[92:95]
    ds_read_b64_tr_b16 v[42:43], v22 offset:11680
    buffer_load_dwordx4 v8, s[4:7], s54 offen offset:3072 lds
    s_waitcnt lgkmcnt(6)
    v_mfma_f32_16x16x32_bf16 v[60:63], v[48:51], a[8:11], v[60:63]
    ds_read_b64_tr_b16 v[44:45], v22 offset:9408
    v_mfma_f32_16x16x32_bf16 v[96:99], v[48:51], a[12:15], v[96:99]
    ds_read_b64_tr_b16 v[46:47], v22 offset:11712
    s_waitcnt lgkmcnt(6)
    v_mfma_f32_16x16x32_bf16 v[64:67], v[32:35], a[8:11], v[64:67]
    ds_read_b64_tr_b16 v[48:49], v22 offset:9440
    v_mfma_f32_16x16x32_bf16 v[100:103], v[32:35], a[12:15], v[100:103]
    ds_read_b64_tr_b16 v[50:51], v22 offset:11744
    s_add_u32 m0, s39, 45056
    s_nop 0
    buffer_load_dwordx4 v9, s[4:7], s54 offen offset:0 lds
    s_waitcnt lgkmcnt(6)
    v_mfma_f32_16x16x32_bf16 v[68:71], v[36:39], a[8:11], v[68:71]
    ds_read_b64_tr_b16 v[32:33], v22 offset:9472
    v_mfma_f32_16x16x32_bf16 v[104:107], v[36:39], a[12:15], v[104:107]
    ds_read_b64_tr_b16 v[34:35], v22 offset:11776
    s_waitcnt lgkmcnt(6)
    v_mfma_f32_16x16x32_bf16 v[72:75], v[40:43], a[8:11], v[72:75]
    ds_read_b64_tr_b16 v[36:37], v22 offset:18432
    v_mfma_f32_16x16x32_bf16 v[108:111], v[40:43], a[12:15], v[108:111]
    ds_read_b64_tr_b16 v[38:39], v22 offset:20736
    s_waitcnt lgkmcnt(6)
    v_mfma_f32_16x16x32_bf16 v[76:79], v[44:47], a[8:11], v[76:79]
    ds_read_b64_tr_b16 v[40:41], v22 offset:18464
    v_mfma_f32_16x16x32_bf16 v[112:115], v[44:47], a[12:15], v[112:115]
    ds_read_b64_tr_b16 v[42:43], v22 offset:20768
    s_waitcnt lgkmcnt(6)
    v_mfma_f32_16x16x32_bf16 v[80:83], v[48:51], a[8:11], v[80:83]
    ds_read_b64_tr_b16 v[44:45], v22 offset:18496
    v_mfma_f32_16x16x32_bf16 v[116:119], v[48:51], a[12:15], v[116:119]
    ds_read_b64_tr_b16 v[46:47], v22 offset:20800
    s_waitcnt lgkmcnt(6)
    v_mfma_f32_16x16x32_bf16 v[84:87], v[32:35], a[8:11], v[84:87]
    ds_read_b64_tr_b16 v[48:49], v22 offset:18528
    v_mfma_f32_16x16x32_bf16 v[120:123], v[32:35], a[12:15], v[120:123]
    ds_read_b64_tr_b16 v[50:51], v22 offset:20832
    s_add_u32 s32, s37, 9216
    buffer_load_dwordx4 a[8:11], v23, s[12:15], s32 offen sc1
    buffer_load_dwordx4 a[12:15], v24, s[12:15], s32 offen sc1
    s_waitcnt vmcnt(54) lgkmcnt(6)
    v_mfma_f32_16x16x32_bf16 v[52:55], v[36:39], a[16:19], v[52:55]
    ds_read_b64_tr_b16 v[32:33], v22 offset:18560
    v_mfma_f32_16x16x32_bf16 v[88:91], v[36:39], a[20:23], v[88:91]
    ds_read_b64_tr_b16 v[34:35], v22 offset:20864
    s_waitcnt lgkmcnt(6)
    v_mfma_f32_16x16x32_bf16 v[56:59], v[40:43], a[16:19], v[56:59]
    ds_read_b64_tr_b16 v[36:37], v22 offset:18592
    v_mfma_f32_16x16x32_bf16 v[92:95], v[40:43], a[20:23], v[92:95]
    ds_read_b64_tr_b16 v[38:39], v22 offset:20896
    s_waitcnt lgkmcnt(6)
    v_mfma_f32_16x16x32_bf16 v[60:63], v[44:47], a[16:19], v[60:63]
    ds_read_b64_tr_b16 v[40:41], v22 offset:18624
    v_mfma_f32_16x16x32_bf16 v[96:99], v[44:47], a[20:23], v[96:99]
    ds_read_b64_tr_b16 v[42:43], v22 offset:20928
    s_waitcnt lgkmcnt(6)
    v_mfma_f32_16x16x32_bf16 v[64:67], v[48:51], a[16:19], v[64:67]
    ds_read_b64_tr_b16 v[44:45], v22 offset:18656
    v_mfma_f32_16x16x32_bf16 v[100:103], v[48:51], a[20:23], v[100:103]
    ds_read_b64_tr_b16 v[46:47], v22 offset:20960
    s_waitcnt lgkmcnt(6)
    v_mfma_f32_16x16x32_bf16 v[68:71], v[32:35], a[16:19], v[68:71]
    ds_read_b64_tr_b16 v[48:49], v22 offset:18688
    v_mfma_f32_16x16x32_bf16 v[104:107], v[32:35], a[20:23], v[104:107]
    ds_read_b64_tr_b16 v[50:51], v22 offset:20992
    s_waitcnt vmcnt(24)
    s_mov_b64 exec, 1
    ds_add_u32 v29, v31
    s_mov_b64 exec, -1
    s_waitcnt lgkmcnt(7)
    v_mfma_f32_16x16x32_bf16 v[72:75], v[36:39], a[16:19], v[72:75]
    ds_read_b64_tr_b16 v[32:33], v22 offset:27648
    v_mfma_f32_16x16x32_bf16 v[108:111], v[36:39], a[20:23], v[108:111]
    ds_read_b64_tr_b16 v[34:35], v22 offset:29952
    s_waitcnt lgkmcnt(7)
    v_mfma_f32_16x16x32_bf16 v[76:79], v[40:43], a[16:19], v[76:79]
    ds_read_b64_tr_b16 v[36:37], v22 offset:27680
    v_mfma_f32_16x16x32_bf16 v[112:115], v[40:43], a[20:23], v[112:115]
    ds_read_b64_tr_b16 v[38:39], v22 offset:29984
    s_waitcnt lgkmcnt(7)
    v_mfma_f32_16x16x32_bf16 v[80:83], v[44:47], a[16:19], v[80:83]
    ds_read_b64_tr_b16 v[40:41], v22 offset:27712
    v_mfma_f32_16x16x32_bf16 v[116:119], v[44:47], a[20:23], v[116:119]
    ds_read_b64_tr_b16 v[42:43], v22 offset:30016
    s_lshl_b32 s33, s31, 2
    s_add_u32 s33, s33, 2
    s_cmp_ge_u32 s33, 9
    s_cselect_b32 s34, 9, 0
    s_sub_u32 s33, s33, s34
    s_lshl_b32 s33, s33, 5
    s_lshl_b32 s34, s34, 11
    s_add_u32 s34, s34, s33
    s_add_u32 s34, s34, s57
    s_add_u32 s33, s33, s58
    buffer_load_dwordx2 a[104:105], v126, s[16:19], s34 offen
    buffer_load_dwordx2 a[106:107], v127, s[20:23], s33 offen
    s_lshl_b32 s33, s31, 2
    s_add_u32 s33, s33, 3
    s_cmp_ge_u32 s33, 9
    s_cselect_b32 s34, 9, 0
    s_sub_u32 s33, s33, s34
    s_lshl_b32 s33, s33, 5
    s_lshl_b32 s34, s34, 11
    s_add_u32 s34, s34, s33
    s_add_u32 s34, s34, s57
    s_add_u32 s33, s33, s58
    buffer_load_dwordx2 a[108:109], v126, s[16:19], s34 offen
    buffer_load_dwordx2 a[110:111], v127, s[20:23], s33 offen
    s_waitcnt lgkmcnt(7)
    v_mfma_f32_16x16x32_bf16 v[84:87], v[48:51], a[16:19], v[84:87]
    ds_read_b64_tr_b16 v[44:45], v22 offset:27744
    v_mfma_f32_16x16x32_bf16 v[120:123], v[48:51], a[20:23], v[120:123]
    ds_read_b64_tr_b16 v[46:47], v22 offset:30048
    s_add_u32 s32, s37, 10240
    buffer_load_dwordx4 a[16:19], v23, s[12:15], s32 offen sc1
    buffer_load_dwordx4 a[20:23], v24, s[12:15], s32 offen sc1
    s_waitcnt vmcnt(54) lgkmcnt(6)
    v_mfma_f32_16x16x32_bf16 v[52:55], v[32:35], a[24:27], v[52:55]
    ds_read_b64_tr_b16 v[48:49], v22 offset:27776
    v_mfma_f32_16x16x32_bf16 v[88:91], v[32:35], a[28:31], v[88:91]
    ds_read_b64_tr_b16 v[50:51], v22 offset:30080
    s_waitcnt lgkmcnt(6)
    v_mfma_f32_16x16x32_bf16 v[56:59], v[36:39], a[24:27], v[56:59]
    ds_read_b64_tr_b16 v[32:33], v22 offset:27808
    v_mfma_f32_16x16x32_bf16 v[92:95], v[36:39], a[28:31], v[92:95]
    ds_read_b64_tr_b16 v[34:35], v22 offset:30112
    s_waitcnt lgkmcnt(6)
    v_mfma_f32_16x16x32_bf16 v[60:63], v[40:43], a[24:27], v[60:63]
    ds_read_b64_tr_b16 v[36:37], v22 offset:27840
    v_mfma_f32_16x16x32_bf16 v[96:99], v[40:43], a[28:31], v[96:99]
    ds_read_b64_tr_b16 v[38:39], v22 offset:30144
    ds_read_b32 v30, v29
    s_waitcnt lgkmcnt(7)
    v_mfma_f32_16x16x32_bf16 v[64:67], v[44:47], a[24:27], v[64:67]
    ds_read_b64_tr_b16 v[40:41], v22 offset:27872
    v_mfma_f32_16x16x32_bf16 v[100:103], v[44:47], a[28:31], v[100:103]
    ds_read_b64_tr_b16 v[42:43], v22 offset:30176
    s_waitcnt lgkmcnt(7)
    v_mfma_f32_16x16x32_bf16 v[68:71], v[48:51], a[24:27], v[68:71]
    ds_read_b64_tr_b16 v[44:45], v22 offset:27904
    v_mfma_f32_16x16x32_bf16 v[104:107], v[48:51], a[28:31], v[104:107]
    ds_read_b64_tr_b16 v[46:47], v22 offset:30208
    s_waitcnt lgkmcnt(7)
    v_mfma_f32_16x16x32_bf16 v[72:75], v[32:35], a[24:27], v[72:75]
    s_waitcnt lgkmcnt(4)
    v_cmp_gt_u32 vcc, 20, v30
    s_cbranch_vccz L_k2_c4_ok
L_k2_c4:
    ds_read_b32 v30, v29
    s_waitcnt lgkmcnt(0)
    v_cmp_gt_u32 vcc, 20, v30
    s_cbranch_vccnz L_k2_c4
L_k2_c4_ok:
    ds_read_b64_tr_b16 v[48:49], v19 offset:0
    v_mfma_f32_16x16x32_bf16 v[108:111], v[32:35], a[28:31], v[108:111]
    ds_read_b64_tr_b16 v[50:51], v19 offset:2304
    s_add_u32 s54, s35, 294912
    s_add_u32 m0, s39, 73728
    s_nop 0
    buffer_load_dwordx4 v1, s[4:7], s54 offen offset:0 lds
    s_waitcnt lgkmcnt(7)
    v_mfma_f32_16x16x32_bf16 v[76:79], v[36:39], a[24:27], v[76:79]
    ds_read_b64_tr_b16 v[32:33], v19 offset:32
    v_mfma_f32_16x16x32_bf16 v[112:115], v[36:39], a[28:31], v[112:115]
    ds_read_b64_tr_b16 v[34:35], v19 offset:2336
    s_waitcnt lgkmcnt(6)
    v_mfma_f32_16x16x32_bf16 v[80:83], v[40:43], a[24:27], v[80:83]
    ds_read_b64_tr_b16 v[36:37], v19 offset:64
    v_mfma_f32_16x16x32_bf16 v[116:119], v[40:43], a[28:31], v[116:119]
    ds_read_b64_tr_b16 v[38:39], v19 offset:2368
    buffer_load_dwordx4 v2, s[4:7], s54 offen offset:1024 lds
    s_waitcnt lgkmcnt(6)
    v_mfma_f32_16x16x32_bf16 v[84:87], v[44:47], a[24:27], v[84:87]
    ds_read_b64_tr_b16 v[40:41], v19 offset:96
    v_mfma_f32_16x16x32_bf16 v[120:123], v[44:47], a[28:31], v[120:123]
    ds_read_b64_tr_b16 v[42:43], v19 offset:2400
    s_add_u32 s32, s37, 11264
    buffer_load_dwordx4 a[24:27], v23, s[12:15], s32 offen sc1
    buffer_load_dwordx4 a[28:31], v24, s[12:15], s32 offen sc1
    s_waitcnt vmcnt(51) lgkmcnt(6)
    v_mfma_f32_16x16x32_bf16 v[52:55], v[48:51], a[32:35], v[52:55]
    ds_read_b64_tr_b16 v[44:45], v19 offset:128
    v_mfma_f32_16x16x32_bf16 v[88:91], v[48:51], a[36:39], v[88:91]
    ds_read_b64_tr_b16 v[46:47], v19 offset:2432
    buffer_load_dwordx4 v3, s[4:7], s54 offen offset:2048 lds
    s_waitcnt lgkmcnt(6)
    v_mfma_f32_16x16x32_bf16 v[56:59], v[32:35], a[32:35], v[56:59]
    ds_read_b64_tr_b16 v[48:49], v19 offset:160
    v_mfma_f32_16x16x32_bf16 v[92:95], v[32:35], a[36:39], v[92:95]
    ds_read_b64_tr_b16 v[50:51], v19 offset:2464
    s_waitcnt lgkmcnt(6)
    v_mfma_f32_16x16x32_bf16 v[60:63], v[36:39], a[32:35], v[60:63]
    ds_read_b64_tr_b16 v[32:33], v19 offset:192
    v_mfma_f32_16x16x32_bf16 v[96:99], v[36:39], a[36:39], v[96:99]
    ds_read_b64_tr_b16 v[34:35], v19 offset:2496
    buffer_load_dwordx4 v4, s[4:7], s54 offen offset:3072 lds
    s_waitcnt lgkmcnt(6)
    v_mfma_f32_16x16x32_bf16 v[64:67], v[40:43], a[32:35], v[64:67]
    ds_read_b64_tr_b16 v[36:37], v19 offset:224
    v_mfma_f32_16x16x32_bf16 v[100:103], v[40:43], a[36:39], v[100:103]
    ds_read_b64_tr_b16 v[38:39], v19 offset:2528
    s_waitcnt lgkmcnt(6)
    v_mfma_f32_16x16x32_bf16 v[68:71], v[44:47], a[32:35], v[68:71]
    ds_read_b64_tr_b16 v[40:41], v19 offset:256
    v_mfma_f32_16x16x32_bf16 v[104:107], v[44:47], a[36:39], v[104:107]
    ds_read_b64_tr_b16 v[42:43], v19 offset:2560
    s_add_u32 m0, s39, 77824
    s_nop 0
    buffer_load_dwordx4 v5, s[4:7], s54 offen offset:0 lds
    s_waitcnt lgkmcnt(6)
    v_mfma_f32_16x16x32_bf16 v[72:75], v[48:51], a[32:35], v[72:75]
    ds_read_b64_tr_b16 v[44:45], v19 offset:9216
    v_mfma_f32_16x16x32_bf16 v[108:111], v[48:51], a[36:39], v[108:111]
    ds_read_b64_tr_b16 v[46:47], v19 offset:11520
    s_waitcnt lgkmcnt(6)
    v_mfma_f32_16x16x32_bf16 v[76:79], v[32:35], a[32:35], v[76:79]
    ds_read_b64_tr_b16 v[48:49], v19 offset:9248
    v_mfma_f32_16x16x32_bf16 v[112:115], v[32:35], a[36:39], v[112:115]
    ds_read_b64_tr_b16 v[50:51], v19 offset:11552
    buffer_load_dwordx4 v6, s[4:7], s54 offen offset:1024 lds
    s_waitcnt lgkmcnt(6)
    v_mfma_f32_16x16x32_bf16 v[80:83], v[36:39], a[32:35], v[80:83]
    ds_read_b64_tr_b16 v[32:33], v19 offset:9280
    v_mfma_f32_16x16x32_bf16 v[116:119], v[36:39], a[36:39], v[116:119]
    ds_read_b64_tr_b16 v[34:35], v19 offset:11584
    s_waitcnt lgkmcnt(6)
    v_mfma_f32_16x16x32_bf16 v[84:87], v[40:43], a[32:35], v[84:87]
    ds_read_b64_tr_b16 v[36:37], v19 offset:9312
    v_mfma_f32_16x16x32_bf16 v[120:123], v[40:43], a[36:39], v[120:123]
    ds_read_b64_tr_b16 v[38:39], v19 offset:11616
    buffer_load_dwordx4 v7, s[4:7], s54 offen offset:2048 lds
    s_add_u32 s32, s37, 20480
    buffer_load_dwordx4 a[32:35], v23, s[12:15], s32 offen sc1
    buffer_load_dwordx4 a[36:39], v24, s[12:15], s32 offen sc1
    s_waitcnt vmcnt(56) lgkmcnt(6)
    v_mfma_f32_16x16x32_bf16 v[52:55], v[44:47], a[40:43], v[52:55]
    ds_read_b64_tr_b16 v[40:41], v19 offset:9344
    v_mfma_f32_16x16x32_bf16 v[88:91], v[44:47], a[44:47], v[88:91]
    ds_read_b64_tr_b16 v[42:43], v19 offset:11648
    s_waitcnt lgkmcnt(6)
    v_mfma_f32_16x16x32_bf16 v[56:59], v[48:51], a[40:43], v[56:59]
    ds_read_b64_tr_b16 v[44:45], v19 offset:9376
    v_mfma_f32_16x16x32_bf16 v[92:95], v[48:51], a[44:47], v[92:95]
    ds_read_b64_tr_b16 v[46:47], v19 offset:11680
    buffer_load_dwordx4 v8, s[4:7], s54 offen offset:3072 lds
    s_waitcnt lgkmcnt(6)
    v_mfma_f32_16x16x32_bf16 v[60:63], v[32:35], a[40:43], v[60:63]
    ds_read_b64_tr_b16 v[48:49], v19 offset:9408
    v_mfma_f32_16x16x32_bf16 v[96:99], v[32:35], a[44:47], v[96:99]
    ds_read_b64_tr_b16 v[50:51], v19 offset:11712
    s_waitcnt lgkmcnt(6)
    v_mfma_f32_16x16x32_bf16 v[64:67], v[36:39], a[40:43], v[64:67]
    ds_read_b64_tr_b16 v[32:33], v19 offset:9440
    v_mfma_f32_16x16x32_bf16 v[100:103], v[36:39], a[44:47], v[100:103]
    ds_read_b64_tr_b16 v[34:35], v19 offset:11744
    s_add_u32 m0, s39, 81920
    s_nop 0
    buffer_load_dwordx4 v9, s[4:7], s54 offen offset:0 lds
    s_waitcnt lgkmcnt(6)
    v_mfma_f32_16x16x32_bf16 v[68:71], v[40:43], a[40:43], v[68:71]
    ds_read_b64_tr_b16 v[36:37], v19 offset:9472
    v_mfma_f32_16x16x32_bf16 v[104:107], v[40:43], a[44:47], v[104:107]
    ds_read_b64_tr_b16 v[38:39], v19 offset:11776
    s_waitcnt lgkmcnt(6)
    v_mfma_f32_16x16x32_bf16 v[72:75], v[44:47], a[40:43], v[72:75]
    ds_read_b64_tr_b16 v[40:41], v19 offset:18432
    v_mfma_f32_16x16x32_bf16 v[108:111], v[44:47], a[44:47], v[108:111]
    ds_read_b64_tr_b16 v[42:43], v19 offset:20736
    s_waitcnt lgkmcnt(6)
    v_mfma_f32_16x16x32_bf16 v[76:79], v[48:51], a[40:43], v[76:79]
    ds_read_b64_tr_b16 v[44:45], v19 offset:18464
    v_mfma_f32_16x16x32_bf16 v[112:115], v[48:51], a[44:47], v[112:115]
    ds_read_b64_tr_b16 v[46:47], v19 offset:20768
    s_waitcnt lgkmcnt(6)
    v_mfma_f32_16x16x32_bf16 v[80:83], v[32:35], a[40:43], v[80:83]
    ds_read_b64_tr_b16 v[48:49], v19 offset:18496
    v_mfma_f32_16x16x32_bf16 v[116:119], v[32:35], a[44:47], v[116:119]
    ds_read_b64_tr_b16 v[50:51], v19 offset:20800
    s_waitcnt lgkmcnt(6)
    v_mfma_f32_16x16x32_bf16 v[84:87], v[36:39], a[40:43], v[84:87]
    ds_read_b64_tr_b16 v[32:33], v19 offset:18528
    v_mfma_f32_16x16x32_bf16 v[120:123], v[36:39], a[44:47], v[120:123]
    ds_read_b64_tr_b16 v[34:35], v19 offset:20832
    s_add_u32 s32, s37, 21504
    buffer_load_dwordx4 a[40:43], v23, s[12:15], s32 offen sc1
    buffer_load_dwordx4 a[44:47], v24, s[12:15], s32 offen sc1
    s_waitcnt vmcnt(58) lgkmcnt(6)
    v_mfma_f32_16x16x32_bf16 v[52:55], v[40:43], a[48:51], v[52:55]
    ds_read_b64_tr_b16 v[36:37], v19 offset:18560
    v_mfma_f32_16x16x32_bf16 v[88:91], v[40:43], a[52:55], v[88:91]
    ds_read_b64_tr_b16 v[38:39], v19 offset:20864
    s_waitcnt lgkmcnt(6)
    v_mfma_f32_16x16x32_bf16 v[56:59], v[44:47], a[48:51], v[56:59]
    ds_read_b64_tr_b16 v[40:41], v19 offset:18592
    v_mfma_f32_16x16x32_bf16 v[92:95], v[44:47], a[52:55], v[92:95]
    ds_read_b64_tr_b16 v[42:43], v19 offset:20896
    s_waitcnt lgkmcnt(6)
    v_mfma_f32_16x16x32_bf16 v[60:63], v[48:51], a[48:51], v[60:63]
    ds_read_b64_tr_b16 v[44:45], v19 offset:18624
    v_mfma_f32_16x16x32_bf16 v[96:99], v[48:51], a[52:55], v[96:99]
    ds_read_b64_tr_b16 v[46:47], v19 offset:20928
    s_waitcnt lgkmcnt(6)
    v_mfma_f32_16x16x32_bf16 v[64:67], v[32:35], a[48:51], v[64:67]
    ds_read_b64_tr_b16 v[48:49], v19 offset:18656
    v_mfma_f32_16x16x32_bf16 v[100:103], v[32:35], a[52:55], v[100:103]
    ds_read_b64_tr_b16 v[50:51], v19 offset:20960
    s_waitcnt lgkmcnt(6)
    v_mfma_f32_16x16x32_bf16 v[68:71], v[36:39], a[48:51], v[68:71]
    ds_read_b64_tr_b16 v[32:33], v19 offset:18688
    v_mfma_f32_16x16x32_bf16 v[104:107], v[36:39], a[52:55], v[104:107]
    ds_read_b64_tr_b16 v[34:35], v19 offset:20992
    s_waitcnt vmcnt(23)
    s_mov_b64 exec, 1
    ds_add_u32 v29, v31
    s_mov_b64 exec, -1
    s_waitcnt lgkmcnt(7)
    v_mfma_f32_16x16x32_bf16 v[72:75], v[40:43], a[48:51], v[72:75]
    ds_read_b64_tr_b16 v[36:37], v19 offset:27648
    v_mfma_f32_16x16x32_bf16 v[108:111], v[40:43], a[52:55], v[108:111]
    ds_read_b64_tr_b16 v[38:39], v19 offset:29952
    s_waitcnt lgkmcnt(7)
    v_mfma_f32_16x16x32_bf16 v[76:79], v[44:47], a[48:51], v[76:79]
    ds_read_b64_tr_b16 v[40:41], v19 offset:27680
    v_mfma_f32_16x16x32_bf16 v[112:115], v[44:47], a[52:55], v[112:115]
    ds_read_b64_tr_b16 v[42:43], v19 offset:29984
    s_waitcnt lgkmcnt(7)
    v_mfma_f32_16x16x32_bf16 v[80:83], v[48:51], a[48:51], v[80:83]
    ds_read_b64_tr_b16 v[44:45], v19 offset:27712
    v_mfma_f32_16x16x32_bf16 v[116:119], v[48:51], a[52:55], v[116:119]
    ds_read_b64_tr_b16 v[46:47], v19 offset:30016
    s_mov_b32 s33, 16
    s_cmp_ge_u32 s33, 9
    s_cselect_b32 s34, 9, 0
    s_sub_u32 s33, s33, s34
    s_lshl_b32 s33, s33, 5
    s_lshl_b32 s34, s34, 11
    s_add_u32 s34, s34, s33
    s_add_u32 s34, s34, s57
    s_add_u32 s33, s33, s58
    buffer_load_dwordx2 a[112:113], v126, s[16:19], s34 offen
    buffer_load_dwordx2 a[114:115], v127, s[20:23], s33 offen
    s_mov_b32 s33, 17
    s_cmp_ge_u32 s33, 9
    s_cselect_b32 s34, 9, 0
    s_sub_u32 s33, s33, s34
    s_lshl_b32 s33, s33, 5
    s_lshl_b32 s34, s34, 11
    s_add_u32 s34, s34, s33
    s_add_u32 s34, s34, s57
    s_add_u32 s33, s33, s58
    buffer_load_dwordx2 a[116:117], v126, s[16:19], s34 offen
    buffer_load_dwordx2 a[118:119], v127, s[20:23], s33 offen
    s_waitcnt lgkmcnt(7)
    v_mfma_f32_16x16x32_bf16 v[84:87], v[32:35], a[48:51], v[84:87]
    ds_read_b64_tr_b16 v[48:49], v19 offset:27744
    v_mfma_f32_16x16x32_bf16 v[120:123], v[32:35], a[52:55], v[120:123]
    ds_read_b64_tr_b16 v[50:51], v19 offset:30048
    s_add_u32 s32, s37, 22528
    buffer_load_dwordx4 a[48:51], v23, s[12:15], s32 offen sc1
    buffer_load_dwordx4 a[52:55], v24, s[12:15], s32 offen sc1
    s_waitcnt vmcnt(60) lgkmcnt(6)
    v_mfma_f32_16x16x32_bf16 v[52:55], v[36:39], a[56:59], v[52:55]
    ds_read_b64_tr_b16 v[32:33], v19 offset:27776
    v_mfma_f32_16x16x32_bf16 v[88:91], v[36:39], a[60:63], v[88:91]
    ds_read_b64_tr_b16 v[34:35], v19 offset:30080
    s_waitcnt lgkmcnt(6)
    v_mfma_f32_16x16x32_bf16 v[56:59], v[40:43], a[56:59], v[56:59]
    ds_read_b64_tr_b16 v[36:37], v19 offset:27808
    v_mfma_f32_16x16x32_bf16 v[92:95], v[40:43], a[60:63], v[92:95]
    ds_read_b64_tr_b16 v[38:39], v19 offset:30112
    s_waitcnt lgkmcnt(6)
    v_mfma_f32_16x16x32_bf16 v[60:63], v[44:47], a[56:59], v[60:63]
    ds_read_b64_tr_b16 v[40:41], v19 offset:27840
    v_mfma_f32_16x16x32_bf16 v[96:99], v[44:47], a[60:63], v[96:99]
    ds_read_b64_tr_b16 v[42:43], v19 offset:30144
    ds_read_b32 v30, v29
    s_waitcnt lgkmcnt(7)
    v_mfma_f32_16x16x32_bf16 v[64:67], v[48:51], a[56:59], v[64:67]
    ds_read_b64_tr_b16 v[44:45], v19 offset:27872
    v_mfma_f32_16x16x32_bf16 v[100:103], v[48:51], a[60:63], v[100:103]
    ds_read_b64_tr_b16 v[46:47], v19 offset:30176
    s_waitcnt lgkmcnt(7)
    v_mfma_f32_16x16x32_bf16 v[68:71], v[32:35], a[56:59], v[68:71]
    ds_read_b64_tr_b16 v[48:49], v19 offset:27904
    v_mfma_f32_16x16x32_bf16 v[104:107], v[32:35], a[60:63], v[104:107]
    ds_read_b64_tr_b16 v[50:51], v19 offset:30208
    s_waitcnt lgkmcnt(7)
    v_mfma_f32_16x16x32_bf16 v[72:75], v[36:39], a[56:59], v[72:75]
    s_waitcnt lgkmcnt(4)
    v_cmp_gt_u32 vcc, 24, v30
    s_cbranch_vccz L_k2_c5_ok
L_k2_c5:
    ds_read_b32 v30, v29
    s_waitcnt lgkmcnt(0)
    v_cmp_gt_u32 vcc, 24, v30
    s_cbranch_vccnz L_k2_c5
L_k2_c5_ok:
    ds_read_b64_tr_b16 v[32:33], v20 offset:0
    v_mfma_f32_16x16x32_bf16 v[108:111], v[36:39], a[60:63], v[108:111]
    ds_read_b64_tr_b16 v[34:35], v20 offset:2304
    s_add_u32 s54, s35, 737280
    s_add_u32 m0, s39, 110592
    s_nop 0
    buffer_load_dwordx4 v1, s[4:7], s54 offen offset:0 lds
    s_waitcnt lgkmcnt(7)
    v_mfma_f32_16x16x32_bf16 v[76:79], v[40:43], a[56:59], v[76:79]
    ds_read_b64_tr_b16 v[36:37], v20 offset:32
    v_mfma_f32_16x16x32_bf16 v[112:115], v[40:43], a[60:63], v[112:115]
    ds_read_b64_tr_b16 v[38:39], v20 offset:2336
    s_waitcnt lgkmcnt(6)
    v_mfma_f32_16x16x32_bf16 v[80:83], v[44:47], a[56:59], v[80:83]
    ds_read_b64_tr_b16 v[40:41], v20 offset:64
    v_mfma_f32_16x16x32_bf16 v[116:119], v[44:47], a[60:63], v[116:119]
    ds_read_b64_tr_b16 v[42:43], v20 offset:2368
    buffer_load_dwordx4 v2, s[4:7], s54 offen offset:1024 lds
    s_waitcnt lgkmcnt(6)
    v_mfma_f32_16x16x32_bf16 v[84:87], v[48:51], a[56:59], v[84:87]
    ds_read_b64_tr_b16 v[44:45], v20 offset:96
    v_mfma_f32_16x16x32_bf16 v[120:123], v[48:51], a[60:63], v[120:123]
    ds_read_b64_tr_b16 v[46:47], v20 offset:2400
    s_add_u32 s32, s37, 23552
    buffer_load_dwordx4 a[56:59], v23, s[12:15], s32 offen sc1
    buffer_load_dwordx4 a[60:63], v24, s[12:15], s32 offen sc1
    s_waitcnt vmcnt(57) lgkmcnt(6)
    v_mfma_f32_16x16x32_bf16 v[52:55], v[32:35], a[64:67], v[52:55]
    ds_read_b64_tr_b16 v[48:49], v20 offset:128
    v_mfma_f32_16x16x32_bf16 v[88:91], v[32:35], a[68:71], v[88:91]
    ds_read_b64_tr_b16 v[50:51], v20 offset:2432
    buffer_load_dwordx4 v3, s[4:7], s54 offen offset:2048 lds
    s_waitcnt lgkmcnt(6)
    v_mfma_f32_16x16x32_bf16 v[56:59], v[36:39], a[64:67], v[56:59]
    ds_read_b64_tr_b16 v[32:33], v20 offset:160
    v_mfma_f32_16x16x32_bf16 v[92:95], v[36:39], a[68:71], v[92:95]
    ds_read_b64_tr_b16 v[34:35], v20 offset:2464
    s_waitcnt lgkmcnt(6)
    v_mfma_f32_16x16x32_bf16 v[60:63], v[40:43], a[64:67], v[60:63]
    ds_read_b64_tr_b16 v[36:37], v20 offset:192
    v_mfma_f32_16x16x32_bf16 v[96:99], v[40:43], a[68:71], v[96:99]
    ds_read_b64_tr_b16 v[38:39], v20 offset:2496
    buffer_load_dwordx4 v4, s[4:7], s54 offen offset:3072 lds
    s_waitcnt lgkmcnt(6)
    v_mfma_f32_16x16x32_bf16 v[64:67], v[44:47], a[64:67], v[64:67]
    ds_read_b64_tr_b16 v[40:41], v20 offset:224
    v_mfma_f32_16x16x32_bf16 v[100:103], v[44:47], a[68:71], v[100:103]
    ds_read_b64_tr_b16 v[42:43], v20 offset:2528
    s_waitcnt lgkmcnt(6)
    v_mfma_f32_16x16x32_bf16 v[68:71], v[48:51], a[64:67], v[68:71]
    ds_read_b64_tr_b16 v[44:45], v20 offset:256
    v_mfma_f32_16x16x32_bf16 v[104:107], v[48:51], a[68:71], v[104:107]
    ds_read_b64_tr_b16 v[46:47], v20 offset:2560
    s_add_u32 m0, s39, 114688
    s_nop 0
    buffer_load_dwordx4 v5, s[4:7], s54 offen offset:0 lds
    s_waitcnt lgkmcnt(6)
    v_mfma_f32_16x16x32_bf16 v[72:75], v[32:35], a[64:67], v[72:75]
    ds_read_b64_tr_b16 v[48:49], v20 offset:9216
    v_mfma_f32_16x16x32_bf16 v[108:111], v[32:35], a[68:71], v[108:111]
    ds_read_b64_tr_b16 v[50:51], v20 offset:11520
    s_waitcnt lgkmcnt(6)
    v_mfma_f32_16x16x32_bf16 v[76:79], v[36:39], a[64:67], v[76:79]
    ds_read_b64_tr_b16 v[32:33], v20 offset:9248
    v_mfma_f32_16x16x32_bf16 v[112:115], v[36:39], a[68:71], v[112:115]
    ds_read_b64_tr_b16 v[34:35], v20 offset:11552
    buffer_load_dwordx4 v6, s[4:7], s54 offen offset:1024 lds
    s_waitcnt lgkmcnt(6)
    v_mfma_f32_16x16x32_bf16 v[80:83], v[40:43], a[64:67], v[80:83]
    ds_read_b64_tr_b16 v[36:37], v20 offset:9280
    v_mfma_f32_16x16x32_bf16 v[116:119], v[40:43], a[68:71], v[116:119]
    ds_read_b64_tr_b16 v[38:39], v20 offset:11584
    s_waitcnt lgkmcnt(6)
    v_mfma_f32_16x16x32_bf16 v[84:87], v[44:47], a[64:67], v[84:87]
    ds_read_b64_tr_b16 v[40:41], v20 offset:9312
    v_mfma_f32_16x16x32_bf16 v[120:123], v[44:47], a[68:71], v[120:123]
    ds_read_b64_tr_b16 v[42:43], v20 offset:11616
    buffer_load_dwordx4 v7, s[4:7], s54 offen offset:2048 lds
    s_add_u32 s32, s37, 32768
    buffer_load_dwordx4 a[64:67], v23, s[12:15], s32 offen sc1
    buffer_load_dwordx4 a[68:71], v24, s[12:15], s32 offen sc1
    s_waitcnt vmcnt(59) lgkmcnt(6)
    v_mfma_f32_16x16x32_bf16 v[52:55], v[48:51], a[72:75], v[52:55]
    ds_read_b64_tr_b16 v[44:45], v20 offset:9344
    v_mfma_f32_16x16x32_bf16 v[88:91], v[48:51], a[76:79], v[88:91]
    ds_read_b64_tr_b16 v[46:47], v20 offset:11648
    s_waitcnt lgkmcnt(6)
    v_mfma_f32_16x16x32_bf16 v[56:59], v[32:35], a[72:75], v[56:59]
    ds_read_b64_tr_b16 v[48:49], v20 offset:9376
    v_mfma_f32_16x16x32_bf16 v[92:95], v[32:35], a[76:79], v[92:95]
    ds_read_b64_tr_b16 v[50:51], v20 offset:11680
    buffer_load_dwordx4 v8, s[4:7], s54 offen offset:3072 lds
    s_waitcnt lgkmcnt(6)
    v_mfma_f32_16x16x32_bf16 v[60:63], v[36:39], a[72:75], v[60:63]
    ds_read_b64_tr_b16 v[32:33], v20 offset:9408
    v_mfma_f32_16x16x32_bf16 v[96:99], v[36:39], a[76:79], v[96:99]
    ds_read_b64_tr_b16 v[34:35], v20 offset:11712
    s_waitcnt lgkmcnt(6)
    v_mfma_f32_16x16x32_bf16 v[64:67], v[40:43], a[72:75], v[64:67]
    ds_read_b64_tr_b16 v[36:37], v20 offset:9440
    v_mfma_f32_16x16x32_bf16 v[100:103], v[40:43], a[76:79], v[100:103]
    ds_read_b64_tr_b16 v[38:39], v20 offset:11744
    s_add_u32 m0, s39, 118784
    s_nop 0
    buffer_load_dwordx4 v9, s[4:7], s54 offen offset:0 lds
    s_waitcnt lgkmcnt(6)
    v_mfma_f32_16x16x32_bf16 v[68:71], v[44:47], a[72:75], v[68:71]
    ds_read_b64_tr_b16 v[40:41], v20 offset:9472
    v_mfma_f32_16x16x32_bf16 v[104:107], v[44:47], a[76:79], v[104:107]
    ds_read_b64_tr_b16 v[42:43], v20 offset:11776
    s_waitcnt lgkmcnt(6)
    v_mfma_f32_16x16x32_bf16 v[72:75], v[48:51], a[72:75], v[72:75]
    ds_read_b64_tr_b16 v[44:45], v20 offset:18432
    v_mfma_f32_16x16x32_bf16 v[108:111], v[48:51], a[76:79], v[108:111]
    ds_read_b64_tr_b16 v[46:47], v20 offset:20736
    s_waitcnt lgkmcnt(6)
    v_mfma_f32_16x16x32_bf16 v[76:79], v[32:35], a[72:75], v[76:79]
    ds_read_b64_tr_b16 v[48:49], v20 offset:18464
    v_mfma_f32_16x16x32_bf16 v[112:115], v[32:35], a[76:79], v[112:115]
    ds_read_b64_tr_b16 v[50:51], v20 offset:20768
    s_waitcnt lgkmcnt(6)
    v_mfma_f32_16x16x32_bf16 v[80:83], v[36:39], a[72:75], v[80:83]
    ds_read_b64_tr_b16 v[32:33], v20 offset:18496
    v_mfma_f32_16x16x32_bf16 v[116:119], v[36:39], a[76:79], v[116:119]
    ds_read_b64_tr_b16 v[34:35], v20 offset:20800
    s_waitcnt lgkmcnt(6)
    v_mfma_f32_16x16x32_bf16 v[84:87], v[40:43], a[72:75], v[84:87]
    ds_read_b64_tr_b16 v[36:37], v20 offset:18528
    v_mfma_f32_16x16x32_bf16 v[120:123], v[40:43], a[76:79], v[120:123]
    ds_read_b64_tr_b16 v[38:39], v20 offset:20832
    s_add_u32 s32, s37, 33792
    buffer_load_dwordx4 a[72:75], v23, s[12:15], s32 offen sc1
    buffer_load_dwordx4 a[76:79], v24, s[12:15], s32 offen sc1
    s_waitcnt vmcnt(57) lgkmcnt(6)
    v_mfma_f32_16x16x32_bf16 v[52:55], v[44:47], a[80:83], v[52:55]
    ds_read_b64_tr_b16 v[40:41], v20 offset:18560
    v_mfma_f32_16x16x32_bf16 v[88:91], v[44:47], a[84:87], v[88:91]
    ds_read_b64_tr_b16 v[42:43], v20 offset:20864
    s_waitcnt lgkmcnt(6)
    v_mfma_f32_16x16x32_bf16 v[56:59], v[48:51], a[80:83], v[56:59]
    ds_read_b64_tr_b16 v[44:45], v20 offset:18592
    v_mfma_f32_16x16x32_bf16 v[92:95], v[48:51], a[84:87], v[92:95]
    ds_read_b64_tr_b16 v[46:47], v20 offset:20896
    s_waitcnt lgkmcnt(6)
    v_mfma_f32_16x16x32_bf16 v[60:63], v[32:35], a[80:83], v[60:63]
    ds_read_b64_tr_b16 v[48:49], v20 offset:18624
    v_mfma_f32_16x16x32_bf16 v[96:99], v[32:35], a[84:87], v[96:99]
    ds_read_b64_tr_b16 v[50:51], v20 offset:20928
    s_waitcnt lgkmcnt(6)
    v_mfma_f32_16x16x32_bf16 v[64:67], v[36:39], a[80:83], v[64:67]
    ds_read_b64_tr_b16 v[32:33], v20 offset:18656
    v_mfma_f32_16x16x32_bf16 v[100:103], v[36:39], a[84:87], v[100:103]
    ds_read_b64_tr_b16 v[34:35], v20 offset:20960
    s_waitcnt lgkmcnt(6)
    v_mfma_f32_16x16x32_bf16 v[68:71], v[40:43], a[80:83], v[68:71]
    ds_read_b64_tr_b16 v[36:37], v20 offset:18688
    v_mfma_f32_16x16x32_bf16 v[104:107], v[40:43], a[84:87], v[104:107]
    ds_read_b64_tr_b16 v[38:39], v20 offset:20992
    s_waitcnt vmcnt(23)
    s_mov_b64 exec, 1
    ds_add_u32 v29, v31
    s_mov_b64 exec, -1
    s_waitcnt lgkmcnt(7)
    v_mfma_f32_16x16x32_bf16 v[72:75], v[44:47], a[80:83], v[72:75]
    ds_read_b64_tr_b16 v[40:41], v20 offset:27648
    v_mfma_f32_16x16x32_bf16 v[108:111], v[44:47], a[84:87], v[108:111]
    ds_read_b64_tr_b16 v[42:43], v20 offset:29952
    s_waitcnt lgkmcnt(7)
    v_mfma_f32_16x16x32_bf16 v[76:79], v[48:51], a[80:83], v[76:79]
    ds_read_b64_tr_b16 v[44:45], v20 offset:27680
    v_mfma_f32_16x16x32_bf16 v[112:115], v[48:51], a[84:87], v[112:115]
    ds_read_b64_tr_b16 v[46:47], v20 offset:29984
    s_waitcnt lgkmcnt(7)
    v_mfma_f32_16x16x32_bf16 v[80:83], v[32:35], a[80:83], v[80:83]
    ds_read_b64_tr_b16 v[48:49], v20 offset:27712
    v_mfma_f32_16x16x32_bf16 v[116:119], v[32:35], a[84:87], v[116:119]
    ds_read_b64_tr_b16 v[50:51], v20 offset:30016
    s_waitcnt lgkmcnt(7)
    v_mfma_f32_16x16x32_bf16 v[84:87], v[36:39], a[80:83], v[84:87]
    ds_read_b64_tr_b16 v[32:33], v20 offset:27744
    v_mfma_f32_16x16x32_bf16 v[120:123], v[36:39], a[84:87], v[120:123]
    ds_read_b64_tr_b16 v[34:35], v20 offset:30048
    s_add_u32 s32, s37, 34816
    buffer_load_dwordx4 a[80:83], v23, s[12:15], s32 offen sc1
    buffer_load_dwordx4 a[84:87], v24, s[12:15], s32 offen sc1
    s_waitcnt vmcnt(55) lgkmcnt(6)
    v_mfma_f32_16x16x32_bf16 v[52:55], v[40:43], a[88:91], v[52:55]
    ds_read_b64_tr_b16 v[36:37], v20 offset:27776
    v_mfma_f32_16x16x32_bf16 v[88:91], v[40:43], a[92:95], v[88:91]
    ds_read_b64_tr_b16 v[38:39], v20 offset:30080
    s_waitcnt lgkmcnt(6)
    v_mfma_f32_16x16x32_bf16 v[56:59], v[44:47], a[88:91], v[56:59]
    ds_read_b64_tr_b16 v[40:41], v20 offset:27808
    v_mfma_f32_16x16x32_bf16 v[92:95], v[44:47], a[92:95], v[92:95]
    ds_read_b64_tr_b16 v[42:43], v20 offset:30112
    s_waitcnt lgkmcnt(6)
    v_mfma_f32_16x16x32_bf16 v[60:63], v[48:51], a[88:91], v[60:63]
    ds_read_b64_tr_b16 v[44:45], v20 offset:27840
    v_mfma_f32_16x16x32_bf16 v[96:99], v[48:51], a[92:95], v[96:99]
    ds_read_b64_tr_b16 v[46:47], v20 offset:30144
    ds_read_b32 v30, v29
    s_waitcnt lgkmcnt(7)
    v_mfma_f32_16x16x32_bf16 v[64:67], v[32:35], a[88:91], v[64:67]
    ds_read_b64_tr_b16 v[48:49], v20 offset:27872
    v_mfma_f32_16x16x32_bf16 v[100:103], v[32:35], a[92:95], v[100:103]
    ds_read_b64_tr_b16 v[50:51], v20 offset:30176
    s_waitcnt lgkmcnt(7)
    v_mfma_f32_16x16x32_bf16 v[68:71], v[36:39], a[88:91], v[68:71]
    ds_read_b64_tr_b16 v[32:33], v20 offset:27904
    v_mfma_f32_16x16x32_bf16 v[104:107], v[36:39], a[92:95], v[104:107]
    ds_read_b64_tr_b16 v[34:35], v20 offset:30208
    s_waitcnt lgkmcnt(7)
    v_mfma_f32_16x16x32_bf16 v[72:75], v[40:43], a[88:91], v[72:75]
    s_waitcnt lgkmcnt(4)
    v_cmp_gt_u32 vcc, 28, v30
    s_cbranch_vccz L_k2_c6_ok
L_k2_c6:
    ds_read_b32 v30, v29
    s_waitcnt lgkmcnt(0)
    v_cmp_gt_u32 vcc, 28, v30
    s_cbranch_vccnz L_k2_c6
L_k2_c6_ok:
    ds_read_b64_tr_b16 v[36:37], v21 offset:0
    v_mfma_f32_16x16x32_bf16 v[108:111], v[40:43], a[92:95], v[108:111]
    ds_read_b64_tr_b16 v[38:39], v21 offset:2304
    s_add_u32 s54, s35, 1179648
    s_add_u32 m0, s39, 0
    s_nop 0
    buffer_load_dwordx4 v1, s[4:7], s54 offen offset:0 lds
    s_waitcnt lgkmcnt(7)
    v_mfma_f32_16x16x32_bf16 v[76:79], v[44:47], a[88:91], v[76:79]
    ds_read_b64_tr_b16 v[40:41], v21 offset:32
    v_mfma_f32_16x16x32_bf16 v[112:115], v[44:47], a[92:95], v[112:115]
    ds_read_b64_tr_b16 v[42:43], v21 offset:2336
    s_waitcnt lgkmcnt(6)
    v_mfma_f32_16x16x32_bf16 v[80:83], v[48:51], a[88:91], v[80:83]
    ds_read_b64_tr_b16 v[44:45], v21 offset:64
    v_mfma_f32_16x16x32_bf16 v[116:119], v[48:51], a[92:95], v[116:119]
    ds_read_b64_tr_b16 v[46:47], v21 offset:2368
    buffer_load_dwordx4 v2, s[4:7], s54 offen offset:1024 lds
    s_waitcnt lgkmcnt(6)
    v_mfma_f32_16x16x32_bf16 v[84:87], v[32:35], a[88:91], v[84:87]
    ds_read_b64_tr_b16 v[48:49], v21 offset:96
    v_mfma_f32_16x16x32_bf16 v[120:123], v[32:35], a[92:95], v[120:123]
    ds_read_b64_tr_b16 v[50:51], v21 offset:2400
    s_add_u32 s32, s37, 35840
    buffer_load_dwordx4 a[88:91], v23, s[12:15], s32 offen sc1
    buffer_load_dwordx4 a[92:95], v24, s[12:15], s32 offen sc1
    s_waitcnt vmcnt(52) lgkmcnt(6)
    v_mfma_f32_16x16x32_bf16 v[52:55], v[36:39], a[0:3], v[52:55]
    ds_read_b64_tr_b16 v[32:33], v21 offset:128
    v_mfma_f32_16x16x32_bf16 v[88:91], v[36:39], a[4:7], v[88:91]
    ds_read_b64_tr_b16 v[34:35], v21 offset:2432
    buffer_load_dwordx4 v3, s[4:7], s54 offen offset:2048 lds
    s_waitcnt lgkmcnt(6)
    v_mfma_f32_16x16x32_bf16 v[56:59], v[40:43], a[0:3], v[56:59]
    ds_read_b64_tr_b16 v[36:37], v21 offset:160
    v_mfma_f32_16x16x32_bf16 v[92:95], v[40:43], a[4:7], v[92:95]
    ds_read_b64_tr_b16 v[38:39], v21 offset:2464
    s_waitcnt lgkmcnt(6)
    v_mfma_f32_16x16x32_bf16 v[60:63], v[44:47], a[0:3], v[60:63]
    ds_read_b64_tr_b16 v[40:41], v21 offset:192
    v_mfma_f32_16x16x32_bf16 v[96:99], v[44:47], a[4:7], v[96:99]
    ds_read_b64_tr_b16 v[42:43], v21 offset:2496
    buffer_load_dwordx4 v4, s[4:7], s54 offen offset:3072 lds
    s_waitcnt lgkmcnt(6)
    v_mfma_f32_16x16x32_bf16 v[64:67], v[48:51], a[0:3], v[64:67]
    ds_read_b64_tr_b16 v[44:45], v21 offset:224
    v_mfma_f32_16x16x32_bf16 v[100:103], v[48:51], a[4:7], v[100:103]
    ds_read_b64_tr_b16 v[46:47], v21 offset:2528
    s_waitcnt lgkmcnt(6)
    v_mfma_f32_16x16x32_bf16 v[68:71], v[32:35], a[0:3], v[68:71]
    ds_read_b64_tr_b16 v[48:49], v21 offset:256
    v_mfma_f32_16x16x32_bf16 v[104:107], v[32:35], a[4:7], v[104:107]
    ds_read_b64_tr_b16 v[50:51], v21 offset:2560
    s_add_u32 m0, s39, 4096
    s_nop 0
    buffer_load_dwordx4 v5, s[4:7], s54 offen offset:0 lds
    s_waitcnt lgkmcnt(6)
    v_mfma_f32_16x16x32_bf16 v[72:75], v[36:39], a[0:3], v[72:75]
    ds_read_b64_tr_b16 v[32:33], v21 offset:9216
    v_mfma_f32_16x16x32_bf16 v[108:111], v[36:39], a[4:7], v[108:111]
    ds_read_b64_tr_b16 v[34:35], v21 offset:11520
    s_waitcnt lgkmcnt(6)
    v_mfma_f32_16x16x32_bf16 v[76:79], v[40:43], a[0:3], v[76:79]
    ds_read_b64_tr_b16 v[36:37], v21 offset:9248
    v_mfma_f32_16x16x32_bf16 v[112:115], v[40:43], a[4:7], v[112:115]
    ds_read_b64_tr_b16 v[38:39], v21 offset:11552
    buffer_load_dwordx4 v6, s[4:7], s54 offen offset:1024 lds
    s_waitcnt lgkmcnt(6)
    v_mfma_f32_16x16x32_bf16 v[80:83], v[44:47], a[0:3], v[80:83]
    ds_read_b64_tr_b16 v[40:41], v21 offset:9280
    v_mfma_f32_16x16x32_bf16 v[116:119], v[44:47], a[4:7], v[116:119]
    ds_read_b64_tr_b16 v[42:43], v21 offset:11584
    s_waitcnt lgkmcnt(6)
    v_mfma_f32_16x16x32_bf16 v[84:87], v[48:51], a[0:3], v[84:87]
    ds_read_b64_tr_b16 v[44:45], v21 offset:9312
    v_mfma_f32_16x16x32_bf16 v[120:123], v[48:51], a[4:7], v[120:123]
    ds_read_b64_tr_b16 v[46:47], v21 offset:11616
    buffer_load_dwordx4 v7, s[4:7], s54 offen offset:2048 lds
    s_waitcnt vmcnt(53) lgkmcnt(6)
    v_mfma_f32_16x16x32_bf16 v[52:55], v[32:35], a[8:11], v[52:55]
    ds_read_b64_tr_b16 v[48:49], v21 offset:9344
    v_mfma_f32_16x16x32_bf16 v[88:91], v[32:35], a[12:15], v[88:91]
    ds_read_b64_tr_b16 v[50:51], v21 offset:11648
    s_waitcnt lgkmcnt(6)
    v_mfma_f32_16x16x32_bf16 v[56:59], v[36:39], a[8:11], v[56:59]
    ds_read_b64_tr_b16 v[32:33], v21 offset:9376
    v_mfma_f32_16x16x32_bf16 v[92:95], v[36:39], a[12:15], v[92:95]
    ds_read_b64_tr_b16 v[34:35], v21 offset:11680
    buffer_load_dwordx4 v8, s[4:7], s54 offen offset:3072 lds
    s_waitcnt lgkmcnt(6)
    v_mfma_f32_16x16x32_bf16 v[60:63], v[40:43], a[8:11], v[60:63]
    ds_read_b64_tr_b16 v[36:37], v21 offset:9408
    v_mfma_f32_16x16x32_bf16 v[96:99], v[40:43], a[12:15], v[96:99]
    ds_read_b64_tr_b16 v[38:39], v21 offset:11712
    s_waitcnt lgkmcnt(6)
    v_mfma_f32_16x16x32_bf16 v[64:67], v[44:47], a[8:11], v[64:67]
    ds_read_b64_tr_b16 v[40:41], v21 offset:9440
    v_mfma_f32_16x16x32_bf16 v[100:103], v[44:47], a[12:15], v[100:103]
    ds_read_b64_tr_b16 v[42:43], v21 offset:11744
    s_add_u32 m0, s39, 8192
    s_nop 0
    buffer_load_dwordx4 v9, s[4:7], s54 offen offset:0 lds
    s_waitcnt lgkmcnt(6)
    v_mfma_f32_16x16x32_bf16 v[68:71], v[48:51], a[8:11], v[68:71]
    ds_read_b64_tr_b16 v[44:45], v21 offset:9472
    v_mfma_f32_16x16x32_bf16 v[104:107], v[48:51], a[12:15], v[104:107]
    ds_read_b64_tr_b16 v[46:47], v21 offset:11776
    s_waitcnt lgkmcnt(6)
    v_mfma_f32_16x16x32_bf16 v[72:75], v[32:35], a[8:11], v[72:75]
    ds_read_b64_tr_b16 v[48:49], v21 offset:18432
    v_mfma_f32_16x16x32_bf16 v[108:111], v[32:35], a[12:15], v[108:111]
    ds_read_b64_tr_b16 v[50:51], v21 offset:20736
    s_waitcnt lgkmcnt(6)
    v_mfma_f32_16x16x32_bf16 v[76:79], v[36:39], a[8:11], v[76:79]
    ds_read_b64_tr_b16 v[32:33], v21 offset:18464
    v_mfma_f32_16x16x32_bf16 v[112:115], v[36:39], a[12:15], v[112:115]
    ds_read_b64_tr_b16 v[34:35], v21 offset:20768
    s_waitcnt lgkmcnt(6)
    v_mfma_f32_16x16x32_bf16 v[80:83], v[40:43], a[8:11], v[80:83]
    ds_read_b64_tr_b16 v[36:37], v21 offset:18496
    v_mfma_f32_16x16x32_bf16 v[116:119], v[40:43], a[12:15], v[116:119]
    ds_read_b64_tr_b16 v[38:39], v21 offset:20800
    s_waitcnt lgkmcnt(6)
    v_mfma_f32_16x16x32_bf16 v[84:87], v[44:47], a[8:11], v[84:87]
    ds_read_b64_tr_b16 v[40:41], v21 offset:18528
    v_mfma_f32_16x16x32_bf16 v[120:123], v[44:47], a[12:15], v[120:123]
    ds_read_b64_tr_b16 v[42:43], v21 offset:20832
    s_waitcnt vmcnt(49) lgkmcnt(6)
    v_mfma_f32_16x16x32_bf16 v[52:55], v[48:51], a[16:19], v[52:55]
    ds_read_b64_tr_b16 v[44:45], v21 offset:18560
    v_mfma_f32_16x16x32_bf16 v[88:91], v[48:51], a[20:23], v[88:91]
    ds_read_b64_tr_b16 v[46:47], v21 offset:20864
    s_waitcnt lgkmcnt(6)
    v_mfma_f32_16x16x32_bf16 v[56:59], v[32:35], a[16:19], v[56:59]
    ds_read_b64_tr_b16 v[48:49], v21 offset:18592
    v_mfma_f32_16x16x32_bf16 v[92:95], v[32:35], a[20:23], v[92:95]
    ds_read_b64_tr_b16 v[50:51], v21 offset:20896
    s_waitcnt lgkmcnt(6)
    v_mfma_f32_16x16x32_bf16 v[60:63], v[36:39], a[16:19], v[60:63]
    ds_read_b64_tr_b16 v[32:33], v21 offset:18624
    v_mfma_f32_16x16x32_bf16 v[96:99], v[36:39], a[20:23], v[96:99]
    ds_read_b64_tr_b16 v[34:35], v21 offset:20928
    s_waitcnt lgkmcnt(6)
    v_mfma_f32_16x16x32_bf16 v[64:67], v[40:43], a[16:19], v[64:67]
    ds_read_b64_tr_b16 v[36:37], v21 offset:18656
    v_mfma_f32_16x16x32_bf16 v[100:103], v[40:43], a[20:23], v[100:103]
    ds_read_b64_tr_b16 v[38:39], v21 offset:20960
    s_waitcnt lgkmcnt(6)
    v_mfma_f32_16x16x32_bf16 v[68:71], v[44:47], a[16:19], v[68:71]
    ds_read_b64_tr_b16 v[40:41], v21 offset:18688
    v_mfma_f32_16x16x32_bf16 v[104:107], v[44:47], a[20:23], v[104:107]
    ds_read_b64_tr_b16 v[42:43], v21 offset:20992
    s_waitcnt vmcnt(15)
    s_mov_b64 exec, 1
    ds_add_u32 v29, v31
    s_mov_b64 exec, -1
    s_waitcnt lgkmcnt(7)
    v_mfma_f32_16x16x32_bf16 v[72:75], v[48:51], a[16:19], v[72:75]
    ds_read_b64_tr_b16 v[44:45], v21 offset:27648
    v_mfma_f32_16x16x32_bf16 v[108:111], v[48:51], a[20:23], v[108:111]
    ds_read_b64_tr_b16 v[46:47], v21 offset:29952
    s_waitcnt lgkmcnt(7)
    v_mfma_f32_16x16x32_bf16 v[76:79], v[32:35], a[16:19], v[76:79]
    ds_read_b64_tr_b16 v[48:49], v21 offset:27680
    v_mfma_f32_16x16x32_bf16 v[112:115], v[32:35], a[20:23], v[112:115]
    ds_read_b64_tr_b16 v[50:51], v21 offset:29984
    s_waitcnt lgkmcnt(7)
    v_mfma_f32_16x16x32_bf16 v[80:83], v[36:39], a[16:19], v[80:83]
    ds_read_b64_tr_b16 v[32:33], v21 offset:27712
    v_mfma_f32_16x16x32_bf16 v[116:119], v[36:39], a[20:23], v[116:119]
    ds_read_b64_tr_b16 v[34:35], v21 offset:30016
    s_waitcnt lgkmcnt(7)
    v_mfma_f32_16x16x32_bf16 v[84:87], v[40:43], a[16:19], v[84:87]
    ds_read_b64_tr_b16 v[36:37], v21 offset:27744
    v_mfma_f32_16x16x32_bf16 v[120:123], v[40:43], a[20:23], v[120:123]
    ds_read_b64_tr_b16 v[38:39], v21 offset:30048
    s_waitcnt vmcnt(45) lgkmcnt(6)
    v_mfma_f32_16x16x32_bf16 v[52:55], v[44:47], a[24:27], v[52:55]
    ds_read_b64_tr_b16 v[40:41], v21 offset:27776
    v_mfma_f32_16x16x32_bf16 v[88:91], v[44:47], a[28:31], v[88:91]
    ds_read_b64_tr_b16 v[42:43], v21 offset:30080
    s_waitcnt lgkmcnt(6)
    v_mfma_f32_16x16x32_bf16 v[56:59], v[48:51], a[24:27], v[56:59]
    ds_read_b64_tr_b16 v[44:45], v21 offset:27808
    v_mfma_f32_16x16x32_bf16 v[92:95], v[48:51], a[28:31], v[92:95]
    ds_read_b64_tr_b16 v[46:47], v21 offset:30112
    s_waitcnt lgkmcnt(6)
    v_mfma_f32_16x16x32_bf16 v[60:63], v[32:35], a[24:27], v[60:63]
    ds_read_b64_tr_b16 v[48:49], v21 offset:27840
    v_mfma_f32_16x16x32_bf16 v[96:99], v[32:35], a[28:31], v[96:99]
    ds_read_b64_tr_b16 v[50:51], v21 offset:30144
    ds_read_b32 v30, v29
    s_waitcnt lgkmcnt(7)
    v_mfma_f32_16x16x32_bf16 v[64:67], v[36:39], a[24:27], v[64:67]
    ds_read_b64_tr_b16 v[32:33], v21 offset:27872
    v_mfma_f32_16x16x32_bf16 v[100:103], v[36:39], a[28:31], v[100:103]
    ds_read_b64_tr_b16 v[34:35], v21 offset:30176
    s_waitcnt lgkmcnt(7)
    v_mfma_f32_16x16x32_bf16 v[68:71], v[40:43], a[24:27], v[68:71]
    ds_read_b64_tr_b16 v[36:37], v21 offset:27904
    v_mfma_f32_16x16x32_bf16 v[104:107], v[40:43], a[28:31], v[104:107]
    ds_read_b64_tr_b16 v[38:39], v21 offset:30208
    s_waitcnt lgkmcnt(7)
    v_mfma_f32_16x16x32_bf16 v[72:75], v[44:47], a[24:27], v[72:75]
    s_waitcnt lgkmcnt(4)
    v_cmp_gt_u32 vcc, 32, v30
    s_cbranch_vccz L_k2_c7_ok
L_k2_c7:
    ds_read_b32 v30, v29
    s_waitcnt lgkmcnt(0)
    v_cmp_gt_u32 vcc, 32, v30
    s_cbranch_vccnz L_k2_c7
L_k2_c7_ok:
    ds_read_b64_tr_b16 v[40:41], v22 offset:0
    v_mfma_f32_16x16x32_bf16 v[108:111], v[44:47], a[28:31], v[108:111]
    ds_read_b64_tr_b16 v[42:43], v22 offset:2304
    s_mov_b32 s54, s36
    s_add_u32 m0, s39, 36864
    s_nop 0
    buffer_load_dwordx4 v10, s[8:11], s54 offen offset:0 lds
    s_waitcnt lgkmcnt(7)
    v_mfma_f32_16x16x32_bf16 v[76:79], v[48:51], a[24:27], v[76:79]
    ds_read_b64_tr_b16 v[44:45], v22 offset:32
    v_mfma_f32_16x16x32_bf16 v[112:115], v[48:51], a[28:31], v[112:115]
    ds_read_b64_tr_b16 v[46:47], v22 offset:2336
    s_waitcnt lgkmcnt(6)
    v_mfma_f32_16x16x32_bf16 v[80:83], v[32:35], a[24:27], v[80:83]
    ds_read_b64_tr_b16 v[48:49], v22 offset:64
    v_mfma_f32_16x16x32_bf16 v[116:119], v[32:35], a[28:31], v[116:119]
    ds_read_b64_tr_b16 v[50:51], v22 offset:2368
    buffer_load_dwordx4 v11, s[8:11], s54 offen offset:1024 lds
    s_waitcnt lgkmcnt(6)
    v_mfma_f32_16x16x32_bf16 v[84:87], v[36:39], a[24:27], v[84:87]
    ds_read_b64_tr_b16 v[32:33], v22 offset:96
    v_mfma_f32_16x16x32_bf16 v[120:123], v[36:39], a[28:31], v[120:123]
    ds_read_b64_tr_b16 v[34:35], v22 offset:2400
    v_mov_b32 v25, 0
    buffer_load_dword a126, v25, s[12:15], s55 offen sc1
    s_waitcnt vmcnt(41) lgkmcnt(6)
    v_mfma_f32_16x16x32_bf16 v[52:55], v[40:43], a[32:35], v[52:55]
    ds_read_b64_tr_b16 v[36:37], v22 offset:128
    v_mfma_f32_16x16x32_bf16 v[88:91], v[40:43], a[36:39], v[88:91]
    ds_read_b64_tr_b16 v[38:39], v22 offset:2432
    buffer_load_dwordx4 v12, s[8:11], s54 offen offset:2048 lds
    s_waitcnt lgkmcnt(6)
    v_mfma_f32_16x16x32_bf16 v[56:59], v[44:47], a[32:35], v[56:59]
    ds_read_b64_tr_b16 v[40:41], v22 offset:160
    v_mfma_f32_16x16x32_bf16 v[92:95], v[44:47], a[36:39], v[92:95]
    ds_read_b64_tr_b16 v[42:43], v22 offset:2464
    s_waitcnt lgkmcnt(6)
    v_mfma_f32_16x16x32_bf16 v[60:63], v[48:51], a[32:35], v[60:63]
    ds_read_b64_tr_b16 v[44:45], v22 offset:192
    v_mfma_f32_16x16x32_bf16 v[96:99], v[48:51], a[36:39], v[96:99]
    ds_read_b64_tr_b16 v[46:47], v22 offset:2496
    buffer_load_dwordx4 v13, s[8:11], s54 offen offset:3072 lds
    s_waitcnt lgkmcnt(6)
    v_mfma_f32_16x16x32_bf16 v[64:67], v[32:35], a[32:35], v[64:67]
    ds_read_b64_tr_b16 v[48:49], v22 offset:224
    v_mfma_f32_16x16x32_bf16 v[100:103], v[32:35], a[36:39], v[100:103]
    ds_read_b64_tr_b16 v[50:51], v22 offset:2528
    s_waitcnt lgkmcnt(6)
    v_mfma_f32_16x16x32_bf16 v[68:71], v[36:39], a[32:35], v[68:71]
    ds_read_b64_tr_b16 v[32:33], v22 offset:256
    v_mfma_f32_16x16x32_bf16 v[104:107], v[36:39], a[36:39], v[104:107]
    ds_read_b64_tr_b16 v[34:35], v22 offset:2560
    s_add_u32 m0, s39, 40960
    s_nop 0
    buffer_load_dwordx4 v14, s[8:11], s54 offen offset:0 lds
    s_waitcnt lgkmcnt(6)
    v_mfma_f32_16x16x32_bf16 v[72:75], v[40:43], a[32:35], v[72:75]
    ds_read_b64_tr_b16 v[36:37], v22 offset:9216
    v_mfma_f32_16x16x32_bf16 v[108:111], v[40:43], a[36:39], v[108:111]
    ds_read_b64_tr_b16 v[38:39], v22 offset:11520
    s_waitcnt lgkmcnt(6)
    v_mfma_f32_16x16x32_bf16 v[76:79], v[44:47], a[32:35], v[76:79]
    ds_read_b64_tr_b16 v[40:41], v22 offset:9248
    v_mfma_f32_16x16x32_bf16 v[112:115], v[44:47], a[36:39], v[112:115]
    ds_read_b64_tr_b16 v[42:43], v22 offset:11552
    buffer_load_dwordx4 v15, s[8:11], s54 offen offset:1024 lds
    s_waitcnt lgkmcnt(6)
    v_mfma_f32_16x16x32_bf16 v[80:83], v[48:51], a[32:35], v[80:83]
    ds_read_b64_tr_b16 v[44:45], v22 offset:9280
    v_mfma_f32_16x16x32_bf16 v[116:119], v[48:51], a[36:39], v[116:119]
    ds_read_b64_tr_b16 v[46:47], v22 offset:11584
    s_waitcnt lgkmcnt(6)
    v_mfma_f32_16x16x32_bf16 v[84:87], v[32:35], a[32:35], v[84:87]
    ds_read_b64_tr_b16 v[48:49], v22 offset:9312
    v_mfma_f32_16x16x32_bf16 v[120:123], v[32:35], a[36:39], v[120:123]
    ds_read_b64_tr_b16 v[50:51], v22 offset:11616
    buffer_load_dwordx4 v16, s[8:11], s54 offen offset:2048 lds
    s_waitcnt vmcnt(42) lgkmcnt(6)
    v_mfma_f32_16x16x32_bf16 v[52:55], v[36:39], a[40:43], v[52:55]
    ds_read_b64_tr_b16 v[32:33], v22 offset:9344
    v_mfma_f32_16x16x32_bf16 v[88:91], v[36:39], a[44:47], v[88:91]
    ds_read_b64_tr_b16 v[34:35], v22 offset:11648
    s_waitcnt lgkmcnt(6)
    v_mfma_f32_16x16x32_bf16 v[56:59], v[40:43], a[40:43], v[56:59]
    ds_read_b64_tr_b16 v[36:37], v22 offset:9376
    v_mfma_f32_16x16x32_bf16 v[92:95], v[40:43], a[44:47], v[92:95]
    ds_read_b64_tr_b16 v[38:39], v22 offset:11680
    buffer_load_dwordx4 v17, s[8:11], s54 offen offset:3072 lds
    s_waitcnt lgkmcnt(6)
    v_mfma_f32_16x16x32_bf16 v[60:63], v[44:47], a[40:43], v[60:63]
    ds_read_b64_tr_b16 v[40:41], v22 offset:9408
    v_mfma_f32_16x16x32_bf16 v[96:99], v[44:47], a[44:47], v[96:99]
    ds_read_b64_tr_b16 v[42:43], v22 offset:11712
    s_waitcnt lgkmcnt(6)
    v_mfma_f32_16x16x32_bf16 v[64:67], v[48:51], a[40:43], v[64:67]
    ds_read_b64_tr_b16 v[44:45], v22 offset:9440
    v_mfma_f32_16x16x32_bf16 v[100:103], v[48:51], a[44:47], v[100:103]
    ds_read_b64_tr_b16 v[46:47], v22 offset:11744
    s_add_u32 m0, s39, 45056
    s_nop 0
    buffer_load_dwordx4 v18, s[8:11], s54 offen offset:0 lds
    s_waitcnt lgkmcnt(6)
    v_mfma_f32_16x16x32_bf16 v[68:71], v[32:35], a[40:43], v[68:71]
    ds_read_b64_tr_b16 v[48:49], v22 offset:9472
    v_mfma_f32_16x16x32_bf16 v[104:107], v[32:35], a[44:47], v[104:107]
    ds_read_b64_tr_b16 v[50:51], v22 offset:11776
    s_waitcnt lgkmcnt(6)
    v_mfma_f32_16x16x32_bf16 v[72:75], v[36:39], a[40:43], v[72:75]
    ds_read_b64_tr_b16 v[32:33], v22 offset:18432
    v_mfma_f32_16x16x32_bf16 v[108:111], v[36:39], a[44:47], v[108:111]
    ds_read_b64_tr_b16 v[34:35], v22 offset:20736
    s_waitcnt lgkmcnt(6)
    v_mfma_f32_16x16x32_bf16 v[76:79], v[40:43], a[40:43], v[76:79]
    ds_read_b64_tr_b16 v[36:37], v22 offset:18464
    v_mfma_f32_16x16x32_bf16 v[112:115], v[40:43], a[44:47], v[112:115]
    ds_read_b64_tr_b16 v[38:39], v22 offset:20768
    s_waitcnt lgkmcnt(6)
    v_mfma_f32_16x16x32_bf16 v[80:83], v[44:47], a[40:43], v[80:83]
    ds_read_b64_tr_b16 v[40:41], v22 offset:18496
    v_mfma_f32_16x16x32_bf16 v[116:119], v[44:47], a[44:47], v[116:119]
    ds_read_b64_tr_b16 v[42:43], v22 offset:20800
    s_waitcnt lgkmcnt(6)
    v_mfma_f32_16x16x32_bf16 v[84:87], v[48:51], a[40:43], v[84:87]
    ds_read_b64_tr_b16 v[44:45], v22 offset:18528
    v_mfma_f32_16x16x32_bf16 v[120:123], v[48:51], a[44:47], v[120:123]
    ds_read_b64_tr_b16 v[46:47], v22 offset:20832
    s_waitcnt vmcnt(38) lgkmcnt(6)
    v_mfma_f32_16x16x32_bf16 v[52:55], v[32:35], a[48:51], v[52:55]
    ds_read_b64_tr_b16 v[48:49], v22 offset:18560
    v_mfma_f32_16x16x32_bf16 v[88:91], v[32:35], a[52:55], v[88:91]
    ds_read_b64_tr_b16 v[50:51], v22 offset:20864
    s_waitcnt lgkmcnt(6)
    v_mfma_f32_16x16x32_bf16 v[56:59], v[36:39], a[48:51], v[56:59]
    ds_read_b64_tr_b16 v[32:33], v22 offset:18592
    v_mfma_f32_16x16x32_bf16 v[92:95], v[36:39], a[52:55], v[92:95]
    ds_read_b64_tr_b16 v[34:35], v22 offset:20896
    s_waitcnt lgkmcnt(6)
    v_mfma_f32_16x16x32_bf16 v[60:63], v[40:43], a[48:51], v[60:63]
    ds_read_b64_tr_b16 v[36:37], v22 offset:18624
    v_mfma_f32_16x16x32_bf16 v[96:99], v[40:43], a[52:55], v[96:99]
    ds_read_b64_tr_b16 v[38:39], v22 offset:20928
    s_waitcnt lgkmcnt(6)
    v_mfma_f32_16x16x32_bf16 v[64:67], v[44:47], a[48:51], v[64:67]
    ds_read_b64_tr_b16 v[40:41], v22 offset:18656
    v_mfma_f32_16x16x32_bf16 v[100:103], v[44:47], a[52:55], v[100:103]
    ds_read_b64_tr_b16 v[42:43], v22 offset:20960
    s_waitcnt lgkmcnt(6)
    v_mfma_f32_16x16x32_bf16 v[68:71], v[48:51], a[48:51], v[68:71]
    ds_read_b64_tr_b16 v[44:45], v22 offset:18688
    v_mfma_f32_16x16x32_bf16 v[104:107], v[48:51], a[52:55], v[104:107]
    ds_read_b64_tr_b16 v[46:47], v22 offset:20992
    s_waitcnt vmcnt(10)
    s_mov_b64 exec, 1
    ds_add_u32 v29, v31
    s_mov_b64 exec, -1
    s_waitcnt lgkmcnt(7)
    v_mfma_f32_16x16x32_bf16 v[72:75], v[32:35], a[48:51], v[72:75]
    ds_read_b64_tr_b16 v[48:49], v22 offset:27648
    v_mfma_f32_16x16x32_bf16 v[108:111], v[32:35], a[52:55], v[108:111]
    ds_read_b64_tr_b16 v[50:51], v22 offset:29952
    s_waitcnt lgkmcnt(7)
    v_mfma_f32_16x16x32_bf16 v[76:79], v[36:39], a[48:51], v[76:79]
    ds_read_b64_tr_b16 v[32:33], v22 offset:27680
    v_mfma_f32_16x16x32_bf16 v[112:115], v[36:39], a[52:55], v[112:115]
    ds_read_b64_tr_b16 v[34:35], v22 offset:29984
    s_waitcnt lgkmcnt(7)
    v_mfma_f32_16x16x32_bf16 v[80:83], v[40:43], a[48:51], v[80:83]
    ds_read_b64_tr_b16 v[36:37], v22 offset:27712
    v_mfma_f32_16x16x32_bf16 v[116:119], v[40:43], a[52:55], v[116:119]
    ds_read_b64_tr_b16 v[38:39], v22 offset:30016
    s_waitcnt lgkmcnt(7)
    v_mfma_f32_16x16x32_bf16 v[84:87], v[44:47], a[48:51], v[84:87]
    ds_read_b64_tr_b16 v[40:41], v22 offset:27744
    v_mfma_f32_16x16x32_bf16 v[120:123], v[44:47], a[52:55], v[120:123]
    ds_read_b64_tr_b16 v[42:43], v22 offset:30048
    s_waitcnt vmcnt(34) lgkmcnt(6)
    v_mfma_f32_16x16x32_bf16 v[52:55], v[48:51], a[56:59], v[52:55]
    ds_read_b64_tr_b16 v[44:45], v22 offset:27776
    v_mfma_f32_16x16x32_bf16 v[88:91], v[48:51], a[60:63], v[88:91]
    ds_read_b64_tr_b16 v[46:47], v22 offset:30080
    s_waitcnt lgkmcnt(6)
    v_mfma_f32_16x16x32_bf16 v[56:59], v[32:35], a[56:59], v[56:59]
    ds_read_b64_tr_b16 v[48:49], v22 offset:27808
    v_mfma_f32_16x16x32_bf16 v[92:95], v[32:35], a[60:63], v[92:95]
    ds_read_b64_tr_b16 v[50:51], v22 offset:30112
    s_waitcnt lgkmcnt(6)
    v_mfma_f32_16x16x32_bf16 v[60:63], v[36:39], a[56:59], v[60:63]
    ds_read_b64_tr_b16 v[32:33], v22 offset:27840
    v_mfma_f32_16x16x32_bf16 v[96:99], v[36:39], a[60:63], v[96:99]
    ds_read_b64_tr_b16 v[34:35], v22 offset:30144
    ds_read_b32 v30, v29
    s_waitcnt lgkmcnt(7)
    v_mfma_f32_16x16x32_bf16 v[64:67], v[40:43], a[56:59], v[64:67]
    ds_read_b64_tr_b16 v[36:37], v22 offset:27872
    v_mfma_f32_16x16x32_bf16 v[100:103], v[40:43], a[60:63], v[100:103]
    ds_read_b64_tr_b16 v[38:39], v22 offset:30176
    s_waitcnt lgkmcnt(7)
    v_mfma_f32_16x16x32_bf16 v[68:71], v[44:47], a[56:59], v[68:71]
    ds_read_b64_tr_b16 v[40:41], v22 offset:27904
    v_mfma_f32_16x16x32_bf16 v[104:107], v[44:47], a[60:63], v[104:107]
    ds_read_b64_tr_b16 v[42:43], v22 offset:30208
    s_waitcnt lgkmcnt(7)
    v_mfma_f32_16x16x32_bf16 v[72:75], v[48:51], a[56:59], v[72:75]
    s_waitcnt lgkmcnt(4)
    v_cmp_gt_u32 vcc, 36, v30
    s_cbranch_vccz L_k2_c8_ok
L_k2_c8:
    ds_read_b32 v30, v29
    s_waitcnt lgkmcnt(0)
    v_cmp_gt_u32 vcc, 36, v30
    s_cbranch_vccnz L_k2_c8
L_k2_c8_ok:
    ds_read_b64_tr_b16 v[44:45], v19 offset:0
    v_mfma_f32_16x16x32_bf16 v[108:111], v[48:51], a[60:63], v[108:111]
    ds_read_b64_tr_b16 v[46:47], v19 offset:2304
    s_lshl_b32 s33, s28, 6
    s_add_u32 s33, s33, 0
    v_add_u32 v28, s33, v0
    s_movk_i32 s34, 3641
    v_mul_u32_u24 v27, s34, v28
    v_lshrrev_b32 v27, 16, v27
    v_mul_u32_u24 v25, 18, v27
    v_sub_u32 v28, v28, v25
    v_lshlrev_b32 v28, 4, v28
    v_bfe_u32 v25, v27, 2, 1
    v_lshlrev_b32 v25, 2, v25
    v_bfe_u32 v26, v27, 3, 1
    v_lshl_add_u32 v25, v26, 1, v25
    v_bfe_u32 v26, v27, 1, 1
    v_add_u32 v25, v25, v26
    v_mul_u32_u24 v25, 18, v25
    v_and_b32 v26, 1, v27
    v_add3_u32 v25, v25, v26, 16
    s_movk_i32 s34, 1152
    v_mad_u32_u24 v1, v25, s34, v28
    v_cmp_gt_u32 vcc, 16, v27
    v_mov_b32 v26, 1073741824
    s_mul_i32 s54, s31, 165888
    v_cndmask_b32 v1, v26, v1, vcc
    s_add_u32 s54, s54, s58
    s_lshl_b32 s33, s28, 10
    s_add_u32 m0, s33, 73728
    s_nop 0
    buffer_load_dwordx4 v1, s[8:11], s54 offen lds
    s_waitcnt lgkmcnt(7)
    v_mfma_f32_16x16x32_bf16 v[76:79], v[32:35], a[56:59], v[76:79]
    ds_read_b64_tr_b16 v[48:49], v19 offset:32
    v_mfma_f32_16x16x32_bf16 v[112:115], v[32:35], a[60:63], v[112:115]
    ds_read_b64_tr_b16 v[50:51], v19 offset:2336
    s_waitcnt lgkmcnt(6)
    v_mfma_f32_16x16x32_bf16 v[80:83], v[36:39], a[56:59], v[80:83]
    ds_read_b64_tr_b16 v[32:33], v19 offset:64
    v_mfma_f32_16x16x32_bf16 v[116:119], v[36:39], a[60:63], v[116:119]
    ds_read_b64_tr_b16 v[34:35], v19 offset:2368
    s_lshl_b32 s33, s28, 6
    s_add_u32 s33, s33, 256
    v_add_u32 v28, s33, v0
    s_movk_i32 s34, 3641
    v_mul_u32_u24 v27, s34, v28
    v_lshrrev_b32 v27, 16, v27
    v_mul_u32_u24 v25, 18, v27
    v_sub_u32 v28, v28, v25
    v_lshlrev_b32 v28, 4, v28
    v_bfe_u32 v25, v27, 2, 1
    v_lshlrev_b32 v25, 2, v25
    v_bfe_u32 v26, v27, 3, 1
    v_lshl_add_u32 v25, v26, 1, v25
    v_bfe_u32 v26, v27, 1, 1
    v_add_u32 v25, v25, v26
    v_mul_u32_u24 v25, 18, v25
    v_and_b32 v26, 1, v27
    v_add3_u32 v25, v25, v26, 16
    s_movk_i32 s34, 1152
    v_mad_u32_u24 v2, v25, s34, v28
    v_cmp_gt_u32 vcc, 16, v27
    v_mov_b32 v26, 1073741824
    s_mul_i32 s54, s31, 165888
    v_cndmask_b32 v2, v26, v2, vcc
    s_add_u32 s54, s54, s58
    s_lshl_b32 s33, s28, 10
    s_add_u32 m0, s33, 77824
    s_nop 0
    buffer_load_dwordx4 v2, s[8:11], s54 offen lds
    s_waitcnt lgkmcnt(6)
    v_mfma_f32_16x16x32_bf16 v[84:87], v[40:43], a[56:59], v[84:87]
    ds_read_b64_tr_b16 v[36:37], v19 offset:96
    v_mfma_f32_16x16x32_bf16 v[120:123], v[40:43], a[60:63], v[120:123]
    ds_read_b64_tr_b16 v[38:39], v19 offset:2400
    s_waitcnt vmcnt(9)
    v_accvgpr_read_b32 v26, a126
    v_mov_b32 v25, 0
    v_cmp_ne_u32 vcc, 16, v26
    s_cbranch_vccz L_k2_po_ok
L_k2_po:
    buffer_load_dword v26, v25, s[12:15], s55 offen sc1
    s_waitcnt vmcnt(0)
    v_cmp_ne_u32 vcc, 16, v26
    s_cbranch_vccz L_k2_po_ok
    s_sleep 4
    s_branch L_k2_po
L_k2_po_ok:
    v_add_u32 v24, 20480, v23
    v_cmp_gt_u32 vcc, 32, v0
    v_mov_b32 v27, 1073741824
    s_add_u32 s33, s38, 4096
    v_cndmask_b32 v25, v27, v23, vcc
    v_cndmask_b32 v26, v27, v24, vcc
    buffer_load_dwordx4 a[0:3], v23, s[12:15], s38 offen offset:0 sc1
    buffer_load_dwordx4 a[4:7], v24, s[12:15], s38 offen offset:0 sc1
    buffer_load_dwordx4 a[8:11], v23, s[12:15], s38 offen offset:1024 sc1
    buffer_load_dwordx4 a[12:15], v24, s[12:15], s38 offen offset:1024 sc1
    buffer_load_dwordx4 a[16:19], v23, s[12:15], s38 offen offset:2048 sc1
    buffer_load_dwordx4 a[20:23], v24, s[12:15], s38 offen offset:2048 sc1
    buffer_load_dwordx4 a[24:27], v23, s[12:15], s38 offen offset:3072 sc1
    buffer_load_dwordx4 a[28:31], v24, s[12:15], s38 offen offset:3072 sc1
    buffer_load_dwordx4 a[32:35], v25, s[12:15], s33 offen sc1
    buffer_load_dwordx4 a[36:39], v26, s[12:15], s33 offen sc1
    s_waitcnt vmcnt(39) lgkmcnt(6)
    v_mfma_f32_16x16x32_bf16 v[52:55], v[44:47], a[64:67], v[52:55]
    ds_read_b64_tr_b16 v[40:41], v19 offset:128
    v_mfma_f32_16x16x32_bf16 v[88:91], v[44:47], a[68:71], v[88:91]
    ds_read_b64_tr_b16 v[42:43], v19 offset:2432
    s_waitcnt lgkmcnt(6)
    v_mfma_f32_16x16x32_bf16 v[56:59], v[48:51], a[64:67], v[56:59]
    ds_read_b64_tr_b16 v[44:45], v19 offset:160
    v_mfma_f32_16x16x32_bf16 v[92:95], v[48:51], a[68:71], v[92:95]
    ds_read_b64_tr_b16 v[46:47], v19 offset:2464
    s_waitcnt lgkmcnt(6)
    v_mfma_f32_16x16x32_bf16 v[60:63], v[32:35], a[64:67], v[60:63]
    ds_read_b64_tr_b16 v[48:49], v19 offset:192
    v_mfma_f32_16x16x32_bf16 v[96:99], v[32:35], a[68:71], v[96:99]
    ds_read_b64_tr_b16 v[50:51], v19 offset:2496
    s_waitcnt lgkmcnt(6)
    v_mfma_f32_16x16x32_bf16 v[64:67], v[36:39], a[64:67], v[64:67]
    ds_read_b64_tr_b16 v[32:33], v19 offset:224
    v_mfma_f32_16x16x32_bf16 v[100:103], v[36:39], a[68:71], v[100:103]
    ds_read_b64_tr_b16 v[34:35], v19 offset:2528
    s_waitcnt lgkmcnt(6)
    v_mfma_f32_16x16x32_bf16 v[68:71], v[40:43], a[64:67], v[68:71]
    ds_read_b64_tr_b16 v[36:37], v19 offset:256
    v_mfma_f32_16x16x32_bf16 v[104:107], v[40:43], a[68:71], v[104:107]
    ds_read_b64_tr_b16 v[38:39], v19 offset:2560
    s_waitcnt lgkmcnt(6)
    v_mfma_f32_16x16x32_bf16 v[72:75], v[44:47], a[64:67], v[72:75]
    ds_read_b64_tr_b16 v[40:41], v19 offset:9216
    v_mfma_f32_16x16x32_bf16 v[108:111], v[44:47], a[68:71], v[108:111]
    ds_read_b64_tr_b16 v[42:43], v19 offset:11520
    s_waitcnt lgkmcnt(6)
    v_mfma_f32_16x16x32_bf16 v[76:79], v[48:51], a[64:67], v[76:79]
    ds_read_b64_tr_b16 v[44:45], v19 offset:9248
    v_mfma_f32_16x16x32_bf16 v[112:115], v[48:51], a[68:71], v[112:115]
    ds_read_b64_tr_b16 v[46:47], v19 offset:11552
    s_waitcnt lgkmcnt(6)
    v_mfma_f32_16x16x32_bf16 v[80:83], v[32:35], a[64:67], v[80:83]
    ds_read_b64_tr_b16 v[48:49], v19 offset:9280
    v_mfma_f32_16x16x32_bf16 v[116:119], v[32:35], a[68:71], v[116:119]
    ds_read_b64_tr_b16 v[50:51], v19 offset:11584
    s_waitcnt lgkmcnt(6)
    v_mfma_f32_16x16x32_bf16 v[84:87], v[36:39], a[64:67], v[84:87]
    ds_read_b64_tr_b16 v[32:33], v19 offset:9312
    v_mfma_f32_16x16x32_bf16 v[120:123], v[36:39], a[68:71], v[120:123]
    ds_read_b64_tr_b16 v[34:35], v19 offset:11616
    s_waitcnt vmcnt(35) lgkmcnt(6)
    v_mfma_f32_16x16x32_bf16 v[52:55], v[40:43], a[72:75], v[52:55]
    ds_read_b64_tr_b16 v[36:37], v19 offset:9344
    v_mfma_f32_16x16x32_bf16 v[88:91], v[40:43], a[76:79], v[88:91]
    ds_read_b64_tr_b16 v[38:39], v19 offset:11648
    s_waitcnt lgkmcnt(6)
    v_mfma_f32_16x16x32_bf16 v[56:59], v[44:47], a[72:75], v[56:59]
    ds_read_b64_tr_b16 v[40:41], v19 offset:9376
    v_mfma_f32_16x16x32_bf16 v[92:95], v[44:47], a[76:79], v[92:95]
    ds_read_b64_tr_b16 v[42:43], v19 offset:11680
    s_waitcnt lgkmcnt(6)
    v_mfma_f32_16x16x32_bf16 v[60:63], v[48:51], a[72:75], v[60:63]
    ds_read_b64_tr_b16 v[44:45], v19 offset:9408
    v_mfma_f32_16x16x32_bf16 v[96:99], v[48:51], a[76:79], v[96:99]
    ds_read_b64_tr_b16 v[46:47], v19 offset:11712
    s_waitcnt lgkmcnt(6)
    v_mfma_f32_16x16x32_bf16 v[64:67], v[32:35], a[72:75], v[64:67]
    ds_read_b64_tr_b16 v[48:49], v19 offset:9440
    v_mfma_f32_16x16x32_bf16 v[100:103], v[32:35], a[76:79], v[100:103]
    ds_read_b64_tr_b16 v[50:51], v19 offset:11744
    s_waitcnt lgkmcnt(6)
    v_mfma_f32_16x16x32_bf16 v[68:71], v[36:39], a[72:75], v[68:71]
    ds_read_b64_tr_b16 v[32:33], v19 offset:9472
    v_mfma_f32_16x16x32_bf16 v[104:107], v[36:39], a[76:79], v[104:107]
    ds_read_b64_tr_b16 v[34:35], v19 offset:11776
    s_waitcnt lgkmcnt(6)
    v_mfma_f32_16x16x32_bf16 v[72:75], v[40:43], a[72:75], v[72:75]
    ds_read_b64_tr_b16 v[36:37], v19 offset:18432
    v_mfma_f32_16x16x32_bf16 v[108:111], v[40:43], a[76:79], v[108:111]
    ds_read_b64_tr_b16 v[38:39], v19 offset:20736
    s_waitcnt lgkmcnt(6)
    v_mfma_f32_16x16x32_bf16 v[76:79], v[44:47], a[72:75], v[76:79]
    ds_read_b64_tr_b16 v[40:41], v19 offset:18464
    v_mfma_f32_16x16x32_bf16 v[112:115], v[44:47], a[76:79], v[112:115]
    ds_read_b64_tr_b16 v[42:43], v19 offset:20768
    s_waitcnt lgkmcnt(6)
    v_mfma_f32_16x16x32_bf16 v[80:83], v[48:51], a[72:75], v[80:83]
    ds_read_b64_tr_b16 v[44:45], v19 offset:18496
    v_mfma_f32_16x16x32_bf16 v[116:119], v[48:51], a[76:79], v[116:119]
    ds_read_b64_tr_b16 v[46:47], v19 offset:20800
    s_waitcnt lgkmcnt(6)
    v_mfma_f32_16x16x32_bf16 v[84:87], v[32:35], a[72:75], v[84:87]
    ds_read_b64_tr_b16 v[48:49], v19 offset:18528
    v_mfma_f32_16x16x32_bf16 v[120:123], v[32:35], a[76:79], v[120:123]
    ds_read_b64_tr_b16 v[50:51], v19 offset:20832
    s_waitcnt vmcnt(33) lgkmcnt(6)
    v_mfma_f32_16x16x32_bf16 v[52:55], v[36:39], a[80:83], v[52:55]
    ds_read_b64_tr_b16 v[32:33], v19 offset:18560
    v_mfma_f32_16x16x32_bf16 v[88:91], v[36:39], a[84:87], v[88:91]
    ds_read_b64_tr_b16 v[34:35], v19 offset:20864
    s_waitcnt lgkmcnt(6)
    v_mfma_f32_16x16x32_bf16 v[56:59], v[40:43], a[80:83], v[56:59]
    ds_read_b64_tr_b16 v[36:37], v19 offset:18592
    v_mfma_f32_16x16x32_bf16 v[92:95], v[40:43], a[84:87], v[92:95]
    ds_read_b64_tr_b16 v[38:39], v19 offset:20896
    s_waitcnt lgkmcnt(6)
    v_mfma_f32_16x16x32_bf16 v[60:63], v[44:47], a[80:83], v[60:63]
    ds_read_b64_tr_b16 v[40:41], v19 offset:18624
    v_mfma_f32_16x16x32_bf16 v[96:99], v[44:47], a[84:87], v[96:99]
    ds_read_b64_tr_b16 v[42:43], v19 offset:20928
    s_waitcnt lgkmcnt(6)
    v_mfma_f32_16x16x32_bf16 v[64:67], v[48:51], a[80:83], v[64:67]
    ds_read_b64_tr_b16 v[44:45], v19 offset:18656
    v_mfma_f32_16x16x32_bf16 v[100:103], v[48:51], a[84:87], v[100:103]
    ds_read_b64_tr_b16 v[46:47], v19 offset:20960
    s_waitcnt lgkmcnt(6)
    v_mfma_f32_16x16x32_bf16 v[68:71], v[32:35], a[80:83], v[68:71]
    ds_read_b64_tr_b16 v[48:49], v19 offset:18688
    v_mfma_f32_16x16x32_bf16 v[104:107], v[32:35], a[84:87], v[104:107]
    ds_read_b64_tr_b16 v[50:51], v19 offset:20992
    s_waitcnt vmcnt(12)
    s_mov_b64 exec, 1
    ds_add_u32 v29, v31
    s_mov_b64 exec, -1
    s_waitcnt lgkmcnt(7)
    v_mfma_f32_16x16x32_bf16 v[72:75], v[36:39], a[80:83], v[72:75]
    ds_read_b64_tr_b16 v[32:33], v19 offset:27648
    v_mfma_f32_16x16x32_bf16 v[108:111], v[36:39], a[84:87], v[108:111]
    ds_read_b64_tr_b16 v[34:35], v19 offset:29952
    s_waitcnt lgkmcnt(7)
    v_mfma_f32_16x16x32_bf16 v[76:79], v[40:43], a[80:83], v[76:79]
    ds_read_b64_tr_b16 v[36:37], v19 offset:27680
    v_mfma_f32_16x16x32_bf16 v[112:115], v[40:43], a[84:87], v[112:115]
    ds_read_b64_tr_b16 v[38:39], v19 offset:29984
    s_waitcnt lgkmcnt(7)
    v_mfma_f32_16x16x32_bf16 v[80:83], v[44:47], a[80:83], v[80:83]
    ds_read_b64_tr_b16 v[40:41], v19 offset:27712
    v_mfma_f32_16x16x32_bf16 v[116:119], v[44:47], a[84:87], v[116:119]
    ds_read_b64_tr_b16 v[42:43], v19 offset:30016
    s_waitcnt lgkmcnt(7)
    v_mfma_f32_16x16x32_bf16 v[84:87], v[48:51], a[80:83], v[84:87]
    ds_read_b64_tr_b16 v[44:45], v19 offset:27744
    v_mfma_f32_16x16x32_bf16 v[120:123], v[48:51], a[84:87], v[120:123]
    ds_read_b64_tr_b16 v[46:47], v19 offset:30048
    s_waitcnt vmcnt(29) lgkmcnt(6)
    v_mfma_f32_16x16x32_bf16 v[52:55], v[32:35], a[88:91], v[52:55]
    ds_read_b64_tr_b16 v[48:49], v19 offset:27776
    v_mfma_f32_16x16x32_bf16 v[88:91], v[32:35], a[92:95], v[88:91]
    ds_read_b64_tr_b16 v[50:51], v19 offset:30080
    s_waitcnt lgkmcnt(6)
    v_mfma_f32_16x16x32_bf16 v[56:59], v[36:39], a[88:91], v[56:59]
    ds_read_b64_tr_b16 v[32:33], v19 offset:27808
    v_mfma_f32_16x16x32_bf16 v[92:95], v[36:39], a[92:95], v[92:95]
    ds_read_b64_tr_b16 v[34:35], v19 offset:30112
    s_waitcnt lgkmcnt(6)
    v_mfma_f32_16x16x32_bf16 v[60:63], v[40:43], a[88:91], v[60:63]
    ds_read_b64_tr_b16 v[36:37], v19 offset:27840
    v_mfma_f32_16x16x32_bf16 v[96:99], v[40:43], a[92:95], v[96:99]
    ds_read_b64_tr_b16 v[38:39], v19 offset:30144
    ds_read_b32 v30, v29
    s_waitcnt lgkmcnt(7)
    v_mfma_f32_16x16x32_bf16 v[64:67], v[44:47], a[88:91], v[64:67]
    ds_read_b64_tr_b16 v[40:41], v19 offset:27872
    v_mfma_f32_16x16x32_bf16 v[100:103], v[44:47], a[92:95], v[100:103]
    ds_read_b64_tr_b16 v[42:43], v19 offset:30176
    s_waitcnt lgkmcnt(7)
    v_mfma_f32_16x16x32_bf16 v[68:71], v[48:51], a[88:91], v[68:71]
    ds_read_b64_tr_b16 v[44:45], v19 offset:27904
    v_mfma_f32_16x16x32_bf16 v[104:107], v[48:51], a[92:95], v[104:107]
    ds_read_b64_tr_b16 v[46:47], v19 offset:30208
    s_waitcnt lgkmcnt(7)
    v_mfma_f32_16x16x32_bf16 v[72:75], v[32:35], a[88:91], v[72:75]
    s_waitcnt lgkmcnt(4)
    v_cmp_gt_u32 vcc, 40, v30
    s_cbranch_vccz L_k2_c9_ok
L_k2_c9:
    ds_read_b32 v30, v29
    s_waitcnt lgkmcnt(0)
    v_cmp_gt_u32 vcc, 40, v30
    s_cbranch_vccnz L_k2_c9
L_k2_c9_ok:
    ds_read_b64_tr_b16 v[48:49], v20 offset:0
    v_mfma_f32_16x16x32_bf16 v[108:111], v[32:35], a[92:95], v[108:111]
    ds_read_b64_tr_b16 v[50:51], v20 offset:2304
    s_waitcnt lgkmcnt(7)
    v_mfma_f32_16x16x32_bf16 v[76:79], v[36:39], a[88:91], v[76:79]
    ds_read_b64_tr_b16 v[32:33], v20 offset:32
    v_mfma_f32_16x16x32_bf16 v[112:115], v[36:39], a[92:95], v[112:115]
    ds_read_b64_tr_b16 v[34:35], v20 offset:2336
    s_waitcnt lgkmcnt(6)
    v_mfma_f32_16x16x32_bf16 v[80:83], v[40:43], a[88:91], v[80:83]
    ds_read_b64_tr_b16 v[36:37], v20 offset:64
    v_mfma_f32_16x16x32_bf16 v[116:119], v[40:43], a[92:95], v[116:119]
    ds_read_b64_tr_b16 v[38:39], v20 offset:2368
    s_waitcnt lgkmcnt(6)
    v_mfma_f32_16x16x32_bf16 v[84:87], v[44:47], a[88:91], v[84:87]
    ds_read_b64_tr_b16 v[40:41], v20 offset:96
    v_mfma_f32_16x16x32_bf16 v[120:123], v[44:47], a[92:95], v[120:123]
    ds_read_b64_tr_b16 v[42:43], v20 offset:2400
    s_waitcnt vmcnt(8) lgkmcnt(6)
    v_mfma_f32_16x16x32_bf16 v[52:55], v[48:51], a[0:3], v[52:55]
    ds_read_b64_tr_b16 v[44:45], v20 offset:128
    v_mfma_f32_16x16x32_bf16 v[88:91], v[48:51], a[4:7], v[88:91]
    ds_read_b64_tr_b16 v[46:47], v20 offset:2432
    s_waitcnt lgkmcnt(6)
    v_mfma_f32_16x16x32_bf16 v[56:59], v[32:35], a[0:3], v[56:59]
    ds_read_b64_tr_b16 v[48:49], v20 offset:160
    v_mfma_f32_16x16x32_bf16 v[92:95], v[32:35], a[4:7], v[92:95]
    ds_read_b64_tr_b16 v[50:51], v20 offset:2464
    s_waitcnt lgkmcnt(6)
    v_mfma_f32_16x16x32_bf16 v[60:63], v[36:39], a[0:3], v[60:63]
    ds_read_b64_tr_b16 v[32:33], v20 offset:192
    v_mfma_f32_16x16x32_bf16 v[96:99], v[36:39], a[4:7], v[96:99]
    ds_read_b64_tr_b16 v[34:35], v20 offset:2496
    s_waitcnt lgkmcnt(6)
    v_mfma_f32_16x16x32_bf16 v[64:67], v[40:43], a[0:3], v[64:67]
    ds_read_b64_tr_b16 v[36:37], v20 offset:224
    v_mfma_f32_16x16x32_bf16 v[100:103], v[40:43], a[4:7], v[100:103]
    ds_read_b64_tr_b16 v[38:39], v20 offset:2528
    s_waitcnt lgkmcnt(6)
    v_mfma_f32_16x16x32_bf16 v[68:71], v[44:47], a[0:3], v[68:71]
    ds_read_b64_tr_b16 v[40:41], v20 offset:256
    v_mfma_f32_16x16x32_bf16 v[104:107], v[44:47], a[4:7], v[104:107]
    ds_read_b64_tr_b16 v[42:43], v20 offset:2560
    s_waitcnt lgkmcnt(6)
    v_mfma_f32_16x16x32_bf16 v[72:75], v[48:51], a[0:3], v[72:75]
    ds_read_b64_tr_b16 v[44:45], v20 offset:9216
    v_mfma_f32_16x16x32_bf16 v[108:111], v[48:51], a[4:7], v[108:111]
    ds_read_b64_tr_b16 v[46:47], v20 offset:11520
    s_waitcnt lgkmcnt(6)
    v_mfma_f32_16x16x32_bf16 v[76:79], v[32:35], a[0:3], v[76:79]
    ds_read_b64_tr_b16 v[48:49], v20 offset:9248
    v_mfma_f32_16x16x32_bf16 v[112:115], v[32:35], a[4:7], v[112:115]
    ds_read_b64_tr_b16 v[50:51], v20 offset:11552
    s_waitcnt lgkmcnt(6)
    v_mfma_f32_16x16x32_bf16 v[80:83], v[36:39], a[0:3], v[80:83]
    ds_read_b64_tr_b16 v[32:33], v20 offset:9280
    v_mfma_f32_16x16x32_bf16 v[116:119], v[36:39], a[4:7], v[116:119]
    ds_read_b64_tr_b16 v[34:35], v20 offset:11584
    s_waitcnt lgkmcnt(6)
    v_mfma_f32_16x16x32_bf16 v[84:87], v[40:43], a[0:3], v[84:87]
    ds_read_b64_tr_b16 v[36:37], v20 offset:9312
    v_mfma_f32_16x16x32_bf16 v[120:123], v[40:43], a[4:7], v[120:123]
    ds_read_b64_tr_b16 v[38:39], v20 offset:11616
    s_waitcnt vmcnt(6) lgkmcnt(6)
    v_mfma_f32_16x16x32_bf16 v[52:55], v[44:47], a[8:11], v[52:55]
    ds_read_b64_tr_b16 v[40:41], v20 offset:9344
    v_mfma_f32_16x16x32_bf16 v[88:91], v[44:47], a[12:15], v[88:91]
    ds_read_b64_tr_b16 v[42:43], v20 offset:11648
    s_waitcnt lgkmcnt(6)
    v_mfma_f32_16x16x32_bf16 v[56:59], v[48:51], a[8:11], v[56:59]
    ds_read_b64_tr_b16 v[44:45], v20 offset:9376
    v_mfma_f32_16x16x32_bf16 v[92:95], v[48:51], a[12:15], v[92:95]
    ds_read_b64_tr_b16 v[46:47], v20 offset:11680
    s_waitcnt lgkmcnt(6)
    v_mfma_f32_16x16x32_bf16 v[60:63], v[32:35], a[8:11], v[60:63]
    ds_read_b64_tr_b16 v[48:49], v20 offset:9408
    v_mfma_f32_16x16x32_bf16 v[96:99], v[32:35], a[12:15], v[96:99]
    ds_read_b64_tr_b16 v[50:51], v20 offset:11712
    s_waitcnt lgkmcnt(6)
    v_mfma_f32_16x16x32_bf16 v[64:67], v[36:39], a[8:11], v[64:67]
    ds_read_b64_tr_b16 v[32:33], v20 offset:9440
    v_mfma_f32_16x16x32_bf16 v[100:103], v[36:39], a[12:15], v[100:103]
    ds_read_b64_tr_b16 v[34:35], v20 offset:11744
    s_waitcnt lgkmcnt(6)
    v_mfma_f32_16x16x32_bf16 v[68:71], v[40:43], a[8:11], v[68:71]
    ds_read_b64_tr_b16 v[36:37], v20 offset:9472
    v_mfma_f32_16x16x32_bf16 v[104:107], v[40:43], a[12:15], v[104:107]
    ds_read_b64_tr_b16 v[38:39], v20 offset:11776
    s_waitcnt lgkmcnt(6)
    v_mfma_f32_16x16x32_bf16 v[72:75], v[44:47], a[8:11], v[72:75]
    ds_read_b64_tr_b16 v[40:41], v20 offset:18432
    v_mfma_f32_16x16x32_bf16 v[108:111], v[44:47], a[12:15], v[108:111]
    ds_read_b64_tr_b16 v[42:43], v20 offset:20736
    s_waitcnt lgkmcnt(6)
    v_mfma_f32_16x16x32_bf16 v[76:79], v[48:51], a[8:11], v[76:79]
    ds_read_b64_tr_b16 v[44:45], v20 offset:18464
    v_mfma_f32_16x16x32_bf16 v[112:115], v[48:51], a[12:15], v[112:115]
    ds_read_b64_tr_b16 v[46:47], v20 offset:20768
    s_waitcnt lgkmcnt(6)
    v_mfma_f32_16x16x32_bf16 v[80:83], v[32:35], a[8:11], v[80:83]
    ds_read_b64_tr_b16 v[48:49], v20 offset:18496
    v_mfma_f32_16x16x32_bf16 v[116:119], v[32:35], a[12:15], v[116:119]
    ds_read_b64_tr_b16 v[50:51], v20 offset:20800
    s_waitcnt lgkmcnt(6)
    v_mfma_f32_16x16x32_bf16 v[84:87], v[36:39], a[8:11], v[84:87]
    ds_read_b64_tr_b16 v[32:33], v20 offset:18528
    v_mfma_f32_16x16x32_bf16 v[120:123], v[36:39], a[12:15], v[120:123]
    ds_read_b64_tr_b16 v[34:35], v20 offset:20832
    s_waitcnt vmcnt(4) lgkmcnt(6)
    v_mfma_f32_16x16x32_bf16 v[52:55], v[40:43], a[16:19], v[52:55]
    ds_read_b64_tr_b16 v[36:37], v20 offset:18560
    v_mfma_f32_16x16x32_bf16 v[88:91], v[40:43], a[20:23], v[88:91]
    ds_read_b64_tr_b16 v[38:39], v20 offset:20864
    s_waitcnt lgkmcnt(6)
    v_mfma_f32_16x16x32_bf16 v[56:59], v[44:47], a[16:19], v[56:59]
    ds_read_b64_tr_b16 v[40:41], v20 offset:18592
    v_mfma_f32_16x16x32_bf16 v[92:95], v[44:47], a[20:23], v[92:95]
    ds_read_b64_tr_b16 v[42:43], v20 offset:20896
    s_waitcnt lgkmcnt(6)
    v_mfma_f32_16x16x32_bf16 v[60:63], v[48:51], a[16:19], v[60:63]
    ds_read_b64_tr_b16 v[44:45], v20 offset:18624
    v_mfma_f32_16x16x32_bf16 v[96:99], v[48:51], a[20:23], v[96:99]
    ds_read_b64_tr_b16 v[46:47], v20 offset:20928
    s_waitcnt lgkmcnt(6)
    v_mfma_f32_16x16x32_bf16 v[64:67], v[32:35], a[16:19], v[64:67]
    ds_read_b64_tr_b16 v[48:49], v20 offset:18656
    v_mfma_f32_16x16x32_bf16 v[100:103], v[32:35], a[20:23], v[100:103]
    ds_read_b64_tr_b16 v[50:51], v20 offset:20960
    s_waitcnt lgkmcnt(6)
    v_mfma_f32_16x16x32_bf16 v[68:71], v[36:39], a[16:19], v[68:71]
    ds_read_b64_tr_b16 v[32:33], v20 offset:18688
    v_mfma_f32_16x16x32_bf16 v[104:107], v[36:39], a[20:23], v[104:107]
    ds_read_b64_tr_b16 v[34:35], v20 offset:20992
    s_waitcnt vmcnt(10)
    s_mov_b64 exec, 1
    ds_add_u32 v29, v31
    s_mov_b64 exec, -1
    s_waitcnt lgkmcnt(7)
    v_mfma_f32_16x16x32_bf16 v[72:75], v[40:43], a[16:19], v[72:75]
    ds_read_b64_tr_b16 v[36:37], v20 offset:27648
    v_mfma_f32_16x16x32_bf16 v[108:111], v[40:43], a[20:23], v[108:111]
    ds_read_b64_tr_b16 v[38:39], v20 offset:29952
    s_waitcnt lgkmcnt(7)
    v_mfma_f32_16x16x32_bf16 v[76:79], v[44:47], a[16:19], v[76:79]
    ds_read_b64_tr_b16 v[40:41], v20 offset:27680
    v_mfma_f32_16x16x32_bf16 v[112:115], v[44:47], a[20:23], v[112:115]
    ds_read_b64_tr_b16 v[42:43], v20 offset:29984
    s_waitcnt lgkmcnt(7)
    v_mfma_f32_16x16x32_bf16 v[80:83], v[48:51], a[16:19], v[80:83]
    ds_read_b64_tr_b16 v[44:45], v20 offset:27712
    v_mfma_f32_16x16x32_bf16 v[116:119], v[48:51], a[20:23], v[116:119]
    ds_read_b64_tr_b16 v[46:47], v20 offset:30016
    s_waitcnt lgkmcnt(7)
    v_mfma_f32_16x16x32_bf16 v[84:87], v[32:35], a[16:19], v[84:87]
    ds_read_b64_tr_b16 v[48:49], v20 offset:27744
    v_mfma_f32_16x16x32_bf16 v[120:123], v[32:35], a[20:23], v[120:123]
    ds_read_b64_tr_b16 v[50:51], v20 offset:30048
    s_waitcnt vmcnt(2) lgkmcnt(6)
    v_mfma_f32_16x16x32_bf16 v[52:55], v[36:39], a[24:27], v[52:55]
    ds_read_b64_tr_b16 v[32:33], v20 offset:27776
    v_mfma_f32_16x16x32_bf16 v[88:91], v[36:39], a[28:31], v[88:91]
    ds_read_b64_tr_b16 v[34:35], v20 offset:30080
    s_waitcnt lgkmcnt(6)
    v_mfma_f32_16x16x32_bf16 v[56:59], v[40:43], a[24:27], v[56:59]
    ds_read_b64_tr_b16 v[36:37], v20 offset:27808
    v_mfma_f32_16x16x32_bf16 v[92:95], v[40:43], a[28:31], v[92:95]
    ds_read_b64_tr_b16 v[38:39], v20 offset:30112
    s_waitcnt lgkmcnt(6)
    v_mfma_f32_16x16x32_bf16 v[60:63], v[44:47], a[24:27], v[60:63]
    ds_read_b64_tr_b16 v[40:41], v20 offset:27840
    v_mfma_f32_16x16x32_bf16 v[96:99], v[44:47], a[28:31], v[96:99]
    ds_read_b64_tr_b16 v[42:43], v20 offset:30144
    ds_read_b32 v30, v29
    s_waitcnt lgkmcnt(7)
    v_mfma_f32_16x16x32_bf16 v[64:67], v[48:51], a[24:27], v[64:67]
    ds_read_b64_tr_b16 v[44:45], v20 offset:27872
    v_mfma_f32_16x16x32_bf16 v[100:103], v[48:51], a[28:31], v[100:103]
    ds_read_b64_tr_b16 v[46:47], v20 offset:30176
    s_waitcnt lgkmcnt(7)
    v_mfma_f32_16x16x32_bf16 v[68:71], v[32:35], a[24:27], v[68:71]
    ds_read_b64_tr_b16 v[48:49], v20 offset:27904
    v_mfma_f32_16x16x32_bf16 v[104:107], v[32:35], a[28:31], v[104:107]
    ds_read_b64_tr_b16 v[50:51], v20 offset:30208
    s_waitcnt lgkmcnt(7)
    v_mfma_f32_16x16x32_bf16 v[72:75], v[36:39], a[24:27], v[72:75]
    s_waitcnt lgkmcnt(4)
    v_cmp_gt_u32 vcc, 44, v30
    s_cbranch_vccz L_k2_c10_ok
L_k2_c10:
    ds_read_b32 v30, v29
    s_waitcnt lgkmcnt(0)
    v_cmp_gt_u32 vcc, 44, v30
    s_cbranch_vccnz L_k2_c10
L_k2_c10_ok:
    ds_read_b64_tr_b16 v[32:33], v21 offset:0
    v_mfma_f32_16x16x32_bf16 v[108:111], v[36:39], a[28:31], v[108:111]
    ds_read_b64_tr_b16 v[34:35], v21 offset:2304
    s_waitcnt lgkmcnt(7)
    v_mfma_f32_16x16x32_bf16 v[76:79], v[40:43], a[24:27], v[76:79]
    ds_read_b64_tr_b16 v[36:37], v21 offset:32
    v_mfma_f32_16x16x32_bf16 v[112:115], v[40:43], a[28:31], v[112:115]
    ds_read_b64_tr_b16 v[38:39], v21 offset:2336
    s_waitcnt lgkmcnt(6)
    v_mfma_f32_16x16x32_bf16 v[80:83], v[44:47], a[24:27], v[80:83]
    ds_read_b64_tr_b16 v[40:41], v21 offset:64
    v_mfma_f32_16x16x32_bf16 v[116:119], v[44:47], a[28:31], v[116:119]
    ds_read_b64_tr_b16 v[42:43], v21 offset:2368
    s_waitcnt lgkmcnt(6)
    v_mfma_f32_16x16x32_bf16 v[84:87], v[48:51], a[24:27], v[84:87]
    ds_read_b64_tr_b16 v[44:45], v21 offset:96
    v_mfma_f32_16x16x32_bf16 v[120:123], v[48:51], a[28:31], v[120:123]
    ds_read_b64_tr_b16 v[46:47], v21 offset:2400
    s_waitcnt vmcnt(0) lgkmcnt(6)
    v_mfma_f32_16x16x32_bf16 v[52:55], v[32:35], a[32:35], v[52:55]
    ds_read_b64_tr_b16 v[48:49], v21 offset:128
    v_mfma_f32_16x16x32_bf16 v[88:91], v[32:35], a[36:39], v[88:91]
    ds_read_b64_tr_b16 v[50:51], v21 offset:2432
    s_waitcnt lgkmcnt(6)
    v_mfma_f32_16x16x32_bf16 v[56:59], v[36:39], a[32:35], v[56:59]
    ds_read_b64_tr_b16 v[32:33], v21 offset:160
    v_mfma_f32_16x16x32_bf16 v[92:95], v[36:39], a[36:39], v[92:95]
    ds_read_b64_tr_b16 v[34:35], v21 offset:2464
    s_waitcnt lgkmcnt(6)
    v_mfma_f32_16x16x32_bf16 v[60:63], v[40:43], a[32:35], v[60:63]
    ds_read_b64_tr_b16 v[36:37], v21 offset:192
    v_mfma_f32_16x16x32_bf16 v[96:99], v[40:43], a[36:39], v[96:99]
    ds_read_b64_tr_b16 v[38:39], v21 offset:2496
    s_waitcnt lgkmcnt(6)
    v_mfma_f32_16x16x32_bf16 v[64:67], v[44:47], a[32:35], v[64:67]
    ds_read_b64_tr_b16 v[40:41], v21 offset:224
    v_mfma_f32_16x16x32_bf16 v[100:103], v[44:47], a[36:39], v[100:103]
    ds_read_b64_tr_b16 v[42:43], v21 offset:2528
    s_waitcnt lgkmcnt(6)
    v_mfma_f32_16x16x32_bf16 v[68:71], v[48:51], a[32:35], v[68:71]
    ds_read_b64_tr_b16 v[44:45], v21 offset:256
    v_mfma_f32_16x16x32_bf16 v[104:107], v[48:51], a[36:39], v[104:107]
    ds_read_b64_tr_b16 v[46:47], v21 offset:2560
    s_waitcnt lgkmcnt(6)
    v_mfma_f32_16x16x32_bf16 v[72:75], v[32:35], a[32:35], v[72:75]
    v_mfma_f32_16x16x32_bf16 v[108:111], v[32:35], a[36:39], v[108:111]
    s_waitcnt lgkmcnt(4)
    v_mfma_f32_16x16x32_bf16 v[76:79], v[36:39], a[32:35], v[76:79]
    v_mfma_f32_16x16x32_bf16 v[112:115], v[36:39], a[36:39], v[112:115]
    s_waitcnt lgkmcnt(2)
    v_mfma_f32_16x16x32_bf16 v[80:83], v[40:43], a[32:35], v[80:83]
    v_mfma_f32_16x16x32_bf16 v[116:119], v[40:43], a[36:39], v[116:119]
    s_waitcnt lgkmcnt(0)
    v_mfma_f32_16x16x32_bf16 v[84:87], v[44:47], a[32:35], v[84:87]
    v_mfma_f32_16x16x32_bf16 v[120:123], v[44:47], a[36:39], v[120:123]
    v_lshlrev_b32 v28, 4, v0
    s_nop 7
    s_cmp_lg_u32 s31, 0
    s_cbranch_scc1 L_k2_e0
    v_cvt_pk_bf16_f32 v32, v68, v69
    v_cvt_pk_bf16_f32 v33, v70, v71
    v_cvt_pk_bf16_f32 v34, v72, v73
    v_cvt_pk_bf16_f32 v35, v74, v75
    s_add_u32 s33, s40, 2048
    buffer_store_dwordx4 v[32:35], v28, s[12:15], s33 offen sc1
    v_cvt_pk_bf16_f32 v36, v76, v77
    v_cvt_pk_bf16_f32 v37, v78, v79
    v_cvt_pk_bf16_f32 v38, v80, v81
    v_cvt_pk_bf16_f32 v39, v82, v83
    s_add_u32 s33, s40, 3072
    buffer_store_dwordx4 v[36:39], v28, s[12:15], s33 offen sc1
    v_cvt_pk_bf16_f32 v40, v84, v85
    v_cvt_pk_bf16_f32 v41, v86, v87
    v_cvt_pk_bf16_f32 v42, v88, v89
    v_cvt_pk_bf16_f32 v43, v90, v91
    s_add_u32 s33, s40, 4096
    buffer_store_dwordx4 v[40:43], v28, s[12:15], s33 offen sc1
    v_cvt_pk_bf16_f32 v44, v92, v93
    v_cvt_pk_bf16_f32 v45, v94, v95
    v_cvt_pk_bf16_f32 v46, v96, v97
    v_cvt_pk_bf16_f32 v47, v98, v99
    s_add_u32 s33, s40, 5120
    buffer_store_dwordx4 v[44:47], v28, s[12:15], s33 offen sc1
    v_cvt_pk_bf16_f32 v48, v100, v101
    v_cvt_pk_bf16_f32 v49, v102, v103
    v_cvt_pk_bf16_f32 v50, v104, v105
    v_cvt_pk_bf16_f32 v51, v106, v107
    s_add_u32 s33, s40, 6144
    buffer_store_dwordx4 v[48:51], v28, s[12:15], s33 offen sc1
    v_cvt_pk_bf16_f32 v108, v108, v109
    v_cvt_pk_bf16_f32 v109, v110, v111
    v_cvt_pk_bf16_f32 v110, v112, v113
    v_cvt_pk_bf16_f32 v111, v114, v115
    s_add_u32 s33, s40, 7168
    buffer_store_dwordx4 v[108:111], v28, s[12:15], s33 offen sc1
    v_accvgpr_read_b32 v25, a96
    v_lshlrev_b32 v26, 16, v25
    v_and_b32 v27, 0xffff0000, v25
    v_add_f32 v52, v52, v26
    v_add_f32 v53, v53, v27
    v_accvgpr_read_b32 v25, a97
    v_lshlrev_b32 v26, 16, v25
    v_and_b32 v27, 0xffff0000, v25
    v_add_f32 v54, v54, v26
    v_add_f32 v55, v55, v27
    v_accvgpr_read_b32 v25, a98
    v_lshlrev_b32 v26, 16, v25
    v_and_b32 v27, 0xffff0000, v25
    v_add_f32 v52, v52, v26
    v_add_f32 v53, v53, v27
    v_accvgpr_read_b32 v25, a99
    v_lshlrev_b32 v26, 16, v25
    v_and_b32 v27, 0xffff0000, v25
    v_add_f32 v54, v54, v26
    v_add_f32 v55, v55, v27
    v_accvgpr_read_b32 v25, a100
    v_lshlrev_b32 v26, 16, v25
    v_and_b32 v27, 0xffff0000, v25
    v_add_f32 v56, v56, v26
    v_add_f32 v57, v57, v27
    v_accvgpr_read_b32 v25, a101
    v_lshlrev_b32 v26, 16, v25
    v_and_b32 v27, 0xffff0000, v25
    v_add_f32 v58, v58, v26
    v_add_f32 v59, v59, v27
    v_accvgpr_read_b32 v25, a102
    v_lshlrev_b32 v26, 16, v25
    v_and_b32 v27, 0xffff0000, v25
    v_add_f32 v56, v56, v26
    v_add_f32 v57, v57, v27
    v_accvgpr_read_b32 v25, a103
    v_lshlrev_b32 v26, 16, v25
    v_and_b32 v27, 0xffff0000, v25
    v_add_f32 v58, v58, v26
    v_add_f32 v59, v59, v27
    v_accvgpr_read_b32 v25, a104
    v_lshlrev_b32 v26, 16, v25
    v_and_b32 v27, 0xffff0000, v25
    v_add_f32 v60, v60, v26
    v_add_f32 v61, v61, v27
    v_accvgpr_read_b32 v25, a105
    v_lshlrev_b32 v26, 16, v25
    v_and_b32 v27, 0xffff0000, v25
    v_add_f32 v62, v62, v26
    v_add_f32 v63, v63, v27
    v_accvgpr_read_b32 v25, a106
    v_lshlrev_b32 v26, 16, v25
    v_and_b32 v27, 0xffff0000, v25
    v_add_f32 v60, v60, v26
    v_add_f32 v61, v61, v27
    v_accvgpr_read_b32 v25, a107
    v_lshlrev_b32 v26, 16, v25
    v_and_b32 v27, 0xffff0000, v25
    v_add_f32 v62, v62, v26
    v_add_f32 v63, v63, v27
    v_accvgpr_read_b32 v25, a108
    v_lshlrev_b32 v26, 16, v25
    v_and_b32 v27, 0xffff0000, v25
    v_add_f32 v64, v64, v26
    v_add_f32 v65, v65, v27
    v_accvgpr_read_b32 v25, a109
    v_lshlrev_b32 v26, 16, v25
    v_and_b32 v27, 0xffff0000, v25
    v_add_f32 v66, v66, v26
    v_add_f32 v67, v67, v27
    v_accvgpr_read_b32 v25, a110
    v_lshlrev_b32 v26, 16, v25
    v_and_b32 v27, 0xffff0000, v25
    v_add_f32 v64, v64, v26
    v_add_f32 v65, v65, v27
    v_accvgpr_read_b32 v25, a111
    v_lshlrev_b32 v26, 16, v25
    v_and_b32 v27, 0xffff0000, v25
    v_add_f32 v66, v66, v26
    v_add_f32 v67, v67, v27
    v_accvgpr_read_b32 v25, a112
    v_lshlrev_b32 v26, 16, v25
    v_and_b32 v27, 0xffff0000, v25
    v_add_f32 v116, v116, v26
    v_add_f32 v117, v117, v27
    v_accvgpr_read_b32 v25, a113
    v_lshlrev_b32 v26, 16, v25
    v_and_b32 v27, 0xffff0000, v25
    v_add_f32 v118, v118, v26
    v_add_f32 v119, v119, v27
    v_accvgpr_read_b32 v25, a114
    v_lshlrev_b32 v26, 16, v25
    v_and_b32 v27, 0xffff0000, v25
    v_add_f32 v116, v116, v26
    v_add_f32 v117, v117, v27
    v_accvgpr_read_b32 v25, a115
    v_lshlrev_b32 v26, 16, v25
    v_and_b32 v27, 0xffff0000, v25
    v_add_f32 v118, v118, v26
    v_add_f32 v119, v119, v27
    v_accvgpr_read_b32 v25, a116
    v_lshlrev_b32 v26, 16, v25
    v_and_b32 v27, 0xffff0000, v25
    v_add_f32 v120, v120, v26
    v_add_f32 v121, v121, v27
    v_accvgpr_read_b32 v25, a117
    v_lshlrev_b32 v26, 16, v25
    v_and_b32 v27, 0xffff0000, v25
    v_add_f32 v122, v122, v26
    v_add_f32 v123, v123, v27
    v_accvgpr_read_b32 v25, a118
    v_lshlrev_b32 v26, 16, v25
    v_and_b32 v27, 0xffff0000, v25
    v_add_f32 v120, v120, v26
    v_add_f32 v121, v121, v27
    v_accvgpr_read_b32 v25, a119
    v_lshlrev_b32 v26, 16, v25
    v_and_b32 v27, 0xffff0000, v25
    v_add_f32 v122, v122, v26
    v_add_f32 v123, v123, v27
    v_mov_b32 v25, 0
    s_waitcnt vmcnt(0)
    s_mov_b64 exec, 1
    buffer_atomic_add v31, v25, s[12:15], s56 offen sc1
    s_mov_b64 exec, -1
L_k2_e0_poll:
    buffer_load_dword v26, v25, s[12:15], s56 offen sc1
    s_waitcnt vmcnt(0)
    v_cmp_ne_u32 vcc, 4, v26
    s_cbranch_vccz L_k2_e0_ok
    s_sleep 1
    s_branch L_k2_e0_poll
L_k2_e0_ok:
    s_add_u32 s33, s40, 9216
    buffer_load_dwordx4 v[72:75], v28, s[12:15], s33 offen sc1
    s_add_u32 s33, s40, 10240
    buffer_load_dwordx4 v[80:83], v28, s[12:15], s33 offen sc1
    s_add_u32 s33, s40, 17408
    buffer_load_dwordx4 v[88:91], v28, s[12:15], s33 offen sc1
    s_add_u32 s33, s40, 18432
    buffer_load_dwordx4 v[96:99], v28, s[12:15], s33 offen sc1
    s_add_u32 s33, s40, 19456
    buffer_load_dwordx4 v[104:107], v28, s[12:15], s33 offen sc1
    s_add_u32 s33, s40, 26624
    buffer_load_dwordx4 v[112:115], v28, s[12:15], s33 offen sc1
    s_add_u32 s33, s40, 27648
    buffer_load_dwordx4 v[68:71], v28, s[12:15], s33 offen sc1
    s_add_u32 s33, s40, 28672
    buffer_load_dwordx4 v[76:79], v28, s[12:15], s33 offen sc1
    s_add_u32 s33, s40, 35840
    buffer_load_dwordx4 v[84:87], v28, s[12:15], s33 offen sc1
    s_waitcnt vmcnt(8)
    v_lshlrev_b32 v26, 16, v72
    v_and_b32 v27, 0xffff0000, v72
    v_add_f32 v52, v52, v26
    v_add_f32 v53, v53, v27
    v_lshlrev_b32 v26, 16, v73
    v_and_b32 v27, 0xffff0000, v73
    v_add_f32 v54, v54, v26
    v_add_f32 v55, v55, v27
    v_lshlrev_b32 v26, 16, v74
    v_and_b32 v27, 0xffff0000, v74
    v_add_f32 v56, v56, v26
    v_add_f32 v57, v57, v27
    v_lshlrev_b32 v26, 16, v75
    v_and_b32 v27, 0xffff0000, v75
    v_add_f32 v58, v58, v26
    v_add_f32 v59, v59, v27
    s_waitcnt vmcnt(7)
    v_lshlrev_b32 v26, 16, v80
    v_and_b32 v27, 0xffff0000, v80
    v_add_f32 v60, v60, v26
    v_add_f32 v61, v61, v27
    v_lshlrev_b32 v26, 16, v81
    v_and_b32 v27, 0xffff0000, v81
    v_add_f32 v62, v62, v26
    v_add_f32 v63, v63, v27
    v_lshlrev_b32 v26, 16, v82
    v_and_b32 v27, 0xffff0000, v82
    v_add_f32 v64, v64, v26
    v_add_f32 v65, v65, v27
    v_lshlrev_b32 v26, 16, v83
    v_and_b32 v27, 0xffff0000, v83
    v_add_f32 v66, v66, v26
    v_add_f32 v67, v67, v27
    s_waitcnt vmcnt(6)
    v_lshlrev_b32 v26, 16, v88
    v_and_b32 v27, 0xffff0000, v88
    v_add_f32 v116, v116, v26
    v_add_f32 v117, v117, v27
    v_lshlrev_b32 v26, 16, v89
    v_and_b32 v27, 0xffff0000, v89
    v_add_f32 v118, v118, v26
    v_add_f32 v119, v119, v27
    v_lshlrev_b32 v26, 16, v90
    v_and_b32 v27, 0xffff0000, v90
    v_add_f32 v120, v120, v26
    v_add_f32 v121, v121, v27
    v_lshlrev_b32 v26, 16, v91
    v_and_b32 v27, 0xffff0000, v91
    v_add_f32 v122, v122, v26
    v_add_f32 v123, v123, v27
    s_waitcnt vmcnt(5)
    v_lshlrev_b32 v26, 16, v96
    v_and_b32 v27, 0xffff0000, v96
    v_add_f32 v52, v52, v26
    v_add_f32 v53, v53, v27
    v_lshlrev_b32 v26, 16, v97
    v_and_b32 v27, 0xffff0000, v97
    v_add_f32 v54, v54, v26
    v_add_f32 v55, v55, v27
    v_lshlrev_b32 v26, 16, v98
    v_and_b32 v27, 0xffff0000, v98
    v_add_f32 v56, v56, v26
    v_add_f32 v57, v57, v27
    v_lshlrev_b32 v26, 16, v99
    v_and_b32 v27, 0xffff0000, v99
    v_add_f32 v58, v58, v26
    v_add_f32 v59, v59, v27
    s_waitcnt vmcnt(4)
    v_lshlrev_b32 v26, 16, v104
    v_and_b32 v27, 0xffff0000, v104
    v_add_f32 v60, v60, v26
    v_add_f32 v61, v61, v27
    v_lshlrev_b32 v26, 16, v105
    v_and_b32 v27, 0xffff0000, v105
    v_add_f32 v62, v62, v26
    v_add_f32 v63, v63, v27
    v_lshlrev_b32 v26, 16, v106
    v_and_b32 v27, 0xffff0000, v106
    v_add_f32 v64, v64, v26
    v_add_f32 v65, v65, v27
    v_lshlrev_b32 v26, 16, v107
    v_and_b32 v27, 0xffff0000, v107
    v_add_f32 v66, v66, v26
    v_add_f32 v67, v67, v27
    s_waitcnt vmcnt(3)
    v_lshlrev_b32 v26, 16, v112
    v_and_b32 v27, 0xffff0000, v112
    v_add_f32 v116, v116, v26
    v_add_f32 v117, v117, v27
    v_lshlrev_b32 v26, 16, v113
    v_and_b32 v27, 0xffff0000, v113
    v_add_f32 v118, v118, v26
    v_add_f32 v119, v119, v27
    v_lshlrev_b32 v26, 16, v114
    v_and_b32 v27, 0xffff0000, v114
    v_add_f32 v120, v120, v26
    v_add_f32 v121, v121, v27
    v_lshlrev_b32 v26, 16, v115
    v_and_b32 v27, 0xffff0000, v115
    v_add_f32 v122, v122, v26
    v_add_f32 v123, v123, v27
    s_waitcnt vmcnt(2)
    v_lshlrev_b32 v26, 16, v68
    v_and_b32 v27, 0xffff0000, v68
    v_add_f32 v52, v52, v26
    v_add_f32 v53, v53, v27
    v_lshlrev_b32 v26, 16, v69
    v_and_b32 v27, 0xffff0000, v69
    v_add_f32 v54, v54, v26
    v_add_f32 v55, v55, v27
    v_lshlrev_b32 v26, 16, v70
    v_and_b32 v27, 0xffff0000, v70
    v_add_f32 v56, v56, v26
    v_add_f32 v57, v57, v27
    v_lshlrev_b32 v26, 16, v71
    v_and_b32 v27, 0xffff0000, v71
    v_add_f32 v58, v58, v26
    v_add_f32 v59, v59, v27
    s_waitcnt vmcnt(1)
    v_lshlrev_b32 v26, 16, v76
    v_and_b32 v27, 0xffff0000, v76
    v_add_f32 v60, v60, v26
    v_add_f32 v61, v61, v27
    v_lshlrev_b32 v26, 16, v77
    v_and_b32 v27, 0xffff0000, v77
    v_add_f32 v62, v62, v26
    v_add_f32 v63, v63, v27
    v_lshlrev_b32 v26, 16, v78
    v_and_b32 v27, 0xffff0000, v78
    v_add_f32 v64, v64, v26
    v_add_f32 v65, v65, v27
    v_lshlrev_b32 v26, 16, v79
    v_and_b32 v27, 0xffff0000, v79
    v_add_f32 v66, v66, v26
    v_add_f32 v67, v67, v27
    s_waitcnt vmcnt(0)
    v_lshlrev_b32 v26, 16, v84
    v_and_b32 v27, 0xffff0000, v84
    v_add_f32 v116, v116, v26
    v_add_f32 v117, v117, v27
    v_lshlrev_b32 v26, 16, v85
    v_and_b32 v27, 0xffff0000, v85
    v_add_f32 v118, v118, v26
    v_add_f32 v119, v119, v27
    v_lshlrev_b32 v26, 16, v86
    v_and_b32 v27, 0xffff0000, v86
    v_add_f32 v120, v120, v26
    v_add_f32 v121, v121, v27
    v_lshlrev_b32 v26, 16, v87
    v_and_b32 v27, 0xffff0000, v87
    v_add_f32 v122, v122, v26
    v_add_f32 v123, v123, v27
    v_cvt_pk_bf16_f32 v52, v52, v53
    v_cvt_pk_bf16_f32 v53, v54, v55
    s_add_u32 s33, s57, 0
    buffer_store_dwordx2 v[52:53], v126, s[24:27], s33 offen
    v_cvt_pk_bf16_f32 v56, v56, v57
    v_cvt_pk_bf16_f32 v57, v58, v59
    s_add_u32 s33, s57, 32
    buffer_store_dwordx2 v[56:57], v126, s[24:27], s33 offen
    v_cvt_pk_bf16_f32 v60, v60, v61
    v_cvt_pk_bf16_f32 v61, v62, v63
    s_add_u32 s33, s57, 64
    buffer_store_dwordx2 v[60:61], v126, s[24:27], s33 offen
    v_cvt_pk_bf16_f32 v64, v64, v65
    v_cvt_pk_bf16_f32 v65, v66, v67
    s_add_u32 s33, s57, 96
    buffer_store_dwordx2 v[64:65], v126, s[24:27], s33 offen
    v_cvt_pk_bf16_f32 v116, v116, v117
    v_cvt_pk_bf16_f32 v117, v118, v119
    s_add_u32 s33, s57, 18656
    buffer_store_dwordx2 v[116:117], v126, s[24:27], s33 offen
    v_cvt_pk_bf16_f32 v120, v120, v121
    v_cvt_pk_bf16_f32 v121, v122, v123
    s_add_u32 s33, s57, 18688
    buffer_store_dwordx2 v[120:121], v126, s[24:27], s33 offen
    s_branch L_k2_fin
L_k2_e0:
    s_cmp_lg_u32 s31, 1
    s_cbranch_scc1 L_k2_e1
    v_cvt_pk_bf16_f32 v32, v52, v53
    v_cvt_pk_bf16_f32 v33, v54, v55
    v_cvt_pk_bf16_f32 v34, v56, v57
    v_cvt_pk_bf16_f32 v35, v58, v59
    s_add_u32 s33, s40, 9216
    buffer_store_dwordx4 v[32:35], v28, s[12:15], s33 offen sc1
    v_cvt_pk_bf16_f32 v36, v60, v61
    v_cvt_pk_bf16_f32 v37, v62, v63
    v_cvt_pk_bf16_f32 v38, v64, v65
    v_cvt_pk_bf16_f32 v39, v66, v67
    s_add_u32 s33, s40, 10240
    buffer_store_dwordx4 v[36:39], v28, s[12:15], s33 offen sc1
    v_cvt_pk_bf16_f32 v40, v84, v85
    v_cvt_pk_bf16_f32 v41, v86, v87
    v_cvt_pk_bf16_f32 v42, v88, v89
    v_cvt_pk_bf16_f32 v43, v90, v91
    s_add_u32 s33, s40, 13312
    buffer_store_dwordx4 v[40:43], v28, s[12:15], s33 offen sc1
    v_cvt_pk_bf16_f32 v44, v92, v93
    v_cvt_pk_bf16_f32 v45, v94, v95
    v_cvt_pk_bf16_f32 v46, v96, v97
    v_cvt_pk_bf16_f32 v47, v98, v99
    s_add_u32 s33, s40, 14336
    buffer_store_dwordx4 v[44:47], v28, s[12:15], s33 offen sc1
    v_cvt_pk_bf16_f32 v48, v100, v101
    v_cvt_pk_bf16_f32 v49, v102, v103
    v_cvt_pk_bf16_f32 v50, v104, v105
    v_cvt_pk_bf16_f32 v51, v106, v107
    s_add_u32 s33, s40, 15360
    buffer_store_dwordx4 v[48:51], v28, s[12:15], s33 offen sc1
    v_cvt_pk_bf16_f32 v108, v108, v109
    v_cvt_pk_bf16_f32 v109, v110, v111
    v_cvt_pk_bf16_f32 v110, v112, v113
    v_cvt_pk_bf16_f32 v111, v114, v115
    s_add_u32 s33, s40, 16384
    buffer_store_dwordx4 v[108:111], v28, s[12:15], s33 offen sc1
    v_cvt_pk_bf16_f32 v116, v116, v117
    v_cvt_pk_bf16_f32 v117, v118, v119
    v_cvt_pk_bf16_f32 v118, v120, v121
    v_cvt_pk_bf16_f32 v119, v122, v123
    s_add_u32 s33, s40, 17408
    buffer_store_dwordx4 v[116:119], v28, s[12:15], s33 offen sc1
    v_accvgpr_read_b32 v25, a96
    v_lshlrev_b32 v26, 16, v25
    v_and_b32 v27, 0xffff0000, v25
    v_add_f32 v68, v68, v26
    v_add_f32 v69, v69, v27
    v_accvgpr_read_b32 v25, a97
    v_lshlrev_b32 v26, 16, v25
    v_and_b32 v27, 0xffff0000, v25
    v_add_f32 v70, v70, v26
    v_add_f32 v71, v71, v27
    v_accvgpr_read_b32 v25, a98
    v_lshlrev_b32 v26, 16, v25
    v_and_b32 v27, 0xffff0000, v25
    v_add_f32 v68, v68, v26
    v_add_f32 v69, v69, v27
    v_accvgpr_read_b32 v25, a99
    v_lshlrev_b32 v26, 16, v25
    v_and_b32 v27, 0xffff0000, v25
    v_add_f32 v70, v70, v26
    v_add_f32 v71, v71, v27
    v_accvgpr_read_b32 v25, a100
    v_lshlrev_b32 v26, 16, v25
    v_and_b32 v27, 0xffff0000, v25
    v_add_f32 v72, v72, v26
    v_add_f32 v73, v73, v27
    v_accvgpr_read_b32 v25, a101
    v_lshlrev_b32 v26, 16, v25
    v_and_b32 v27, 0xffff0000, v25
    v_add_f32 v74, v74, v26
    v_add_f32 v75, v75, v27
    v_accvgpr_read_b32 v25, a102
    v_lshlrev_b32 v26, 16, v25
    v_and_b32 v27, 0xffff0000, v25
    v_add_f32 v72, v72, v26
    v_add_f32 v73, v73, v27
    v_accvgpr_read_b32 v25, a103
    v_lshlrev_b32 v26, 16, v25
    v_and_b32 v27, 0xffff0000, v25
    v_add_f32 v74, v74, v26
    v_add_f32 v75, v75, v27
    v_accvgpr_read_b32 v25, a104
    v_lshlrev_b32 v26, 16, v25
    v_and_b32 v27, 0xffff0000, v25
    v_add_f32 v76, v76, v26
    v_add_f32 v77, v77, v27
    v_accvgpr_read_b32 v25, a105
    v_lshlrev_b32 v26, 16, v25
    v_and_b32 v27, 0xffff0000, v25
    v_add_f32 v78, v78, v26
    v_add_f32 v79, v79, v27
    v_accvgpr_read_b32 v25, a106
    v_lshlrev_b32 v26, 16, v25
    v_and_b32 v27, 0xffff0000, v25
    v_add_f32 v76, v76, v26
    v_add_f32 v77, v77, v27
    v_accvgpr_read_b32 v25, a107
    v_lshlrev_b32 v26, 16, v25
    v_and_b32 v27, 0xffff0000, v25
    v_add_f32 v78, v78, v26
    v_add_f32 v79, v79, v27
    v_accvgpr_read_b32 v25, a108
    v_lshlrev_b32 v26, 16, v25
    v_and_b32 v27, 0xffff0000, v25
    v_add_f32 v80, v80, v26
    v_add_f32 v81, v81, v27
    v_accvgpr_read_b32 v25, a109
    v_lshlrev_b32 v26, 16, v25
    v_and_b32 v27, 0xffff0000, v25
    v_add_f32 v82, v82, v26
    v_add_f32 v83, v83, v27
    v_accvgpr_read_b32 v25, a110
    v_lshlrev_b32 v26, 16, v25
    v_and_b32 v27, 0xffff0000, v25
    v_add_f32 v80, v80, v26
    v_add_f32 v81, v81, v27
    v_accvgpr_read_b32 v25, a111
    v_lshlrev_b32 v26, 16, v25
    v_and_b32 v27, 0xffff0000, v25
    v_add_f32 v82, v82, v26
    v_add_f32 v83, v83, v27
    v_mov_b32 v25, 0
    s_waitcnt vmcnt(0)
    s_mov_b64 exec, 1
    buffer_atomic_add v31, v25, s[12:15], s56 offen sc1
    s_mov_b64 exec, -1
L_k2_e1_poll:
    buffer_load_dword v26, v25, s[12:15], s56 offen sc1
    s_waitcnt vmcnt(0)
    v_cmp_ne_u32 vcc, 4, v26
    s_cbranch_vccz L_k2_e1_ok
    s_sleep 1
    s_branch L_k2_e1_poll
L_k2_e1_ok:
    s_add_u32 s33, s40, 2048
    buffer_load_dwordx4 v[56:59], v28, s[12:15], s33 offen sc1
    s_add_u32 s33, s40, 3072
    buffer_load_dwordx4 v[64:67], v28, s[12:15], s33 offen sc1
    s_add_u32 s33, s40, 20480
    buffer_load_dwordx4 v[88:91], v28, s[12:15], s33 offen sc1
    s_add_u32 s33, s40, 21504
    buffer_load_dwordx4 v[96:99], v28, s[12:15], s33 offen sc1
    s_add_u32 s33, s40, 29696
    buffer_load_dwordx4 v[104:107], v28, s[12:15], s33 offen sc1
    s_add_u32 s33, s40, 30720
    buffer_load_dwordx4 v[112:115], v28, s[12:15], s33 offen sc1
    s_waitcnt vmcnt(5)
    v_lshlrev_b32 v26, 16, v56
    v_and_b32 v27, 0xffff0000, v56
    v_add_f32 v68, v68, v26
    v_add_f32 v69, v69, v27
    v_lshlrev_b32 v26, 16, v57
    v_and_b32 v27, 0xffff0000, v57
    v_add_f32 v70, v70, v26
    v_add_f32 v71, v71, v27
    v_lshlrev_b32 v26, 16, v58
    v_and_b32 v27, 0xffff0000, v58
    v_add_f32 v72, v72, v26
    v_add_f32 v73, v73, v27
    v_lshlrev_b32 v26, 16, v59
    v_and_b32 v27, 0xffff0000, v59
    v_add_f32 v74, v74, v26
    v_add_f32 v75, v75, v27
    s_waitcnt vmcnt(4)
    v_lshlrev_b32 v26, 16, v64
    v_and_b32 v27, 0xffff0000, v64
    v_add_f32 v76, v76, v26
    v_add_f32 v77, v77, v27
    v_lshlrev_b32 v26, 16, v65
    v_and_b32 v27, 0xffff0000, v65
    v_add_f32 v78, v78, v26
    v_add_f32 v79, v79, v27
    v_lshlrev_b32 v26, 16, v66
    v_and_b32 v27, 0xffff0000, v66
    v_add_f32 v80, v80, v26
    v_add_f32 v81, v81, v27
    v_lshlrev_b32 v26, 16, v67
    v_and_b32 v27, 0xffff0000, v67
    v_add_f32 v82, v82, v26
    v_add_f32 v83, v83, v27
    s_waitcnt vmcnt(3)
    v_lshlrev_b32 v26, 16, v88
    v_and_b32 v27, 0xffff0000, v88
    v_add_f32 v68, v68, v26
    v_add_f32 v69, v69, v27
    v_lshlrev_b32 v26, 16, v89
    v_and_b32 v27, 0xffff0000, v89
    v_add_f32 v70, v70, v26
    v_add_f32 v71, v71, v27
    v_lshlrev_b32 v26, 16, v90
    v_and_b32 v27, 0xffff0000, v90
    v_add_f32 v72, v72, v26
    v_add_f32 v73, v73, v27
    v_lshlrev_b32 v26, 16, v91
    v_and_b32 v27, 0xffff0000, v91
    v_add_f32 v74, v74, v26
    v_add_f32 v75, v75, v27
    s_waitcnt vmcnt(2)
    v_lshlrev_b32 v26, 16, v96
    v_and_b32 v27, 0xffff0000, v96
    v_add_f32 v76, v76, v26
    v_add_f32 v77, v77, v27
    v_lshlrev_b32 v26, 16, v97
    v_and_b32 v27, 0xffff0000, v97
    v_add_f32 v78, v78, v26
    v_add_f32 v79, v79, v27
    v_lshlrev_b32 v26, 16, v98
    v_and_b32 v27, 0xffff0000, v98
    v_add_f32 v80, v80, v26
    v_add_f32 v81, v81, v27
    v_lshlrev_b32 v26, 16, v99
    v_and_b32 v27, 0xffff0000, v99
    v_add_f32 v82, v82, v26
    v_add_f32 v83, v83, v27
    s_waitcnt vmcnt(1)
    v_lshlrev_b32 v26, 16, v104
    v_and_b32 v27, 0xffff0000, v104
    v_add_f32 v68, v68, v26
    v_add_f32 v69, v69, v27
    v_lshlrev_b32 v26, 16, v105
    v_and_b32 v27, 0xffff0000, v105
    v_add_f32 v70, v70, v26
    v_add_f32 v71, v71, v27
    v_lshlrev_b32 v26, 16, v106
    v_and_b32 v27, 0xffff0000, v106
    v_add_f32 v72, v72, v26
    v_add_f32 v73, v73, v27
    v_lshlrev_b32 v26, 16, v107
    v_and_b32 v27, 0xffff0000, v107
    v_add_f32 v74, v74, v26
    v_add_f32 v75, v75, v27
    s_waitcnt vmcnt(0)
    v_lshlrev_b32 v26, 16, v112
    v_and_b32 v27, 0xffff0000, v112
    v_add_f32 v76, v76, v26
    v_add_f32 v77, v77, v27
    v_lshlrev_b32 v26, 16, v113
    v_and_b32 v27, 0xffff0000, v113
    v_add_f32 v78, v78, v26
    v_add_f32 v79, v79, v27
    v_lshlrev_b32 v26, 16, v114
    v_and_b32 v27, 0xffff0000, v114
    v_add_f32 v80, v80, v26
    v_add_f32 v81, v81, v27
    v_lshlrev_b32 v26, 16, v115
    v_and_b32 v27, 0xffff0000, v115
    v_add_f32 v82, v82, v26
    v_add_f32 v83, v83, v27
    v_cvt_pk_bf16_f32 v68, v68, v69
    v_cvt_pk_bf16_f32 v69, v70, v71
    s_add_u32 s33, s57, 128
    buffer_store_dwordx2 v[68:69], v126, s[24:27], s33 offen
    v_cvt_pk_bf16_f32 v72, v72, v73
    v_cvt_pk_bf16_f32 v73, v74, v75
    s_add_u32 s33, s57, 160
    buffer_store_dwordx2 v[72:73], v126, s[24:27], s33 offen
    v_cvt_pk_bf16_f32 v76, v76, v77
    v_cvt_pk_bf16_f32 v77, v78, v79
    s_add_u32 s33, s57, 192
    buffer_store_dwordx2 v[76:77], v126, s[24:27], s33 offen
    v_cvt_pk_bf16_f32 v80, v80, v81
    v_cvt_pk_bf16_f32 v81, v82, v83
    s_add_u32 s33, s57, 224
    buffer_store_dwordx2 v[80:81], v126, s[24:27], s33 offen
    s_branch L_k2_fin
L_k2_e1:
    s_cmp_lg_u32 s31, 2
    s_cbranch_scc1 L_k2_e2
    v_cvt_pk_bf16_f32 v32, v52, v53
    v_cvt_pk_bf16_f32 v33, v54, v55
    v_cvt_pk_bf16_f32 v34, v56, v57
    v_cvt_pk_bf16_f32 v35, v58, v59
    s_add_u32 s33, s40, 18432
    buffer_store_dwordx4 v[32:35], v28, s[12:15], s33 offen sc1
    v_cvt_pk_bf16_f32 v36, v60, v61
    v_cvt_pk_bf16_f32 v37, v62, v63
    v_cvt_pk_bf16_f32 v38, v64, v65
    v_cvt_pk_bf16_f32 v39, v66, v67
    s_add_u32 s33, s40, 19456
    buffer_store_dwordx4 v[36:39], v28, s[12:15], s33 offen sc1
    v_cvt_pk_bf16_f32 v40, v68, v69
    v_cvt_pk_bf16_f32 v41, v70, v71
    v_cvt_pk_bf16_f32 v42, v72, v73
    v_cvt_pk_bf16_f32 v43, v74, v75
    s_add_u32 s33, s40, 20480
    buffer_store_dwordx4 v[40:43], v28, s[12:15], s33 offen sc1
    v_cvt_pk_bf16_f32 v44, v76, v77
    v_cvt_pk_bf16_f32 v45, v78, v79
    v_cvt_pk_bf16_f32 v46, v80, v81
    v_cvt_pk_bf16_f32 v47, v82, v83
    s_add_u32 s33, s40, 21504
    buffer_store_dwordx4 v[44:47], v28, s[12:15], s33 offen sc1
    v_cvt_pk_bf16_f32 v48, v100, v101
    v_cvt_pk_bf16_f32 v49, v102, v103
    v_cvt_pk_bf16_f32 v50, v104, v105
    v_cvt_pk_bf16_f32 v51, v106, v107
    s_add_u32 s33, s40, 24576
    buffer_store_dwordx4 v[48:51], v28, s[12:15], s33 offen sc1
    v_cvt_pk_bf16_f32 v108, v108, v109
    v_cvt_pk_bf16_f32 v109, v110, v111
    v_cvt_pk_bf16_f32 v110, v112, v113
    v_cvt_pk_bf16_f32 v111, v114, v115
    s_add_u32 s33, s40, 25600
    buffer_store_dwordx4 v[108:111], v28, s[12:15], s33 offen sc1
    v_cvt_pk_bf16_f32 v116, v116, v117
    v_cvt_pk_bf16_f32 v117, v118, v119
    v_cvt_pk_bf16_f32 v118, v120, v121
    v_cvt_pk_bf16_f32 v119, v122, v123
    s_add_u32 s33, s40, 26624
    buffer_store_dwordx4 v[116:119], v28, s[12:15], s33 offen sc1
    v_accvgpr_read_b32 v25, a96
    v_lshlrev_b32 v26, 16, v25
    v_and_b32 v27, 0xffff0000, v25
    v_add_f32 v84, v84, v26
    v_add_f32 v85, v85, v27
    v_accvgpr_read_b32 v25, a97
    v_lshlrev_b32 v26, 16, v25
    v_and_b32 v27, 0xffff0000, v25
    v_add_f32 v86, v86, v26
    v_add_f32 v87, v87, v27
    v_accvgpr_read_b32 v25, a98
    v_lshlrev_b32 v26, 16, v25
    v_and_b32 v27, 0xffff0000, v25
    v_add_f32 v84, v84, v26
    v_add_f32 v85, v85, v27
    v_accvgpr_read_b32 v25, a99
    v_lshlrev_b32 v26, 16, v25
    v_and_b32 v27, 0xffff0000, v25
    v_add_f32 v86, v86, v26
    v_add_f32 v87, v87, v27
    v_accvgpr_read_b32 v25, a100
    v_lshlrev_b32 v26, 16, v25
    v_and_b32 v27, 0xffff0000, v25
    v_add_f32 v88, v88, v26
    v_add_f32 v89, v89, v27
    v_accvgpr_read_b32 v25, a101
    v_lshlrev_b32 v26, 16, v25
    v_and_b32 v27, 0xffff0000, v25
    v_add_f32 v90, v90, v26
    v_add_f32 v91, v91, v27
    v_accvgpr_read_b32 v25, a102
    v_lshlrev_b32 v26, 16, v25
    v_and_b32 v27, 0xffff0000, v25
    v_add_f32 v88, v88, v26
    v_add_f32 v89, v89, v27
    v_accvgpr_read_b32 v25, a103
    v_lshlrev_b32 v26, 16, v25
    v_and_b32 v27, 0xffff0000, v25
    v_add_f32 v90, v90, v26
    v_add_f32 v91, v91, v27
    v_accvgpr_read_b32 v25, a104
    v_lshlrev_b32 v26, 16, v25
    v_and_b32 v27, 0xffff0000, v25
    v_add_f32 v92, v92, v26
    v_add_f32 v93, v93, v27
    v_accvgpr_read_b32 v25, a105
    v_lshlrev_b32 v26, 16, v25
    v_and_b32 v27, 0xffff0000, v25
    v_add_f32 v94, v94, v26
    v_add_f32 v95, v95, v27
    v_accvgpr_read_b32 v25, a106
    v_lshlrev_b32 v26, 16, v25
    v_and_b32 v27, 0xffff0000, v25
    v_add_f32 v92, v92, v26
    v_add_f32 v93, v93, v27
    v_accvgpr_read_b32 v25, a107
    v_lshlrev_b32 v26, 16, v25
    v_and_b32 v27, 0xffff0000, v25
    v_add_f32 v94, v94, v26
    v_add_f32 v95, v95, v27
    v_accvgpr_read_b32 v25, a108
    v_lshlrev_b32 v26, 16, v25
    v_and_b32 v27, 0xffff0000, v25
    v_add_f32 v96, v96, v26
    v_add_f32 v97, v97, v27
    v_accvgpr_read_b32 v25, a109
    v_lshlrev_b32 v26, 16, v25
    v_and_b32 v27, 0xffff0000, v25
    v_add_f32 v98, v98, v26
    v_add_f32 v99, v99, v27
    v_accvgpr_read_b32 v25, a110
    v_lshlrev_b32 v26, 16, v25
    v_and_b32 v27, 0xffff0000, v25
    v_add_f32 v96, v96, v26
    v_add_f32 v97, v97, v27
    v_accvgpr_read_b32 v25, a111
    v_lshlrev_b32 v26, 16, v25
    v_and_b32 v27, 0xffff0000, v25
    v_add_f32 v98, v98, v26
    v_add_f32 v99, v99, v27
    v_mov_b32 v25, 0
    s_waitcnt vmcnt(0)
    s_mov_b64 exec, 1
    buffer_atomic_add v31, v25, s[12:15], s56 offen sc1
    s_mov_b64 exec, -1
L_k2_e2_poll:
    buffer_load_dword v26, v25, s[12:15], s56 offen sc1
    s_waitcnt vmcnt(0)
    v_cmp_ne_u32 vcc, 4, v26
    s_cbranch_vccz L_k2_e2_ok
    s_sleep 1
    s_branch L_k2_e2_poll
L_k2_e2_ok:
    s_add_u32 s33, s40, 4096
    buffer_load_dwordx4 v[56:59], v28, s[12:15], s33 offen sc1
    s_add_u32 s33, s40, 5120
    buffer_load_dwordx4 v[64:67], v28, s[12:15], s33 offen sc1
    s_add_u32 s33, s40, 13312
    buffer_load_dwordx4 v[72:75], v28, s[12:15], s33 offen sc1
    s_add_u32 s33, s40, 14336
    buffer_load_dwordx4 v[80:83], v28, s[12:15], s33 offen sc1
    s_add_u32 s33, s40, 31744
    buffer_load_dwordx4 v[104:107], v28, s[12:15], s33 offen sc1
    s_add_u32 s33, s40, 32768
    buffer_load_dwordx4 v[112:115], v28, s[12:15], s33 offen sc1
    s_waitcnt vmcnt(5)
    v_lshlrev_b32 v26, 16, v56
    v_and_b32 v27, 0xffff0000, v56
    v_add_f32 v84, v84, v26
    v_add_f32 v85, v85, v27
    v_lshlrev_b32 v26, 16, v57
    v_and_b32 v27, 0xffff0000, v57
    v_add_f32 v86, v86, v26
    v_add_f32 v87, v87, v27
    v_lshlrev_b32 v26, 16, v58
    v_and_b32 v27, 0xffff0000, v58
    v_add_f32 v88, v88, v26
    v_add_f32 v89, v89, v27
    v_lshlrev_b32 v26, 16, v59
    v_and_b32 v27, 0xffff0000, v59
    v_add_f32 v90, v90, v26
    v_add_f32 v91, v91, v27
    s_waitcnt vmcnt(4)
    v_lshlrev_b32 v26, 16, v64
    v_and_b32 v27, 0xffff0000, v64
    v_add_f32 v92, v92, v26
    v_add_f32 v93, v93, v27
    v_lshlrev_b32 v26, 16, v65
    v_and_b32 v27, 0xffff0000, v65
    v_add_f32 v94, v94, v26
    v_add_f32 v95, v95, v27
    v_lshlrev_b32 v26, 16, v66
    v_and_b32 v27, 0xffff0000, v66
    v_add_f32 v96, v96, v26
    v_add_f32 v97, v97, v27
    v_lshlrev_b32 v26, 16, v67
    v_and_b32 v27, 0xffff0000, v67
    v_add_f32 v98, v98, v26
    v_add_f32 v99, v99, v27
    s_waitcnt vmcnt(3)
    v_lshlrev_b32 v26, 16, v72
    v_and_b32 v27, 0xffff0000, v72
    v_add_f32 v84, v84, v26
    v_add_f32 v85, v85, v27
    v_lshlrev_b32 v26, 16, v73
    v_and_b32 v27, 0xffff0000, v73
    v_add_f32 v86, v86, v26
    v_add_f32 v87, v87, v27
    v_lshlrev_b32 v26, 16, v74
    v_and_b32 v27, 0xffff0000, v74
    v_add_f32 v88, v88, v26
    v_add_f32 v89, v89, v27
    v_lshlrev_b32 v26, 16, v75
    v_and_b32 v27, 0xffff0000, v75
    v_add_f32 v90, v90, v26
    v_add_f32 v91, v91, v27
    s_waitcnt vmcnt(2)
    v_lshlrev_b32 v26, 16, v80
    v_and_b32 v27, 0xffff0000, v80
    v_add_f32 v92, v92, v26
    v_add_f32 v93, v93, v27
    v_lshlrev_b32 v26, 16, v81
    v_and_b32 v27, 0xffff0000, v81
    v_add_f32 v94, v94, v26
    v_add_f32 v95, v95, v27
    v_lshlrev_b32 v26, 16, v82
    v_and_b32 v27, 0xffff0000, v82
    v_add_f32 v96, v96, v26
    v_add_f32 v97, v97, v27
    v_lshlrev_b32 v26, 16, v83
    v_and_b32 v27, 0xffff0000, v83
    v_add_f32 v98, v98, v26
    v_add_f32 v99, v99, v27
    s_waitcnt vmcnt(1)
    v_lshlrev_b32 v26, 16, v104
    v_and_b32 v27, 0xffff0000, v104
    v_add_f32 v84, v84, v26
    v_add_f32 v85, v85, v27
    v_lshlrev_b32 v26, 16, v105
    v_and_b32 v27, 0xffff0000, v105
    v_add_f32 v86, v86, v26
    v_add_f32 v87, v87, v27
    v_lshlrev_b32 v26, 16, v106
    v_and_b32 v27, 0xffff0000, v106
    v_add_f32 v88, v88, v26
    v_add_f32 v89, v89, v27
    v_lshlrev_b32 v26, 16, v107
    v_and_b32 v27, 0xffff0000, v107
    v_add_f32 v90, v90, v26
    v_add_f32 v91, v91, v27
    s_waitcnt vmcnt(0)
    v_lshlrev_b32 v26, 16, v112
    v_and_b32 v27, 0xffff0000, v112
    v_add_f32 v92, v92, v26
    v_add_f32 v93, v93, v27
    v_lshlrev_b32 v26, 16, v113
    v_and_b32 v27, 0xffff0000, v113
    v_add_f32 v94, v94, v26
    v_add_f32 v95, v95, v27
    v_lshlrev_b32 v26, 16, v114
    v_and_b32 v27, 0xffff0000, v114
    v_add_f32 v96, v96, v26
    v_add_f32 v97, v97, v27
    v_lshlrev_b32 v26, 16, v115
    v_and_b32 v27, 0xffff0000, v115
    v_add_f32 v98, v98, v26
    v_add_f32 v99, v99, v27
    v_cvt_pk_bf16_f32 v84, v84, v85
    v_cvt_pk_bf16_f32 v85, v86, v87
    s_add_u32 s33, s57, 256
    buffer_store_dwordx2 v[84:85], v126, s[24:27], s33 offen
    v_cvt_pk_bf16_f32 v88, v88, v89
    v_cvt_pk_bf16_f32 v89, v90, v91
    s_add_u32 s33, s57, 18432
    buffer_store_dwordx2 v[88:89], v126, s[24:27], s33 offen
    v_cvt_pk_bf16_f32 v92, v92, v93
    v_cvt_pk_bf16_f32 v93, v94, v95
    s_add_u32 s33, s57, 18464
    buffer_store_dwordx2 v[92:93], v126, s[24:27], s33 offen
    v_cvt_pk_bf16_f32 v96, v96, v97
    v_cvt_pk_bf16_f32 v97, v98, v99
    s_add_u32 s33, s57, 18496
    buffer_store_dwordx2 v[96:97], v126, s[24:27], s33 offen
    s_branch L_k2_fin
L_k2_e2:
    s_cmp_lg_u32 s31, 3
    s_cbranch_scc1 L_k2_e3
    v_cvt_pk_bf16_f32 v32, v52, v53
    v_cvt_pk_bf16_f32 v33, v54, v55
    v_cvt_pk_bf16_f32 v34, v56, v57
    v_cvt_pk_bf16_f32 v35, v58, v59
    s_add_u32 s33, s40, 27648
    buffer_store_dwordx4 v[32:35], v28, s[12:15], s33 offen sc1
    v_cvt_pk_bf16_f32 v36, v60, v61
    v_cvt_pk_bf16_f32 v37, v62, v63
    v_cvt_pk_bf16_f32 v38, v64, v65
    v_cvt_pk_bf16_f32 v39, v66, v67
    s_add_u32 s33, s40, 28672
    buffer_store_dwordx4 v[36:39], v28, s[12:15], s33 offen sc1
    v_cvt_pk_bf16_f32 v40, v68, v69
    v_cvt_pk_bf16_f32 v41, v70, v71
    v_cvt_pk_bf16_f32 v42, v72, v73
    v_cvt_pk_bf16_f32 v43, v74, v75
    s_add_u32 s33, s40, 29696
    buffer_store_dwordx4 v[40:43], v28, s[12:15], s33 offen sc1
    v_cvt_pk_bf16_f32 v44, v76, v77
    v_cvt_pk_bf16_f32 v45, v78, v79
    v_cvt_pk_bf16_f32 v46, v80, v81
    v_cvt_pk_bf16_f32 v47, v82, v83
    s_add_u32 s33, s40, 30720
    buffer_store_dwordx4 v[44:47], v28, s[12:15], s33 offen sc1
    v_cvt_pk_bf16_f32 v48, v84, v85
    v_cvt_pk_bf16_f32 v49, v86, v87
    v_cvt_pk_bf16_f32 v50, v88, v89
    v_cvt_pk_bf16_f32 v51, v90, v91
    s_add_u32 s33, s40, 31744
    buffer_store_dwordx4 v[48:51], v28, s[12:15], s33 offen sc1
    v_cvt_pk_bf16_f32 v92, v92, v93
    v_cvt_pk_bf16_f32 v93, v94, v95
    v_cvt_pk_bf16_f32 v94, v96, v97
    v_cvt_pk_bf16_f32 v95, v98, v99
    s_add_u32 s33, s40, 32768
    buffer_store_dwordx4 v[92:95], v28, s[12:15], s33 offen sc1
    v_cvt_pk_bf16_f32 v116, v116, v117
    v_cvt_pk_bf16_f32 v117, v118, v119
    v_cvt_pk_bf16_f32 v118, v120, v121
    v_cvt_pk_bf16_f32 v119, v122, v123
    s_add_u32 s33, s40, 35840
    buffer_store_dwordx4 v[116:119], v28, s[12:15], s33 offen sc1
    v_accvgpr_read_b32 v25, a96
    v_lshlrev_b32 v26, 16, v25
    v_and_b32 v27, 0xffff0000, v25
    v_add_f32 v100, v100, v26
    v_add_f32 v101, v101, v27
    v_accvgpr_read_b32 v25, a97
    v_lshlrev_b32 v26, 16, v25
    v_and_b32 v27, 0xffff0000, v25
    v_add_f32 v102, v102, v26
    v_add_f32 v103, v103, v27
    v_accvgpr_read_b32 v25, a98
    v_lshlrev_b32 v26, 16, v25
    v_and_b32 v27, 0xffff0000, v25
    v_add_f32 v100, v100, v26
    v_add_f32 v101, v101, v27
    v_accvgpr_read_b32 v25, a99
    v_lshlrev_b32 v26, 16, v25
    v_and_b32 v27, 0xffff0000, v25
    v_add_f32 v102, v102, v26
    v_add_f32 v103, v103, v27
    v_accvgpr_read_b32 v25, a100
    v_lshlrev_b32 v26, 16, v25
    v_and_b32 v27, 0xffff0000, v25
    v_add_f32 v104, v104, v26
    v_add_f32 v105, v105, v27
    v_accvgpr_read_b32 v25, a101
    v_lshlrev_b32 v26, 16, v25
    v_and_b32 v27, 0xffff0000, v25
    v_add_f32 v106, v106, v26
    v_add_f32 v107, v107, v27
    v_accvgpr_read_b32 v25, a102
    v_lshlrev_b32 v26, 16, v25
    v_and_b32 v27, 0xffff0000, v25
    v_add_f32 v104, v104, v26
    v_add_f32 v105, v105, v27
    v_accvgpr_read_b32 v25, a103
    v_lshlrev_b32 v26, 16, v25
    v_and_b32 v27, 0xffff0000, v25
    v_add_f32 v106, v106, v26
    v_add_f32 v107, v107, v27
    v_accvgpr_read_b32 v25, a104
    v_lshlrev_b32 v26, 16, v25
    v_and_b32 v27, 0xffff0000, v25
    v_add_f32 v108, v108, v26
    v_add_f32 v109, v109, v27
    v_accvgpr_read_b32 v25, a105
    v_lshlrev_b32 v26, 16, v25
    v_and_b32 v27, 0xffff0000, v25
    v_add_f32 v110, v110, v26
    v_add_f32 v111, v111, v27
    v_accvgpr_read_b32 v25, a106
    v_lshlrev_b32 v26, 16, v25
    v_and_b32 v27, 0xffff0000, v25
    v_add_f32 v108, v108, v26
    v_add_f32 v109, v109, v27
    v_accvgpr_read_b32 v25, a107
    v_lshlrev_b32 v26, 16, v25
    v_and_b32 v27, 0xffff0000, v25
    v_add_f32 v110, v110, v26
    v_add_f32 v111, v111, v27
    v_accvgpr_read_b32 v25, a108
    v_lshlrev_b32 v26, 16, v25
    v_and_b32 v27, 0xffff0000, v25
    v_add_f32 v112, v112, v26
    v_add_f32 v113, v113, v27
    v_accvgpr_read_b32 v25, a109
    v_lshlrev_b32 v26, 16, v25
    v_and_b32 v27, 0xffff0000, v25
    v_add_f32 v114, v114, v26
    v_add_f32 v115, v115, v27
    v_accvgpr_read_b32 v25, a110
    v_lshlrev_b32 v26, 16, v25
    v_and_b32 v27, 0xffff0000, v25
    v_add_f32 v112, v112, v26
    v_add_f32 v113, v113, v27
    v_accvgpr_read_b32 v25, a111
    v_lshlrev_b32 v26, 16, v25
    v_and_b32 v27, 0xffff0000, v25
    v_add_f32 v114, v114, v26
    v_add_f32 v115, v115, v27
    v_mov_b32 v25, 0
    s_waitcnt vmcnt(0)
    s_mov_b64 exec, 1
    buffer_atomic_add v31, v25, s[12:15], s56 offen sc1
    s_mov_b64 exec, -1
L_k2_e3_poll:
    buffer_load_dword v26, v25, s[12:15], s56 offen sc1
    s_waitcnt vmcnt(0)
    v_cmp_ne_u32 vcc, 4, v26
    s_cbranch_vccz L_k2_e3_ok
    s_sleep 1
    s_branch L_k2_e3_poll
L_k2_e3_ok:
    s_add_u32 s33, s40, 6144
    buffer_load_dwordx4 v[56:59], v28, s[12:15], s33 offen sc1
    s_add_u32 s33, s40, 7168
    buffer_load_dwordx4 v[64:67], v28, s[12:15], s33 offen sc1
    s_add_u32 s33, s40, 15360
    buffer_load_dwordx4 v[72:75], v28, s[12:15], s33 offen sc1
    s_add_u32 s33, s40, 16384
    buffer_load_dwordx4 v[80:83], v28, s[12:15], s33 offen sc1
    s_add_u32 s33, s40, 24576
    buffer_load_dwordx4 v[88:91], v28, s[12:15], s33 offen sc1
    s_add_u32 s33, s40, 25600
    buffer_load_dwordx4 v[96:99], v28, s[12:15], s33 offen sc1
    s_waitcnt vmcnt(5)
    v_lshlrev_b32 v26, 16, v56
    v_and_b32 v27, 0xffff0000, v56
    v_add_f32 v100, v100, v26
    v_add_f32 v101, v101, v27
    v_lshlrev_b32 v26, 16, v57
    v_and_b32 v27, 0xffff0000, v57
    v_add_f32 v102, v102, v26
    v_add_f32 v103, v103, v27
    v_lshlrev_b32 v26, 16, v58
    v_and_b32 v27, 0xffff0000, v58
    v_add_f32 v104, v104, v26
    v_add_f32 v105, v105, v27
    v_lshlrev_b32 v26, 16, v59
    v_and_b32 v27, 0xffff0000, v59
    v_add_f32 v106, v106, v26
    v_add_f32 v107, v107, v27
    s_waitcnt vmcnt(4)
    v_lshlrev_b32 v26, 16, v64
    v_and_b32 v27, 0xffff0000, v64
    v_add_f32 v108, v108, v26
    v_add_f32 v109, v109, v27
    v_lshlrev_b32 v26, 16, v65
    v_and_b32 v27, 0xffff0000, v65
    v_add_f32 v110, v110, v26
    v_add_f32 v111, v111, v27
    v_lshlrev_b32 v26, 16, v66
    v_and_b32 v27, 0xffff0000, v66
    v_add_f32 v112, v112, v26
    v_add_f32 v113, v113, v27
    v_lshlrev_b32 v26, 16, v67
    v_and_b32 v27, 0xffff0000, v67
    v_add_f32 v114, v114, v26
    v_add_f32 v115, v115, v27
    s_waitcnt vmcnt(3)
    v_lshlrev_b32 v26, 16, v72
    v_and_b32 v27, 0xffff0000, v72
    v_add_f32 v100, v100, v26
    v_add_f32 v101, v101, v27
    v_lshlrev_b32 v26, 16, v73
    v_and_b32 v27, 0xffff0000, v73
    v_add_f32 v102, v102, v26
    v_add_f32 v103, v103, v27
    v_lshlrev_b32 v26, 16, v74
    v_and_b32 v27, 0xffff0000, v74
    v_add_f32 v104, v104, v26
    v_add_f32 v105, v105, v27
    v_lshlrev_b32 v26, 16, v75
    v_and_b32 v27, 0xffff0000, v75
    v_add_f32 v106, v106, v26
    v_add_f32 v107, v107, v27
    s_waitcnt vmcnt(2)
    v_lshlrev_b32 v26, 16, v80
    v_and_b32 v27, 0xffff0000, v80
    v_add_f32 v108, v108, v26
    v_add_f32 v109, v109, v27
    v_lshlrev_b32 v26, 16, v81
    v_and_b32 v27, 0xffff0000, v81
    v_add_f32 v110, v110, v26
    v_add_f32 v111, v111, v27
    v_lshlrev_b32 v26, 16, v82
    v_and_b32 v27, 0xffff0000, v82
    v_add_f32 v112, v112, v26
    v_add_f32 v113, v113, v27
    v_lshlrev_b32 v26, 16, v83
    v_and_b32 v27, 0xffff0000, v83
    v_add_f32 v114, v114, v26
    v_add_f32 v115, v115, v27
    s_waitcnt vmcnt(1)
    v_lshlrev_b32 v26, 16, v88
    v_and_b32 v27, 0xffff0000, v88
    v_add_f32 v100, v100, v26
    v_add_f32 v101, v101, v27
    v_lshlrev_b32 v26, 16, v89
    v_and_b32 v27, 0xffff0000, v89
    v_add_f32 v102, v102, v26
    v_add_f32 v103, v103, v27
    v_lshlrev_b32 v26, 16, v90
    v_and_b32 v27, 0xffff0000, v90
    v_add_f32 v104, v104, v26
    v_add_f32 v105, v105, v27
    v_lshlrev_b32 v26, 16, v91
    v_and_b32 v27, 0xffff0000, v91
    v_add_f32 v106, v106, v26
    v_add_f32 v107, v107, v27
    s_waitcnt vmcnt(0)
    v_lshlrev_b32 v26, 16, v96
    v_and_b32 v27, 0xffff0000, v96
    v_add_f32 v108, v108, v26
    v_add_f32 v109, v109, v27
    v_lshlrev_b32 v26, 16, v97
    v_and_b32 v27, 0xffff0000, v97
    v_add_f32 v110, v110, v26
    v_add_f32 v111, v111, v27
    v_lshlrev_b32 v26, 16, v98
    v_and_b32 v27, 0xffff0000, v98
    v_add_f32 v112, v112, v26
    v_add_f32 v113, v113, v27
    v_lshlrev_b32 v26, 16, v99
    v_and_b32 v27, 0xffff0000, v99
    v_add_f32 v114, v114, v26
    v_add_f32 v115, v115, v27
    v_cvt_pk_bf16_f32 v100, v100, v101
    v_cvt_pk_bf16_f32 v101, v102, v103
    s_add_u32 s33, s57, 18528
    buffer_store_dwordx2 v[100:101], v126, s[24:27], s33 offen
    v_cvt_pk_bf16_f32 v104, v104, v105
    v_cvt_pk_bf16_f32 v105, v106, v107
    s_add_u32 s33, s57, 18560
    buffer_store_dwordx2 v[104:105], v126, s[24:27], s33 offen
    v_cvt_pk_bf16_f32 v108, v108, v109
    v_cvt_pk_bf16_f32 v109, v110, v111
    s_add_u32 s33, s57, 18592
    buffer_store_dwordx2 v[108:109], v126, s[24:27], s33 offen
    v_cvt_pk_bf16_f32 v112, v112, v113
    v_cvt_pk_bf16_f32 v113, v114, v115
    s_add_u32 s33, s57, 18624
    buffer_store_dwordx2 v[112:113], v126, s[24:27], s33 offen
    s_branch L_k2_fin
L_k2_e3:
L_k2_att:
    s_setprio 2
    s_and_b32 s32, s28, 1
    s_lshl_b32 s42, s31, 3
    s_lshl_b32 s33, s30, 1
    s_add_u32 s42, s42, s33
    s_add_u32 s42, s42, s32
    s_and_b32 s32, s28, 2
    s_lshl_b32 s41, s29, 2
    s_add_u32 s41, s41, s32
    s_add_u32 s41, s41, 1
    s_mov_b32 s61, s41
    s_mul_i32 s32, s42, 18
    s_lshr_b32 s43, s32, 4
    s_and_b32 s44, s32, 15
    s_lshl_b32 s47, s32, 4
    s_add_u32 s47, s47, 4718592
    s_cmp_lg_u32 s28, 4
    s_cbranch_scc1 L_k2_ps
    v_mov_b32 v3, 0
    v_mov_b32 v4, 1
    s_mov_b64 exec, 1
    buffer_atomic_add v4, v3, s[12:15], s80 offen sc0 sc1
    s_mov_b64 exec, -1
    s_cmp_eq_u32 s30, 3
    s_cselect_b32 s33, 3, 2
    s_waitcnt vmcnt(0)
    v_readfirstlane_b32 s34, v4
    v_mov_b32 v5, 1
    s_nop 2
    s_cmp_lg_u32 s34, s33
    s_cbranch_scc1 L_k2_ps
    s_add_u32 s33, s80, 16384
    s_mov_b64 exec, 1
    buffer_store_dword v5, v3, s[12:15], s33 offen sc1
    s_mov_b64 exec, -1
L_k2_ps:
    v_min_u32 v3, 2, v0
    v_sub_u32 v3, s29, v3
    v_max_i32 v3, 0, v3
    v_lshlrev_b32 v3, 7, v3
    s_mov_b32 s33, 47623168
L_k2_pq:
    buffer_load_dword v4, v3, s[12:15], s33 offen sc1
    s_waitcnt vmcnt(0)
    v_cmp_ne_u32 vcc, 1, v4
    s_cbranch_vccz L_k2_pq_ok
    s_sleep 4
    s_branch L_k2_pq
L_k2_pq_ok:
    v_lshlrev_b32 v1, 4, v0
    s_lshl_b32 s34, s43, 10
    s_mul_i32 s33, s41, 73728
    s_add_u32 s33, s33, s34
    buffer_load_dwordx4 v[16:19], v1, s[12:15], s33 offen offset:0 sc1
    buffer_load_dwordx4 v[20:23], v1, s[12:15], s33 offen offset:1024 sc1
    s_add_u32 s46, s34, 36864
    s_sub_u32 s32, s61, 0
    s_max_i32 s32, s32, 0
    s_mul_i32 s32, s32, 73728
    s_add_u32 s32, s32, s46
    buffer_load_dwordx4 a[72:75], v1, s[12:15], s32 offen offset:0 sc1
    buffer_load_dwordx4 a[76:79], v1, s[12:15], s32 offen offset:1024 sc1
    s_sub_u32 s32, s61, 1
    s_max_i32 s32, s32, 0
    s_mul_i32 s32, s32, 73728
    s_add_u32 s32, s32, s46
    buffer_load_dwordx4 a[64:67], v1, s[12:15], s32 offen offset:0 sc1
    buffer_load_dwordx4 a[68:71], v1, s[12:15], s32 offen offset:1024 sc1
    s_sub_u32 s32, s61, 2
    s_max_i32 s32, s32, 0
    s_mul_i32 s32, s32, 73728
    s_add_u32 s32, s32, s46
    buffer_load_dwordx4 a[56:59], v1, s[12:15], s32 offen offset:0 sc1
    buffer_load_dwordx4 a[60:63], v1, s[12:15], s32 offen offset:1024 sc1
    s_sub_u32 s32, s61, 3
    s_max_i32 s32, s32, 0
    s_mul_i32 s32, s32, 73728
    s_add_u32 s32, s32, s46
    buffer_load_dwordx4 a[48:51], v1, s[12:15], s32 offen offset:0 sc1
    buffer_load_dwordx4 a[52:55], v1, s[12:15], s32 offen offset:1024 sc1
    s_sub_u32 s32, s61, 4
    s_max_i32 s32, s32, 0
    s_mul_i32 s32, s32, 73728
    s_add_u32 s32, s32, s46
    buffer_load_dwordx4 a[40:43], v1, s[12:15], s32 offen offset:0 sc1
    buffer_load_dwordx4 a[44:47], v1, s[12:15], s32 offen offset:1024 sc1
    s_sub_u32 s32, s61, 5
    s_max_i32 s32, s32, 0
    s_mul_i32 s32, s32, 73728
    s_add_u32 s32, s32, s46
    buffer_load_dwordx4 a[32:35], v1, s[12:15], s32 offen offset:0 sc1
    buffer_load_dwordx4 a[36:39], v1, s[12:15], s32 offen offset:1024 sc1
    s_sub_u32 s32, s61, 6
    s_max_i32 s32, s32, 0
    s_mul_i32 s32, s32, 73728
    s_add_u32 s32, s32, s46
    buffer_load_dwordx4 a[24:27], v1, s[12:15], s32 offen offset:0 sc1
    buffer_load_dwordx4 a[28:31], v1, s[12:15], s32 offen offset:1024 sc1
    s_sub_u32 s32, s61, 7
    s_max_i32 s32, s32, 0
    s_mul_i32 s32, s32, 73728
    s_add_u32 s32, s32, s46
    buffer_load_dwordx4 a[16:19], v1, s[12:15], s32 offen offset:0 sc1
    buffer_load_dwordx4 a[20:23], v1, s[12:15], s32 offen offset:1024 sc1
    s_sub_u32 s32, s61, 8
    s_max_i32 s32, s32, 0
    s_mul_i32 s32, s32, 73728
    s_add_u32 s32, s32, s46
    buffer_load_dwordx4 a[8:11], v1, s[12:15], s32 offen offset:0 sc1
    buffer_load_dwordx4 a[12:15], v1, s[12:15], s32 offen offset:1024 sc1
    s_sub_u32 s32, s61, 9
    s_max_i32 s32, s32, 0
    s_mul_i32 s32, s32, 73728
    s_add_u32 s32, s32, s46
    buffer_load_dwordx4 a[0:3], v1, s[12:15], s32 offen offset:0 sc1
    buffer_load_dwordx4 a[4:7], v1, s[12:15], s32 offen offset:1024 sc1
    s_sub_u32 s75, s33, 73728
    v_mov_b32 v5, 0x3f803f80
    v_accvgpr_write_b32 a80, v5
    v_accvgpr_write_b32 a81, v5
    v_accvgpr_write_b32 a82, v5
    v_accvgpr_write_b32 a83, v5
    v_accvgpr_write_b32 a84, v5
    v_accvgpr_write_b32 a85, v5
    v_accvgpr_write_b32 a86, v5
    v_accvgpr_write_b32 a87, v5
    v_accvgpr_write_b32 a88, v5
    v_accvgpr_write_b32 a89, v5
    v_accvgpr_write_b32 a90, v5
    v_accvgpr_write_b32 a91, v5
    v_accvgpr_write_b32 a92, v5
    v_accvgpr_write_b32 a93, v5
    v_accvgpr_write_b32 a94, v5
    v_accvgpr_write_b32 a95, v5
    v_accvgpr_write_b32 a96, v5
    v_accvgpr_write_b32 a97, v5
    v_accvgpr_write_b32 a98, v5
    v_accvgpr_write_b32 a99, v5
    v_accvgpr_write_b32 a100, v5
    v_accvgpr_write_b32 a101, v5
    v_accvgpr_write_b32 a102, v5
    v_accvgpr_write_b32 a103, v5
    v_accvgpr_write_b32 a104, v5
    v_accvgpr_write_b32 a105, v5
    v_accvgpr_write_b32 a106, v5
    v_accvgpr_write_b32 a107, v5
    v_accvgpr_write_b32 a108, v5
    v_accvgpr_write_b32 a109, v5
    v_accvgpr_write_b32 a110, v5
    v_accvgpr_write_b32 a111, v5
    v_accvgpr_write_b32 a112, v5
    v_accvgpr_write_b32 a113, v5
    v_accvgpr_write_b32 a114, v5
    v_accvgpr_write_b32 a115, v5
    v_accvgpr_write_b32 a116, v5
    v_accvgpr_write_b32 a117, v5
    v_accvgpr_write_b32 a118, v5
    v_accvgpr_write_b32 a119, v5
    v_accvgpr_write_b32 a120, v5
    v_accvgpr_write_b32 a121, v5
    v_accvgpr_write_b32 a122, v5
    v_accvgpr_write_b32 a123, v5
    v_accvgpr_write_b32 a124, v5
    v_accvgpr_write_b32 a125, v5
    v_accvgpr_write_b32 a126, v5
    v_accvgpr_write_b32 a127, v5
    v_and_b32 v5, 31, v0
    v_lshrrev_b32 v6, 5, v0
    s_movk_i32 s33, 9216
    v_lshlrev_b32 v2, 4, v5
    v_mad_u32_u24 v2, v6, s33, v2
    s_mov_b32 s52, 0x3ffff
    s_mov_b32 s53, 0x3ffff
    v_lshlrev_b32 v7, 2, v6
    v_sub_u32 v7, v5, v7
    v_mov_b32 v3, 0xf149f2ca
    v_cmp_le_i32 s[48:49], 0, v7
    v_cmp_le_i32 s[50:51], 1, v7
    s_nop 0
    v_cndmask_b32 v56, v3, 0, s[48:49]
    v_cndmask_b32 v72, 0, v3, s[48:49]
    v_cndmask_b32 v57, v3, 0, s[50:51]
    v_cndmask_b32 v73, 0, v3, s[50:51]
    v_cmp_le_i32 s[48:49], 2, v7
    v_cmp_le_i32 s[50:51], 3, v7
    s_nop 0
    v_cndmask_b32 v58, v3, 0, s[48:49]
    v_cndmask_b32 v74, 0, v3, s[48:49]
    v_cndmask_b32 v59, v3, 0, s[50:51]
    v_cndmask_b32 v75, 0, v3, s[50:51]
    v_cmp_le_i32 s[48:49], 8, v7
    v_cmp_le_i32 s[50:51], 9, v7
    s_nop 0
    v_cndmask_b32 v60, v3, 0, s[48:49]
    v_cndmask_b32 v76, 0, v3, s[48:49]
    v_cndmask_b32 v61, v3, 0, s[50:51]
    v_cndmask_b32 v77, 0, v3, s[50:51]
    v_cmp_le_i32 s[48:49], 10, v7
    v_cmp_le_i32 s[50:51], 11, v7
    s_nop 0
    v_cndmask_b32 v62, v3, 0, s[48:49]
    v_cndmask_b32 v78, 0, v3, s[48:49]
    v_cndmask_b32 v63, v3, 0, s[50:51]
    v_cndmask_b32 v79, 0, v3, s[50:51]
    v_cmp_le_i32 s[48:49], 16, v7
    v_cmp_le_i32 s[50:51], 17, v7
    s_nop 0
    v_cndmask_b32 v64, v3, 0, s[48:49]
    v_cndmask_b32 v80, 0, v3, s[48:49]
    v_cndmask_b32 v65, v3, 0, s[50:51]
    v_cndmask_b32 v81, 0, v3, s[50:51]
    v_cmp_le_i32 s[48:49], 18, v7
    v_cmp_le_i32 s[50:51], 19, v7
    s_nop 0
    v_cndmask_b32 v66, v3, 0, s[48:49]
    v_cndmask_b32 v82, 0, v3, s[48:49]
    v_cndmask_b32 v67, v3, 0, s[50:51]
    v_cndmask_b32 v83, 0, v3, s[50:51]
    v_cmp_le_i32 s[48:49], 24, v7
    v_cmp_le_i32 s[50:51], 25, v7
    s_nop 0
    v_cndmask_b32 v68, v3, 0, s[48:49]
    v_cndmask_b32 v84, 0, v3, s[48:49]
    v_cndmask_b32 v69, v3, 0, s[50:51]
    v_cndmask_b32 v85, 0, v3, s[50:51]
    v_cmp_le_i32 s[48:49], 26, v7
    v_cmp_le_i32 s[50:51], 27, v7
    s_nop 0
    v_cndmask_b32 v70, v3, 0, s[48:49]
    v_cndmask_b32 v86, 0, v3, s[48:49]
    v_cndmask_b32 v71, v3, 0, s[50:51]
    v_cndmask_b32 v87, 0, v3, s[50:51]
    v_lshlrev_b32 v7, 2, v6
    v_subrev_u32 v7, s44, v7
    v_and_b32 v3, 15, v0
    v_bfe_u32 v4, v0, 4, 1
    s_movk_i32 s33, 20480
    v_lshlrev_b32 v3, 4, v3
    v_mad_u32_u24 v3, v4, s33, v3
    v_lshl_add_u32 v5, v6, 8, v3
    v_cmp_eq_u32 vcc, 0, v6
    v_mov_b32 v4, 1073741824
    s_mul_i32 s32, s31, 5120
    v_cndmask_b32 v6, v4, v3, vcc
    s_add_u32 s32, s32, 25952256
    s_and_b32 s33, s42, 7
    s_lshl_b32 s34, s33, 9
    s_add_u32 s59, s32, s34
    s_lshr_b32 s34, s33, 2
    s_lshl_b32 s34, s34, 8
    s_and_b32 s33, s33, 3
    s_lshl_b32 s33, s33, 2
    s_add_u32 s60, s32, s34
    s_add_u32 s60, s60, s33
    s_add_u32 s60, s60, 4096
    s_waitcnt vmcnt(20)
    v_add_u32 v4, 0, v7
    v_cmp_gt_u32 s[48:49], 18, v4
    v_add_u32 v4, 2, v7
    v_cmp_gt_u32 s[50:51], 18, v4
    s_nop 0
    v_cndmask_b32 v16, 0, v16, s[48:49]
    v_cndmask_b32 v17, 0, v17, s[50:51]
    v_add_u32 v4, 8, v7
    v_cmp_gt_u32 s[48:49], 18, v4
    v_add_u32 v4, 10, v7
    v_cmp_gt_u32 s[50:51], 18, v4
    s_nop 0
    v_cndmask_b32 v18, 0, v18, s[48:49]
    v_cndmask_b32 v19, 0, v19, s[50:51]
    v_add_u32 v4, 16, v7
    v_cmp_gt_u32 s[48:49], 18, v4
    v_add_u32 v4, 18, v7
    v_cmp_gt_u32 s[50:51], 18, v4
    s_nop 0
    v_cndmask_b32 v20, 0, v20, s[48:49]
    v_cndmask_b32 v21, 0, v21, s[50:51]
    v_add_u32 v4, 24, v7
    v_cmp_gt_u32 s[48:49], 18, v4
    v_add_u32 v4, 26, v7
    v_cmp_gt_u32 s[50:51], 18, v4
    s_nop 0
    v_cndmask_b32 v22, 0, v22, s[48:49]
    v_cndmask_b32 v23, 0, v23, s[50:51]
    s_sub_u32 s45, 8, s41
    s_max_i32 s45, s45, 0
    v_mov_b32 v3, 0xf149f2ca
    v_mov_b32 v4, 0xf149f2ca
    s_waitcnt vmcnt(18)
    v_mfma_f32_32x32x16_bf16 v[24:39], a[72:75], v[16:19], v[56:71]
    v_mfma_f32_32x32x16_bf16 v[24:39], a[76:79], v[20:23], v[24:39]
    s_waitcnt vmcnt(16)
    v_mfma_f32_32x32x16_bf16 v[40:55], a[64:67], v[16:19], 0
    v_mfma_f32_32x32x16_bf16 v[40:55], a[68:71], v[20:23], v[40:55]
    s_nop 9
    v_max3_f32 v3, v24, v25, v3
    v_max3_f32 v4, v26, v27, v4
    v_max3_f32 v3, v28, v29, v3
    v_max3_f32 v4, v30, v31, v4
    v_max3_f32 v3, v32, v33, v3
    v_max3_f32 v4, v34, v35, v4
    v_max3_f32 v3, v36, v37, v3
    v_max3_f32 v4, v38, v39, v4
    s_cmp_eq_u32 s45, 8
    s_cbranch_scc1 L_k2_u1_p1end
    s_waitcnt vmcnt(14)
    v_mfma_f32_32x32x16_bf16 v[24:39], a[56:59], v[16:19], 0
    v_mfma_f32_32x32x16_bf16 v[24:39], a[60:63], v[20:23], v[24:39]
    s_nop 3
    v_max3_f32 v3, v40, v41, v3
    v_max3_f32 v4, v42, v43, v4
    v_max3_f32 v3, v44, v45, v3
    v_max3_f32 v4, v46, v47, v4
    v_max3_f32 v3, v48, v49, v3
    v_max3_f32 v4, v50, v51, v4
    v_max3_f32 v3, v52, v53, v3
    v_max3_f32 v4, v54, v55, v4
    s_cmp_eq_u32 s45, 7
    s_cbranch_scc1 L_k2_u1_p1end
    s_waitcnt vmcnt(12)
    v_mfma_f32_32x32x16_bf16 v[40:55], a[48:51], v[16:19], 0
    v_mfma_f32_32x32x16_bf16 v[40:55], a[52:55], v[20:23], v[40:55]
    s_nop 3
    v_max3_f32 v3, v24, v25, v3
    v_max3_f32 v4, v26, v27, v4
    v_max3_f32 v3, v28, v29, v3
    v_max3_f32 v4, v30, v31, v4
    v_max3_f32 v3, v32, v33, v3
    v_max3_f32 v4, v34, v35, v4
    v_max3_f32 v3, v36, v37, v3
    v_max3_f32 v4, v38, v39, v4
    s_cmp_eq_u32 s45, 6
    s_cbranch_scc1 L_k2_u1_p1end
    s_waitcnt vmcnt(10)
    v_mfma_f32_32x32x16_bf16 v[24:39], a[40:43], v[16:19], 0
    v_mfma_f32_32x32x16_bf16 v[24:39], a[44:47], v[20:23], v[24:39]
    s_nop 3
    v_max3_f32 v3, v40, v41, v3
    v_max3_f32 v4, v42, v43, v4
    v_max3_f32 v3, v44, v45, v3
    v_max3_f32 v4, v46, v47, v4
    v_max3_f32 v3, v48, v49, v3
    v_max3_f32 v4, v50, v51, v4
    v_max3_f32 v3, v52, v53, v3
    v_max3_f32 v4, v54, v55, v4
    s_cmp_eq_u32 s45, 5
    s_cbranch_scc1 L_k2_u1_p1end
    s_waitcnt vmcnt(8)
    v_mfma_f32_32x32x16_bf16 v[40:55], a[32:35], v[16:19], 0
    v_mfma_f32_32x32x16_bf16 v[40:55], a[36:39], v[20:23], v[40:55]
    s_nop 3
    v_max3_f32 v3, v24, v25, v3
    v_max3_f32 v4, v26, v27, v4
    v_max3_f32 v3, v28, v29, v3
    v_max3_f32 v4, v30, v31, v4
    v_max3_f32 v3, v32, v33, v3
    v_max3_f32 v4, v34, v35, v4
    v_max3_f32 v3, v36, v37, v3
    v_max3_f32 v4, v38, v39, v4
    s_cmp_eq_u32 s45, 4
    s_cbranch_scc1 L_k2_u1_p1end
    s_waitcnt vmcnt(6)
    v_mfma_f32_32x32x16_bf16 v[24:39], a[24:27], v[16:19], 0
    v_mfma_f32_32x32x16_bf16 v[24:39], a[28:31], v[20:23], v[24:39]
    s_nop 3
    v_max3_f32 v3, v40, v41, v3
    v_max3_f32 v4, v42, v43, v4
    v_max3_f32 v3, v44, v45, v3
    v_max3_f32 v4, v46, v47, v4
    v_max3_f32 v3, v48, v49, v3
    v_max3_f32 v4, v50, v51, v4
    v_max3_f32 v3, v52, v53, v3
    v_max3_f32 v4, v54, v55, v4
    s_cmp_eq_u32 s45, 3
    s_cbranch_scc1 L_k2_u1_p1end
    s_waitcnt vmcnt(4)
    v_mfma_f32_32x32x16_bf16 v[40:55], a[16:19], v[16:19], 0
    v_mfma_f32_32x32x16_bf16 v[40:55], a[20:23], v[20:23], v[40:55]
    s_nop 3
    v_max3_f32 v3, v24, v25, v3
    v_max3_f32 v4, v26, v27, v4
    v_max3_f32 v3, v28, v29, v3
    v_max3_f32 v4, v30, v31, v4
    v_max3_f32 v3, v32, v33, v3
    v_max3_f32 v4, v34, v35, v4
    v_max3_f32 v3, v36, v37, v3
    v_max3_f32 v4, v38, v39, v4
    s_cmp_eq_u32 s45, 2
    s_cbranch_scc1 L_k2_u1_p1end
    s_waitcnt vmcnt(2)
    v_mfma_f32_32x32x16_bf16 v[24:39], a[8:11], v[16:19], v[72:87]
    v_mfma_f32_32x32x16_bf16 v[24:39], a[12:15], v[20:23], v[24:39]
    s_nop 3
    v_max3_f32 v3, v40, v41, v3
    v_max3_f32 v4, v42, v43, v4
    v_max3_f32 v3, v44, v45, v3
    v_max3_f32 v4, v46, v47, v4
    v_max3_f32 v3, v48, v49, v3
    v_max3_f32 v4, v50, v51, v4
    v_max3_f32 v3, v52, v53, v3
    v_max3_f32 v4, v54, v55, v4
    s_cmp_eq_u32 s45, 1
    s_cbranch_scc1 L_k2_u1_p1end
    s_nop 3
    v_max3_f32 v3, v24, v25, v3
    v_max3_f32 v4, v26, v27, v4
    v_max3_f32 v3, v28, v29, v3
    v_max3_f32 v4, v30, v31, v4
    v_max3_f32 v3, v32, v33, v3
    v_max3_f32 v4, v34, v35, v4
    v_max3_f32 v3, v36, v37, v3
    v_max3_f32 v4, v38, v39, v4
L_k2_u1_p1end:
    buffer_load_dwordx4 v[8:11], v1, s[12:15], s75 offen offset:0 sc1
    buffer_load_dwordx4 v[12:15], v1, s[12:15], s75 offen offset:1024 sc1
    s_sub_u32 s33, s41, 0
    s_max_i32 s33, s33, 0
    s_mul_i32 s33, s33, 36864
    s_add_u32 s33, s33, s47
    s_add_u32 s34, s33, 18432
    s_mov_b64 exec, s[52:53]
    buffer_load_dwordx4 a[80:83], v2, s[12:15], s33 offen sc1
    buffer_load_dwordx4 a[84:87], v2, s[12:15], s34 offen sc1
    s_mov_b64 exec, -1
    s_sub_u32 s33, s41, 1
    s_max_i32 s33, s33, 0
    s_mul_i32 s33, s33, 36864
    s_add_u32 s33, s33, s47
    s_add_u32 s34, s33, 18432
    s_mov_b64 exec, s[52:53]
    buffer_load_dwordx4 a[88:91], v2, s[12:15], s33 offen sc1
    buffer_load_dwordx4 a[92:95], v2, s[12:15], s34 offen sc1
    s_mov_b64 exec, -1
    s_sub_u32 s33, s41, 2
    s_max_i32 s33, s33, 0
    s_mul_i32 s33, s33, 36864
    s_add_u32 s33, s33, s47
    s_add_u32 s34, s33, 18432
    s_mov_b64 exec, s[52:53]
    buffer_load_dwordx4 a[96:99], v2, s[12:15], s33 offen sc1
    buffer_load_dwordx4 a[100:103], v2, s[12:15], s34 offen sc1
    s_mov_b64 exec, -1
    s_sub_u32 s33, s41, 3
    s_max_i32 s33, s33, 0
    s_mul_i32 s33, s33, 36864
    s_add_u32 s33, s33, s47
    s_add_u32 s34, s33, 18432
    s_mov_b64 exec, s[52:53]
    buffer_load_dwordx4 a[104:107], v2, s[12:15], s33 offen sc1
    buffer_load_dwordx4 a[108:111], v2, s[12:15], s34 offen sc1
    s_mov_b64 exec, -1
    s_sub_u32 s33, s41, 4
    s_max_i32 s33, s33, 0
    s_mul_i32 s33, s33, 36864
    s_add_u32 s33, s33, s47
    s_add_u32 s34, s33, 18432
    s_mov_b64 exec, s[52:53]
    buffer_load_dwordx4 a[112:115], v2, s[12:15], s33 offen sc1
    buffer_load_dwordx4 a[116:119], v2, s[12:15], s34 offen sc1
    s_mov_b64 exec, -1
    s_sub_u32 s33, s41, 5
    s_max_i32 s33, s33, 0
    s_mul_i32 s33, s33, 36864
    s_add_u32 s33, s33, s47
    s_add_u32 s34, s33, 18432
    s_mov_b64 exec, s[52:53]
    buffer_load_dwordx4 a[120:123], v2, s[12:15], s33 offen sc1
    buffer_load_dwordx4 a[124:127], v2, s[12:15], s34 offen sc1
    s_mov_b64 exec, -1
    v_max_f32 v3, v3, v4
    v_mov_b32 v4, v3
    s_nop 1
    v_permlane32_swap_b32 v3, v4
    s_nop 1
    v_max_f32 v3, v3, v4
    s_nop 3
    v_sub_f32 v56, v56, v3
    v_sub_f32 v57, v57, v3
    v_sub_f32 v58, v58, v3
    v_sub_f32 v59, v59, v3
    v_sub_f32 v60, v60, v3
    v_sub_f32 v61, v61, v3
    v_sub_f32 v62, v62, v3
    v_sub_f32 v63, v63, v3
    v_sub_f32 v64, v64, v3
    v_sub_f32 v65, v65, v3
    v_sub_f32 v66, v66, v3
    v_sub_f32 v67, v67, v3
    v_sub_f32 v68, v68, v3
    v_sub_f32 v69, v69, v3
    v_sub_f32 v70, v70, v3
    v_sub_f32 v71, v71, v3
    v_sub_f32 v88, 0, v3
    v_sub_f32 v89, 0, v3
    v_sub_f32 v90, 0, v3
    v_sub_f32 v91, 0, v3
    v_sub_f32 v92, 0, v3
    v_sub_f32 v93, 0, v3
    v_sub_f32 v94, 0, v3
    v_sub_f32 v95, 0, v3
    v_sub_f32 v96, 0, v3
    v_sub_f32 v97, 0, v3
    v_sub_f32 v98, 0, v3
    v_sub_f32 v99, 0, v3
    v_sub_f32 v100, 0, v3
    v_sub_f32 v101, 0, v3
    v_sub_f32 v102, 0, v3
    v_sub_f32 v103, 0, v3
    v_sub_f32 v72, v72, v3
    v_sub_f32 v73, v73, v3
    v_sub_f32 v74, v74, v3
    v_sub_f32 v75, v75, v3
    v_sub_f32 v76, v76, v3
    v_sub_f32 v77, v77, v3
    v_sub_f32 v78, v78, v3
    v_sub_f32 v79, v79, v3
    v_sub_f32 v80, v80, v3
    v_sub_f32 v81, v81, v3
    v_sub_f32 v82, v82, v3
    v_sub_f32 v83, v83, v3
    v_sub_f32 v84, v84, v3
    v_sub_f32 v85, v85, v3
    v_sub_f32 v86, v86, v3
    v_sub_f32 v87, v87, v3
    v_mfma_f32_32x32x16_bf16 v[24:39], a[72:75], v[16:19], v[56:71]
    v_mfma_f32_32x32x16_bf16 v[24:39], a[76:79], v[20:23], v[24:39]
    v_mfma_f32_32x32x16_bf16 v[40:55], a[64:67], v[16:19], v[88:103]
    v_mfma_f32_32x32x16_bf16 v[40:55], a[68:71], v[20:23], v[40:55]
    s_nop 9
    v_exp_f32 v24, v24
    v_exp_f32 v25, v25
    v_exp_f32 v26, v26
    v_exp_f32 v27, v27
    v_exp_f32 v28, v28
    v_exp_f32 v29, v29
    v_exp_f32 v30, v30
    v_exp_f32 v31, v31
    s_nop 0
    v_cvt_pk_bf16_f32 v120, v24, v25
    v_cvt_pk_bf16_f32 v121, v26, v27
    v_cvt_pk_bf16_f32 v122, v28, v29
    v_cvt_pk_bf16_f32 v123, v30, v31
    s_waitcnt vmcnt(10)
    s_nop 1
    v_mfma_f32_32x32x16_bf16 v[104:119], a[80:83], v[120:123], 0
    v_exp_f32 v32, v32
    v_exp_f32 v33, v33
    v_exp_f32 v34, v34
    v_exp_f32 v35, v35
    v_exp_f32 v36, v36
    v_exp_f32 v37, v37
    v_exp_f32 v38, v38
    v_exp_f32 v39, v39
    s_nop 0
    v_cvt_pk_bf16_f32 v124, v32, v33
    v_cvt_pk_bf16_f32 v125, v34, v35
    v_cvt_pk_bf16_f32 v126, v36, v37
    v_cvt_pk_bf16_f32 v127, v38, v39
    s_nop 1
    v_mfma_f32_32x32x16_bf16 v[104:119], a[84:87], v[124:127], v[104:119]
    s_sub_u32 s33, s41, 6
    s_max_i32 s33, s33, 0
    s_mul_i32 s33, s33, 36864
    s_add_u32 s33, s33, s47
    s_add_u32 s34, s33, 18432
    s_mov_b64 exec, s[52:53]
    buffer_load_dwordx4 a[80:83], v2, s[12:15], s33 offen sc1
    buffer_load_dwordx4 a[84:87], v2, s[12:15], s34 offen sc1
    s_mov_b64 exec, -1
    s_cmp_eq_u32 s45, 8
    s_cbranch_scc1 L_k2_u1_p2end
    v_mfma_f32_32x32x16_bf16 v[24:39], a[56:59], v[16:19], v[88:103]
    v_mfma_f32_32x32x16_bf16 v[24:39], a[60:63], v[20:23], v[24:39]
    v_exp_f32 v40, v40
    v_exp_f32 v41, v41
    v_exp_f32 v42, v42
    v_exp_f32 v43, v43
    v_exp_f32 v44, v44
    v_exp_f32 v45, v45
    v_exp_f32 v46, v46
    v_exp_f32 v47, v47
    s_nop 0
    v_cvt_pk_bf16_f32 v120, v40, v41
    v_cvt_pk_bf16_f32 v121, v42, v43
    v_cvt_pk_bf16_f32 v122, v44, v45
    v_cvt_pk_bf16_f32 v123, v46, v47
    s_waitcnt vmcnt(10)
    s_nop 1
    v_mfma_f32_32x32x16_bf16 v[104:119], a[88:91], v[120:123], v[104:119]
    v_exp_f32 v48, v48
    v_exp_f32 v49, v49
    v_exp_f32 v50, v50
    v_exp_f32 v51, v51
    v_exp_f32 v52, v52
    v_exp_f32 v53, v53
    v_exp_f32 v54, v54
    v_exp_f32 v55, v55
    s_nop 0
    v_cvt_pk_bf16_f32 v124, v48, v49
    v_cvt_pk_bf16_f32 v125, v50, v51
    v_cvt_pk_bf16_f32 v126, v52, v53
    v_cvt_pk_bf16_f32 v127, v54, v55
    s_nop 1
    v_mfma_f32_32x32x16_bf16 v[104:119], a[92:95], v[124:127], v[104:119]
    s_sub_u32 s33, s41, 7
    s_max_i32 s33, s33, 0
    s_mul_i32 s33, s33, 36864
    s_add_u32 s33, s33, s47
    s_add_u32 s34, s33, 18432
    s_mov_b64 exec, s[52:53]
    buffer_load_dwordx4 a[88:91], v2, s[12:15], s33 offen sc1
    buffer_load_dwordx4 a[92:95], v2, s[12:15], s34 offen sc1
    s_mov_b64 exec, -1
    s_cmp_eq_u32 s45, 7
    s_cbranch_scc1 L_k2_u1_p2end
    v_mfma_f32_32x32x16_bf16 v[40:55], a[48:51], v[16:19], v[88:103]
    v_mfma_f32_32x32x16_bf16 v[40:55], a[52:55], v[20:23], v[40:55]
    v_exp_f32 v24, v24
    v_exp_f32 v25, v25
    v_exp_f32 v26, v26
    v_exp_f32 v27, v27
    v_exp_f32 v28, v28
    v_exp_f32 v29, v29
    v_exp_f32 v30, v30
    v_exp_f32 v31, v31
    s_nop 0
    v_cvt_pk_bf16_f32 v120, v24, v25
    v_cvt_pk_bf16_f32 v121, v26, v27
    v_cvt_pk_bf16_f32 v122, v28, v29
    v_cvt_pk_bf16_f32 v123, v30, v31
    s_waitcnt vmcnt(10)
    s_nop 1
    v_mfma_f32_32x32x16_bf16 v[104:119], a[96:99], v[120:123], v[104:119]
    v_exp_f32 v32, v32
    v_exp_f32 v33, v33
    v_exp_f32 v34, v34
    v_exp_f32 v35, v35
    v_exp_f32 v36, v36
    v_exp_f32 v37, v37
    v_exp_f32 v38, v38
    v_exp_f32 v39, v39
    s_nop 0
    v_cvt_pk_bf16_f32 v124, v32, v33
    v_cvt_pk_bf16_f32 v125, v34, v35
    v_cvt_pk_bf16_f32 v126, v36, v37
    v_cvt_pk_bf16_f32 v127, v38, v39
    s_nop 1
    v_mfma_f32_32x32x16_bf16 v[104:119], a[100:103], v[124:127], v[104:119]
    s_sub_u32 s33, s41, 8
    s_max_i32 s33, s33, 0
    s_mul_i32 s33, s33, 36864
    s_add_u32 s33, s33, s47
    s_add_u32 s34, s33, 18432
    s_mov_b64 exec, s[52:53]
    buffer_load_dwordx4 a[96:99], v2, s[12:15], s33 offen sc1
    buffer_load_dwordx4 a[100:103], v2, s[12:15], s34 offen sc1
    s_mov_b64 exec, -1
    s_cmp_eq_u32 s45, 6
    s_cbranch_scc1 L_k2_u1_p2end
    v_mfma_f32_32x32x16_bf16 v[24:39], a[40:43], v[16:19], v[88:103]
    v_mfma_f32_32x32x16_bf16 v[24:39], a[44:47], v[20:23], v[24:39]
    v_exp_f32 v40, v40
    v_exp_f32 v41, v41
    v_exp_f32 v42, v42
    v_exp_f32 v43, v43
    v_exp_f32 v44, v44
    v_exp_f32 v45, v45
    v_exp_f32 v46, v46
    v_exp_f32 v47, v47
    s_nop 0
    v_cvt_pk_bf16_f32 v120, v40, v41
    v_cvt_pk_bf16_f32 v121, v42, v43
    v_cvt_pk_bf16_f32 v122, v44, v45
    v_cvt_pk_bf16_f32 v123, v46, v47
    s_waitcnt vmcnt(10)
    s_nop 1
    v_mfma_f32_32x32x16_bf16 v[104:119], a[104:107], v[120:123], v[104:119]
    v_exp_f32 v48, v48
    v_exp_f32 v49, v49
    v_exp_f32 v50, v50
    v_exp_f32 v51, v51
    v_exp_f32 v52, v52
    v_exp_f32 v53, v53
    v_exp_f32 v54, v54
    v_exp_f32 v55, v55
    s_nop 0
    v_cvt_pk_bf16_f32 v124, v48, v49
    v_cvt_pk_bf16_f32 v125, v50, v51
    v_cvt_pk_bf16_f32 v126, v52, v53
    v_cvt_pk_bf16_f32 v127, v54, v55
    s_nop 1
    v_mfma_f32_32x32x16_bf16 v[104:119], a[108:111], v[124:127], v[104:119]
    s_cmp_eq_u32 s45, 5
    s_cbranch_scc1 L_k2_u1_p2end
    v_mfma_f32_32x32x16_bf16 v[40:55], a[32:35], v[16:19], v[88:103]
    v_mfma_f32_32x32x16_bf16 v[40:55], a[36:39], v[20:23], v[40:55]
    v_exp_f32 v24, v24
    v_exp_f32 v25, v25
    v_exp_f32 v26, v26
    v_exp_f32 v27, v27
    v_exp_f32 v28, v28
    v_exp_f32 v29, v29
    v_exp_f32 v30, v30
    v_exp_f32 v31, v31
    s_nop 0
    v_cvt_pk_bf16_f32 v120, v24, v25
    v_cvt_pk_bf16_f32 v121, v26, v27
    v_cvt_pk_bf16_f32 v122, v28, v29
    v_cvt_pk_bf16_f32 v123, v30, v31
    s_waitcnt vmcnt(8)
    s_nop 1
    v_mfma_f32_32x32x16_bf16 v[104:119], a[112:115], v[120:123], v[104:119]
    v_exp_f32 v32, v32
    v_exp_f32 v33, v33
    v_exp_f32 v34, v34
    v_exp_f32 v35, v35
    v_exp_f32 v36, v36
    v_exp_f32 v37, v37
    v_exp_f32 v38, v38
    v_exp_f32 v39, v39
    s_nop 0
    v_cvt_pk_bf16_f32 v124, v32, v33
    v_cvt_pk_bf16_f32 v125, v34, v35
    v_cvt_pk_bf16_f32 v126, v36, v37
    v_cvt_pk_bf16_f32 v127, v38, v39
    s_nop 1
    v_mfma_f32_32x32x16_bf16 v[104:119], a[116:119], v[124:127], v[104:119]
    s_cmp_eq_u32 s45, 4
    s_cbranch_scc1 L_k2_u1_p2end
    v_mfma_f32_32x32x16_bf16 v[24:39], a[24:27], v[16:19], v[88:103]
    v_mfma_f32_32x32x16_bf16 v[24:39], a[28:31], v[20:23], v[24:39]
    v_exp_f32 v40, v40
    v_exp_f32 v41, v41
    v_exp_f32 v42, v42
    v_exp_f32 v43, v43
    v_exp_f32 v44, v44
    v_exp_f32 v45, v45
    v_exp_f32 v46, v46
    v_exp_f32 v47, v47
    s_nop 0
    v_cvt_pk_bf16_f32 v120, v40, v41
    v_cvt_pk_bf16_f32 v121, v42, v43
    v_cvt_pk_bf16_f32 v122, v44, v45
    v_cvt_pk_bf16_f32 v123, v46, v47
    s_waitcnt vmcnt(6)
    s_nop 1
    v_mfma_f32_32x32x16_bf16 v[104:119], a[120:123], v[120:123], v[104:119]
    v_exp_f32 v48, v48
    v_exp_f32 v49, v49
    v_exp_f32 v50, v50
    v_exp_f32 v51, v51
    v_exp_f32 v52, v52
    v_exp_f32 v53, v53
    v_exp_f32 v54, v54
    v_exp_f32 v55, v55
    s_nop 0
    v_cvt_pk_bf16_f32 v124, v48, v49
    v_cvt_pk_bf16_f32 v125, v50, v51
    v_cvt_pk_bf16_f32 v126, v52, v53
    v_cvt_pk_bf16_f32 v127, v54, v55
    s_nop 1
    v_mfma_f32_32x32x16_bf16 v[104:119], a[124:127], v[124:127], v[104:119]
    s_cmp_eq_u32 s45, 3
    s_cbranch_scc1 L_k2_u1_p2end
    v_mfma_f32_32x32x16_bf16 v[40:55], a[16:19], v[16:19], v[88:103]
    v_mfma_f32_32x32x16_bf16 v[40:55], a[20:23], v[20:23], v[40:55]
    v_exp_f32 v24, v24
    v_exp_f32 v25, v25
    v_exp_f32 v26, v26
    v_exp_f32 v27, v27
    v_exp_f32 v28, v28
    v_exp_f32 v29, v29
    v_exp_f32 v30, v30
    v_exp_f32 v31, v31
    s_nop 0
    v_cvt_pk_bf16_f32 v120, v24, v25
    v_cvt_pk_bf16_f32 v121, v26, v27
    v_cvt_pk_bf16_f32 v122, v28, v29
    v_cvt_pk_bf16_f32 v123, v30, v31
    s_waitcnt vmcnt(4)
    s_nop 1
    v_mfma_f32_32x32x16_bf16 v[104:119], a[80:83], v[120:123], v[104:119]
    v_exp_f32 v32, v32
    v_exp_f32 v33, v33
    v_exp_f32 v34, v34
    v_exp_f32 v35, v35
    v_exp_f32 v36, v36
    v_exp_f32 v37, v37
    v_exp_f32 v38, v38
    v_exp_f32 v39, v39
    s_nop 0
    v_cvt_pk_bf16_f32 v124, v32, v33
    v_cvt_pk_bf16_f32 v125, v34, v35
    v_cvt_pk_bf16_f32 v126, v36, v37
    v_cvt_pk_bf16_f32 v127, v38, v39
    s_nop 1
    v_mfma_f32_32x32x16_bf16 v[104:119], a[84:87], v[124:127], v[104:119]
    s_cmp_eq_u32 s45, 2
    s_cbranch_scc1 L_k2_u1_p2end
    v_mfma_f32_32x32x16_bf16 v[24:39], a[8:11], v[16:19], v[72:87]
    v_mfma_f32_32x32x16_bf16 v[24:39], a[12:15], v[20:23], v[24:39]
    v_exp_f32 v40, v40
    v_exp_f32 v41, v41
    v_exp_f32 v42, v42
    v_exp_f32 v43, v43
    v_exp_f32 v44, v44
    v_exp_f32 v45, v45
    v_exp_f32 v46, v46
    v_exp_f32 v47, v47
    s_nop 0
    v_cvt_pk_bf16_f32 v120, v40, v41
    v_cvt_pk_bf16_f32 v121, v42, v43
    v_cvt_pk_bf16_f32 v122, v44, v45
    v_cvt_pk_bf16_f32 v123, v46, v47
    s_waitcnt vmcnt(2)
    s_nop 1
    v_mfma_f32_32x32x16_bf16 v[104:119], a[88:91], v[120:123], v[104:119]
    v_exp_f32 v48, v48
    v_exp_f32 v49, v49
    v_exp_f32 v50, v50
    v_exp_f32 v51, v51
    v_exp_f32 v52, v52
    v_exp_f32 v53, v53
    v_exp_f32 v54, v54
    v_exp_f32 v55, v55
    s_nop 0
    v_cvt_pk_bf16_f32 v124, v48, v49
    v_cvt_pk_bf16_f32 v125, v50, v51
    v_cvt_pk_bf16_f32 v126, v52, v53
    v_cvt_pk_bf16_f32 v127, v54, v55
    s_nop 1
    v_mfma_f32_32x32x16_bf16 v[104:119], a[92:95], v[124:127], v[104:119]
    s_cmp_eq_u32 s45, 1
    s_cbranch_scc1 L_k2_u1_p2end
    v_exp_f32 v24, v24
    v_exp_f32 v25, v25
    v_exp_f32 v26, v26
    v_exp_f32 v27, v27
    v_exp_f32 v28, v28
    v_exp_f32 v29, v29
    v_exp_f32 v30, v30
    v_exp_f32 v31, v31
    s_nop 0
    v_cvt_pk_bf16_f32 v120, v24, v25
    v_cvt_pk_bf16_f32 v121, v26, v27
    v_cvt_pk_bf16_f32 v122, v28, v29
    v_cvt_pk_bf16_f32 v123, v30, v31
    s_waitcnt vmcnt(0)
    s_nop 1
    v_mfma_f32_32x32x16_bf16 v[104:119], a[96:99], v[120:123], v[104:119]
    v_exp_f32 v32, v32
    v_exp_f32 v33, v33
    v_exp_f32 v34, v34
    v_exp_f32 v35, v35
    v_exp_f32 v36, v36
    v_exp_f32 v37, v37
    v_exp_f32 v38, v38
    v_exp_f32 v39, v39
    s_nop 0
    v_cvt_pk_bf16_f32 v124, v32, v33
    v_cvt_pk_bf16_f32 v125, v34, v35
    v_cvt_pk_bf16_f32 v126, v36, v37
    v_cvt_pk_bf16_f32 v127, v38, v39
    s_nop 1
    v_mfma_f32_32x32x16_bf16 v[104:119], a[100:103], v[124:127], v[104:119]
L_k2_u1_p2end:
    v_add_f32 v56, v56, v3
    v_add_f32 v57, v57, v3
    v_add_f32 v58, v58, v3
    v_add_f32 v59, v59, v3
    v_add_f32 v60, v60, v3
    v_add_f32 v61, v61, v3
    v_add_f32 v62, v62, v3
    v_add_f32 v63, v63, v3
    v_add_f32 v64, v64, v3
    v_add_f32 v65, v65, v3
    v_add_f32 v66, v66, v3
    v_add_f32 v67, v67, v3
    v_add_f32 v68, v68, v3
    v_add_f32 v69, v69, v3
    v_add_f32 v70, v70, v3
    v_add_f32 v71, v71, v3
    v_add_f32 v72, v72, v3
    v_add_f32 v73, v73, v3
    v_add_f32 v74, v74, v3
    v_add_f32 v75, v75, v3
    v_add_f32 v76, v76, v3
    v_add_f32 v77, v77, v3
    v_add_f32 v78, v78, v3
    v_add_f32 v79, v79, v3
    v_add_f32 v80, v80, v3
    v_add_f32 v81, v81, v3
    v_add_f32 v82, v82, v3
    v_add_f32 v83, v83, v3
    v_add_f32 v84, v84, v3
    v_add_f32 v85, v85, v3
    v_add_f32 v86, v86, v3
    v_add_f32 v87, v87, v3
    s_mul_i32 s32, s41, 40960
    s_add_u32 s33, s32, s59
    s_add_u32 s34, s32, s60
    v_rcp_f32 v4, v116
    s_nop 0
    v_mul_f32 v104, v104, v4
    v_mul_f32 v105, v105, v4
    v_mul_f32 v106, v106, v4
    v_mul_f32 v107, v107, v4
    v_mul_f32 v108, v108, v4
    v_mul_f32 v109, v109, v4
    v_mul_f32 v110, v110, v4
    v_mul_f32 v111, v111, v4
    v_mul_f32 v112, v112, v4
    v_mul_f32 v113, v113, v4
    v_cvt_pk_bf16_f32 v88, v104, v105
    v_cvt_pk_bf16_f32 v89, v106, v107
    v_cvt_pk_bf16_f32 v90, v108, v109
    v_cvt_pk_bf16_f32 v91, v110, v111
    v_cvt_pk_bf16_f32 v92, v112, v113
    buffer_store_dwordx4 v[88:91], v5, s[12:15], s33 offen sc1
    buffer_store_dword v92, v6, s[12:15], s34 offen sc1
    s_sub_u32 s41, s41, 1
    s_waitcnt vmcnt(20)
    v_add_u32 v4, 0, v7
    v_cmp_gt_u32 s[48:49], 18, v4
    v_add_u32 v4, 2, v7
    v_cmp_gt_u32 s[50:51], 18, v4
    s_nop 0
    v_cndmask_b32 v8, 0, v8, s[48:49]
    v_cndmask_b32 v9, 0, v9, s[50:51]
    v_add_u32 v4, 8, v7
    v_cmp_gt_u32 s[48:49], 18, v4
    v_add_u32 v4, 10, v7
    v_cmp_gt_u32 s[50:51], 18, v4
    s_nop 0
    v_cndmask_b32 v10, 0, v10, s[48:49]
    v_cndmask_b32 v11, 0, v11, s[50:51]
    v_add_u32 v4, 16, v7
    v_cmp_gt_u32 s[48:49], 18, v4
    v_add_u32 v4, 18, v7
    v_cmp_gt_u32 s[50:51], 18, v4
    s_nop 0
    v_cndmask_b32 v12, 0, v12, s[48:49]
    v_cndmask_b32 v13, 0, v13, s[50:51]
    v_add_u32 v4, 24, v7
    v_cmp_gt_u32 s[48:49], 18, v4
    v_add_u32 v4, 26, v7
    v_cmp_gt_u32 s[50:51], 18, v4
    s_nop 0
    v_cndmask_b32 v14, 0, v14, s[48:49]
    v_cndmask_b32 v15, 0, v15, s[50:51]
    s_sub_u32 s45, 8, s41
    s_max_i32 s45, s45, 0
    v_mov_b32 v3, 0xf149f2ca
    v_mov_b32 v4, 0xf149f2ca
    s_waitcnt vmcnt(38)
    v_mfma_f32_32x32x16_bf16 v[24:39], a[64:67], v[8:11], v[56:71]
    v_mfma_f32_32x32x16_bf16 v[24:39], a[68:71], v[12:15], v[24:39]
    s_waitcnt vmcnt(36)
    v_mfma_f32_32x32x16_bf16 v[40:55], a[56:59], v[8:11], 0
    v_mfma_f32_32x32x16_bf16 v[40:55], a[60:63], v[12:15], v[40:55]
    s_nop 9
    v_max3_f32 v3, v24, v25, v3
    v_max3_f32 v4, v26, v27, v4
    v_max3_f32 v3, v28, v29, v3
    v_max3_f32 v4, v30, v31, v4
    v_max3_f32 v3, v32, v33, v3
    v_max3_f32 v4, v34, v35, v4
    v_max3_f32 v3, v36, v37, v3
    v_max3_f32 v4, v38, v39, v4
    s_cmp_eq_u32 s45, 8
    s_cbranch_scc1 L_k2_u0_p1end
    s_waitcnt vmcnt(34)
    v_mfma_f32_32x32x16_bf16 v[24:39], a[48:51], v[8:11], 0
    v_mfma_f32_32x32x16_bf16 v[24:39], a[52:55], v[12:15], v[24:39]
    s_nop 3
    v_max3_f32 v3, v40, v41, v3
    v_max3_f32 v4, v42, v43, v4
    v_max3_f32 v3, v44, v45, v3
    v_max3_f32 v4, v46, v47, v4
    v_max3_f32 v3, v48, v49, v3
    v_max3_f32 v4, v50, v51, v4
    v_max3_f32 v3, v52, v53, v3
    v_max3_f32 v4, v54, v55, v4
    s_cmp_eq_u32 s45, 7
    s_cbranch_scc1 L_k2_u0_p1end
    s_waitcnt vmcnt(32)
    v_mfma_f32_32x32x16_bf16 v[40:55], a[40:43], v[8:11], 0
    v_mfma_f32_32x32x16_bf16 v[40:55], a[44:47], v[12:15], v[40:55]
    s_nop 3
    v_max3_f32 v3, v24, v25, v3
    v_max3_f32 v4, v26, v27, v4
    v_max3_f32 v3, v28, v29, v3
    v_max3_f32 v4, v30, v31, v4
    v_max3_f32 v3, v32, v33, v3
    v_max3_f32 v4, v34, v35, v4
    v_max3_f32 v3, v36, v37, v3
    v_max3_f32 v4, v38, v39, v4
    s_cmp_eq_u32 s45, 6
    s_cbranch_scc1 L_k2_u0_p1end
    s_waitcnt vmcnt(30)
    v_mfma_f32_32x32x16_bf16 v[24:39], a[32:35], v[8:11], 0
    v_mfma_f32_32x32x16_bf16 v[24:39], a[36:39], v[12:15], v[24:39]
    s_nop 3
    v_max3_f32 v3, v40, v41, v3
    v_max3_f32 v4, v42, v43, v4
    v_max3_f32 v3, v44, v45, v3
    v_max3_f32 v4, v46, v47, v4
    v_max3_f32 v3, v48, v49, v3
    v_max3_f32 v4, v50, v51, v4
    v_max3_f32 v3, v52, v53, v3
    v_max3_f32 v4, v54, v55, v4
    s_cmp_eq_u32 s45, 5
    s_cbranch_scc1 L_k2_u0_p1end
    s_waitcnt vmcnt(28)
    v_mfma_f32_32x32x16_bf16 v[40:55], a[24:27], v[8:11], 0
    v_mfma_f32_32x32x16_bf16 v[40:55], a[28:31], v[12:15], v[40:55]
    s_nop 3
    v_max3_f32 v3, v24, v25, v3
    v_max3_f32 v4, v26, v27, v4
    v_max3_f32 v3, v28, v29, v3
    v_max3_f32 v4, v30, v31, v4
    v_max3_f32 v3, v32, v33, v3
    v_max3_f32 v4, v34, v35, v4
    v_max3_f32 v3, v36, v37, v3
    v_max3_f32 v4, v38, v39, v4
    s_cmp_eq_u32 s45, 4
    s_cbranch_scc1 L_k2_u0_p1end
    s_waitcnt vmcnt(26)
    v_mfma_f32_32x32x16_bf16 v[24:39], a[16:19], v[8:11], 0
    v_mfma_f32_32x32x16_bf16 v[24:39], a[20:23], v[12:15], v[24:39]
    s_nop 3
    v_max3_f32 v3, v40, v41, v3
    v_max3_f32 v4, v42, v43, v4
    v_max3_f32 v3, v44, v45, v3
    v_max3_f32 v4, v46, v47, v4
    v_max3_f32 v3, v48, v49, v3
    v_max3_f32 v4, v50, v51, v4
    v_max3_f32 v3, v52, v53, v3
    v_max3_f32 v4, v54, v55, v4
    s_cmp_eq_u32 s45, 3
    s_cbranch_scc1 L_k2_u0_p1end
    s_waitcnt vmcnt(24)
    v_mfma_f32_32x32x16_bf16 v[40:55], a[8:11], v[8:11], 0
    v_mfma_f32_32x32x16_bf16 v[40:55], a[12:15], v[12:15], v[40:55]
    s_nop 3
    v_max3_f32 v3, v24, v25, v3
    v_max3_f32 v4, v26, v27, v4
    v_max3_f32 v3, v28, v29, v3
    v_max3_f32 v4, v30, v31, v4
    v_max3_f32 v3, v32, v33, v3
    v_max3_f32 v4, v34, v35, v4
    v_max3_f32 v3, v36, v37, v3
    v_max3_f32 v4, v38, v39, v4
    s_cmp_eq_u32 s45, 2
    s_cbranch_scc1 L_k2_u0_p1end
    s_waitcnt vmcnt(22)
    v_mfma_f32_32x32x16_bf16 v[24:39], a[0:3], v[8:11], v[72:87]
    v_mfma_f32_32x32x16_bf16 v[24:39], a[4:7], v[12:15], v[24:39]
    s_nop 3
    v_max3_f32 v3, v40, v41, v3
    v_max3_f32 v4, v42, v43, v4
    v_max3_f32 v3, v44, v45, v3
    v_max3_f32 v4, v46, v47, v4
    v_max3_f32 v3, v48, v49, v3
    v_max3_f32 v4, v50, v51, v4
    v_max3_f32 v3, v52, v53, v3
    v_max3_f32 v4, v54, v55, v4
    s_cmp_eq_u32 s45, 1
    s_cbranch_scc1 L_k2_u0_p1end
    s_nop 3
    v_max3_f32 v3, v24, v25, v3
    v_max3_f32 v4, v26, v27, v4
    v_max3_f32 v3, v28, v29, v3
    v_max3_f32 v4, v30, v31, v4
    v_max3_f32 v3, v32, v33, v3
    v_max3_f32 v4, v34, v35, v4
    v_max3_f32 v3, v36, v37, v3
    v_max3_f32 v4, v38, v39, v4
L_k2_u0_p1end:
    s_sub_u32 s33, s41, 0
    s_max_i32 s33, s33, 0
    s_mul_i32 s33, s33, 36864
    s_add_u32 s33, s33, s47
    s_add_u32 s34, s33, 18432
    s_mov_b64 exec, s[52:53]
    buffer_load_dwordx4 a[80:83], v2, s[12:15], s33 offen sc1
    buffer_load_dwordx4 a[84:87], v2, s[12:15], s34 offen sc1
    s_mov_b64 exec, -1
    s_sub_u32 s33, s41, 1
    s_max_i32 s33, s33, 0
    s_mul_i32 s33, s33, 36864
    s_add_u32 s33, s33, s47
    s_add_u32 s34, s33, 18432
    s_mov_b64 exec, s[52:53]
    buffer_load_dwordx4 a[88:91], v2, s[12:15], s33 offen sc1
    buffer_load_dwordx4 a[92:95], v2, s[12:15], s34 offen sc1
    s_mov_b64 exec, -1
    s_sub_u32 s33, s41, 2
    s_max_i32 s33, s33, 0
    s_mul_i32 s33, s33, 36864
    s_add_u32 s33, s33, s47
    s_add_u32 s34, s33, 18432
    s_mov_b64 exec, s[52:53]
    buffer_load_dwordx4 a[96:99], v2, s[12:15], s33 offen sc1
    buffer_load_dwordx4 a[100:103], v2, s[12:15], s34 offen sc1
    s_mov_b64 exec, -1
    s_sub_u32 s33, s41, 3
    s_max_i32 s33, s33, 0
    s_mul_i32 s33, s33, 36864
    s_add_u32 s33, s33, s47
    s_add_u32 s34, s33, 18432
    s_mov_b64 exec, s[52:53]
    buffer_load_dwordx4 a[104:107], v2, s[12:15], s33 offen sc1
    buffer_load_dwordx4 a[108:111], v2, s[12:15], s34 offen sc1
    s_mov_b64 exec, -1
    s_sub_u32 s33, s41, 4
    s_max_i32 s33, s33, 0
    s_mul_i32 s33, s33, 36864
    s_add_u32 s33, s33, s47
    s_add_u32 s34, s33, 18432
    s_mov_b64 exec, s[52:53]
    buffer_load_dwordx4 a[112:115], v2, s[12:15], s33 offen sc1
    buffer_load_dwordx4 a[116:119], v2, s[12:15], s34 offen sc1
    s_mov_b64 exec, -1
    s_sub_u32 s33, s41, 5
    s_max_i32 s33, s33, 0
    s_mul_i32 s33, s33, 36864
    s_add_u32 s33, s33, s47
    s_add_u32 s34, s33, 18432
    s_mov_b64 exec, s[52:53]
    buffer_load_dwordx4 a[120:123], v2, s[12:15], s33 offen sc1
    buffer_load_dwordx4 a[124:127], v2, s[12:15], s34 offen sc1
    s_mov_b64 exec, -1
    v_max_f32 v3, v3, v4
    v_mov_b32 v4, v3
    s_nop 1
    v_permlane32_swap_b32 v3, v4
    s_nop 1
    v_max_f32 v3, v3, v4
    s_nop 3
    v_sub_f32 v56, v56, v3
    v_sub_f32 v57, v57, v3
    v_sub_f32 v58, v58, v3
    v_sub_f32 v59, v59, v3
    v_sub_f32 v60, v60, v3
    v_sub_f32 v61, v61, v3
    v_sub_f32 v62, v62, v3
    v_sub_f32 v63, v63, v3
    v_sub_f32 v64, v64, v3
    v_sub_f32 v65, v65, v3
    v_sub_f32 v66, v66, v3
    v_sub_f32 v67, v67, v3
    v_sub_f32 v68, v68, v3
    v_sub_f32 v69, v69, v3
    v_sub_f32 v70, v70, v3
    v_sub_f32 v71, v71, v3
    v_sub_f32 v88, 0, v3
    v_sub_f32 v89, 0, v3
    v_sub_f32 v90, 0, v3
    v_sub_f32 v91, 0, v3
    v_sub_f32 v92, 0, v3
    v_sub_f32 v93, 0, v3
    v_sub_f32 v94, 0, v3
    v_sub_f32 v95, 0, v3
    v_sub_f32 v96, 0, v3
    v_sub_f32 v97, 0, v3
    v_sub_f32 v98, 0, v3
    v_sub_f32 v99, 0, v3
    v_sub_f32 v100, 0, v3
    v_sub_f32 v101, 0, v3
    v_sub_f32 v102, 0, v3
    v_sub_f32 v103, 0, v3
    v_sub_f32 v72, v72, v3
    v_sub_f32 v73, v73, v3
    v_sub_f32 v74, v74, v3
    v_sub_f32 v75, v75, v3
    v_sub_f32 v76, v76, v3
    v_sub_f32 v77, v77, v3
    v_sub_f32 v78, v78, v3
    v_sub_f32 v79, v79, v3
    v_sub_f32 v80, v80, v3
    v_sub_f32 v81, v81, v3
    v_sub_f32 v82, v82, v3
    v_sub_f32 v83, v83, v3
    v_sub_f32 v84, v84, v3
    v_sub_f32 v85, v85, v3
    v_sub_f32 v86, v86, v3
    v_sub_f32 v87, v87, v3
    v_mfma_f32_32x32x16_bf16 v[24:39], a[64:67], v[8:11], v[56:71]
    v_mfma_f32_32x32x16_bf16 v[24:39], a[68:71], v[12:15], v[24:39]
    v_mfma_f32_32x32x16_bf16 v[40:55], a[56:59], v[8:11], v[88:103]
    v_mfma_f32_32x32x16_bf16 v[40:55], a[60:63], v[12:15], v[40:55]
    s_nop 9
    v_exp_f32 v24, v24
    v_exp_f32 v25, v25
    v_exp_f32 v26, v26
    v_exp_f32 v27, v27
    v_exp_f32 v28, v28
    v_exp_f32 v29, v29
    v_exp_f32 v30, v30
    v_exp_f32 v31, v31
    s_nop 0
    v_cvt_pk_bf16_f32 v120, v24, v25
    v_cvt_pk_bf16_f32 v121, v26, v27
    v_cvt_pk_bf16_f32 v122, v28, v29
    v_cvt_pk_bf16_f32 v123, v30, v31
    s_waitcnt vmcnt(10)
    s_nop 1
    v_mfma_f32_32x32x16_bf16 v[104:119], a[80:83], v[120:123], 0
    v_exp_f32 v32, v32
    v_exp_f32 v33, v33
    v_exp_f32 v34, v34
    v_exp_f32 v35, v35
    v_exp_f32 v36, v36
    v_exp_f32 v37, v37
    v_exp_f32 v38, v38
    v_exp_f32 v39, v39
    s_nop 0
    v_cvt_pk_bf16_f32 v124, v32, v33
    v_cvt_pk_bf16_f32 v125, v34, v35
    v_cvt_pk_bf16_f32 v126, v36, v37
    v_cvt_pk_bf16_f32 v127, v38, v39
    s_nop 1
    v_mfma_f32_32x32x16_bf16 v[104:119], a[84:87], v[124:127], v[104:119]
    s_sub_u32 s33, s41, 6
    s_max_i32 s33, s33, 0
    s_mul_i32 s33, s33, 36864
    s_add_u32 s33, s33, s47
    s_add_u32 s34, s33, 18432
    s_mov_b64 exec, s[52:53]
    buffer_load_dwordx4 a[80:83], v2, s[12:15], s33 offen sc1
    buffer_load_dwordx4 a[84:87], v2, s[12:15], s34 offen sc1
    s_mov_b64 exec, -1
    s_cmp_eq_u32 s45, 8
    s_cbranch_scc1 L_k2_u0_p2end
    v_mfma_f32_32x32x16_bf16 v[24:39], a[48:51], v[8:11], v[88:103]
    v_mfma_f32_32x32x16_bf16 v[24:39], a[52:55], v[12:15], v[24:39]
    v_exp_f32 v40, v40
    v_exp_f32 v41, v41
    v_exp_f32 v42, v42
    v_exp_f32 v43, v43
    v_exp_f32 v44, v44
    v_exp_f32 v45, v45
    v_exp_f32 v46, v46
    v_exp_f32 v47, v47
    s_nop 0
    v_cvt_pk_bf16_f32 v120, v40, v41
    v_cvt_pk_bf16_f32 v121, v42, v43
    v_cvt_pk_bf16_f32 v122, v44, v45
    v_cvt_pk_bf16_f32 v123, v46, v47
    s_waitcnt vmcnt(10)
    s_nop 1
    v_mfma_f32_32x32x16_bf16 v[104:119], a[88:91], v[120:123], v[104:119]
    v_exp_f32 v48, v48
    v_exp_f32 v49, v49
    v_exp_f32 v50, v50
    v_exp_f32 v51, v51
    v_exp_f32 v52, v52
    v_exp_f32 v53, v53
    v_exp_f32 v54, v54
    v_exp_f32 v55, v55
    s_nop 0
    v_cvt_pk_bf16_f32 v124, v48, v49
    v_cvt_pk_bf16_f32 v125, v50, v51
    v_cvt_pk_bf16_f32 v126, v52, v53
    v_cvt_pk_bf16_f32 v127, v54, v55
    s_nop 1
    v_mfma_f32_32x32x16_bf16 v[104:119], a[92:95], v[124:127], v[104:119]
    s_sub_u32 s33, s41, 7
    s_max_i32 s33, s33, 0
    s_mul_i32 s33, s33, 36864
    s_add_u32 s33, s33, s47
    s_add_u32 s34, s33, 18432
    s_mov_b64 exec, s[52:53]
    buffer_load_dwordx4 a[88:91], v2, s[12:15], s33 offen sc1
    buffer_load_dwordx4 a[92:95], v2, s[12:15], s34 offen sc1
    s_mov_b64 exec, -1
    s_cmp_eq_u32 s45, 7
    s_cbranch_scc1 L_k2_u0_p2end
    v_mfma_f32_32x32x16_bf16 v[40:55], a[40:43], v[8:11], v[88:103]
    v_mfma_f32_32x32x16_bf16 v[40:55], a[44:47], v[12:15], v[40:55]
    v_exp_f32 v24, v24
    v_exp_f32 v25, v25
    v_exp_f32 v26, v26
    v_exp_f32 v27, v27
    v_exp_f32 v28, v28
    v_exp_f32 v29, v29
    v_exp_f32 v30, v30
    v_exp_f32 v31, v31
    s_nop 0
    v_cvt_pk_bf16_f32 v120, v24, v25
    v_cvt_pk_bf16_f32 v121, v26, v27
    v_cvt_pk_bf16_f32 v122, v28, v29
    v_cvt_pk_bf16_f32 v123, v30, v31
    s_waitcnt vmcnt(10)
    s_nop 1
    v_mfma_f32_32x32x16_bf16 v[104:119], a[96:99], v[120:123], v[104:119]
    v_exp_f32 v32, v32
    v_exp_f32 v33, v33
    v_exp_f32 v34, v34
    v_exp_f32 v35, v35
    v_exp_f32 v36, v36
    v_exp_f32 v37, v37
    v_exp_f32 v38, v38
    v_exp_f32 v39, v39
    s_nop 0
    v_cvt_pk_bf16_f32 v124, v32, v33
    v_cvt_pk_bf16_f32 v125, v34, v35
    v_cvt_pk_bf16_f32 v126, v36, v37
    v_cvt_pk_bf16_f32 v127, v38, v39
    s_nop 1
    v_mfma_f32_32x32x16_bf16 v[104:119], a[100:103], v[124:127], v[104:119]
    s_sub_u32 s33, s41, 8
    s_max_i32 s33, s33, 0
    s_mul_i32 s33, s33, 36864
    s_add_u32 s33, s33, s47
    s_add_u32 s34, s33, 18432
    s_mov_b64 exec, s[52:53]
    buffer_load_dwordx4 a[96:99], v2, s[12:15], s33 offen sc1
    buffer_load_dwordx4 a[100:103], v2, s[12:15], s34 offen sc1
    s_mov_b64 exec, -1
    s_cmp_eq_u32 s45, 6
    s_cbranch_scc1 L_k2_u0_p2end
    v_mfma_f32_32x32x16_bf16 v[24:39], a[32:35], v[8:11], v[88:103]
    v_mfma_f32_32x32x16_bf16 v[24:39], a[36:39], v[12:15], v[24:39]
    v_exp_f32 v40, v40
    v_exp_f32 v41, v41
    v_exp_f32 v42, v42
    v_exp_f32 v43, v43
    v_exp_f32 v44, v44
    v_exp_f32 v45, v45
    v_exp_f32 v46, v46
    v_exp_f32 v47, v47
    s_nop 0
    v_cvt_pk_bf16_f32 v120, v40, v41
    v_cvt_pk_bf16_f32 v121, v42, v43
    v_cvt_pk_bf16_f32 v122, v44, v45
    v_cvt_pk_bf16_f32 v123, v46, v47
    s_waitcnt vmcnt(10)
    s_nop 1
    v_mfma_f32_32x32x16_bf16 v[104:119], a[104:107], v[120:123], v[104:119]
    v_exp_f32 v48, v48
    v_exp_f32 v49, v49
    v_exp_f32 v50, v50
    v_exp_f32 v51, v51
    v_exp_f32 v52, v52
    v_exp_f32 v53, v53
    v_exp_f32 v54, v54
    v_exp_f32 v55, v55
    s_nop 0
    v_cvt_pk_bf16_f32 v124, v48, v49
    v_cvt_pk_bf16_f32 v125, v50, v51
    v_cvt_pk_bf16_f32 v126, v52, v53
    v_cvt_pk_bf16_f32 v127, v54, v55
    s_nop 1
    v_mfma_f32_32x32x16_bf16 v[104:119], a[108:111], v[124:127], v[104:119]
    s_cmp_eq_u32 s45, 5
    s_cbranch_scc1 L_k2_u0_p2end
    v_mfma_f32_32x32x16_bf16 v[40:55], a[24:27], v[8:11], v[88:103]
    v_mfma_f32_32x32x16_bf16 v[40:55], a[28:31], v[12:15], v[40:55]
    v_exp_f32 v24, v24
    v_exp_f32 v25, v25
    v_exp_f32 v26, v26
    v_exp_f32 v27, v27
    v_exp_f32 v28, v28
    v_exp_f32 v29, v29
    v_exp_f32 v30, v30
    v_exp_f32 v31, v31
    s_nop 0
    v_cvt_pk_bf16_f32 v120, v24, v25
    v_cvt_pk_bf16_f32 v121, v26, v27
    v_cvt_pk_bf16_f32 v122, v28, v29
    v_cvt_pk_bf16_f32 v123, v30, v31
    s_waitcnt vmcnt(8)
    s_nop 1
    v_mfma_f32_32x32x16_bf16 v[104:119], a[112:115], v[120:123], v[104:119]
    v_exp_f32 v32, v32
    v_exp_f32 v33, v33
    v_exp_f32 v34, v34
    v_exp_f32 v35, v35
    v_exp_f32 v36, v36
    v_exp_f32 v37, v37
    v_exp_f32 v38, v38
    v_exp_f32 v39, v39
    s_nop 0
    v_cvt_pk_bf16_f32 v124, v32, v33
    v_cvt_pk_bf16_f32 v125, v34, v35
    v_cvt_pk_bf16_f32 v126, v36, v37
    v_cvt_pk_bf16_f32 v127, v38, v39
    s_nop 1
    v_mfma_f32_32x32x16_bf16 v[104:119], a[116:119], v[124:127], v[104:119]
    s_cmp_eq_u32 s45, 4
    s_cbranch_scc1 L_k2_u0_p2end
    v_mfma_f32_32x32x16_bf16 v[24:39], a[16:19], v[8:11], v[88:103]
    v_mfma_f32_32x32x16_bf16 v[24:39], a[20:23], v[12:15], v[24:39]
    v_exp_f32 v40, v40
    v_exp_f32 v41, v41
    v_exp_f32 v42, v42
    v_exp_f32 v43, v43
    v_exp_f32 v44, v44
    v_exp_f32 v45, v45
    v_exp_f32 v46, v46
    v_exp_f32 v47, v47
    s_nop 0
    v_cvt_pk_bf16_f32 v120, v40, v41
    v_cvt_pk_bf16_f32 v121, v42, v43
    v_cvt_pk_bf16_f32 v122, v44, v45
    v_cvt_pk_bf16_f32 v123, v46, v47
    s_waitcnt vmcnt(6)
    s_nop 1
    v_mfma_f32_32x32x16_bf16 v[104:119], a[120:123], v[120:123], v[104:119]
    v_exp_f32 v48, v48
    v_exp_f32 v49, v49
    v_exp_f32 v50, v50
    v_exp_f32 v51, v51
    v_exp_f32 v52, v52
    v_exp_f32 v53, v53
    v_exp_f32 v54, v54
    v_exp_f32 v55, v55
    s_nop 0
    v_cvt_pk_bf16_f32 v124, v48, v49
    v_cvt_pk_bf16_f32 v125, v50, v51
    v_cvt_pk_bf16_f32 v126, v52, v53
    v_cvt_pk_bf16_f32 v127, v54, v55
    s_nop 1
    v_mfma_f32_32x32x16_bf16 v[104:119], a[124:127], v[124:127], v[104:119]
    s_cmp_eq_u32 s45, 3
    s_cbranch_scc1 L_k2_u0_p2end
    v_mfma_f32_32x32x16_bf16 v[40:55], a[8:11], v[8:11], v[88:103]
    v_mfma_f32_32x32x16_bf16 v[40:55], a[12:15], v[12:15], v[40:55]
    v_exp_f32 v24, v24
    v_exp_f32 v25, v25
    v_exp_f32 v26, v26
    v_exp_f32 v27, v27
    v_exp_f32 v28, v28
    v_exp_f32 v29, v29
    v_exp_f32 v30, v30
    v_exp_f32 v31, v31
    s_nop 0
    v_cvt_pk_bf16_f32 v120, v24, v25
    v_cvt_pk_bf16_f32 v121, v26, v27
    v_cvt_pk_bf16_f32 v122, v28, v29
    v_cvt_pk_bf16_f32 v123, v30, v31
    s_waitcnt vmcnt(4)
    s_nop 1
    v_mfma_f32_32x32x16_bf16 v[104:119], a[80:83], v[120:123], v[104:119]
    v_exp_f32 v32, v32
    v_exp_f32 v33, v33
    v_exp_f32 v34, v34
    v_exp_f32 v35, v35
    v_exp_f32 v36, v36
    v_exp_f32 v37, v37
    v_exp_f32 v38, v38
    v_exp_f32 v39, v39
    s_nop 0
    v_cvt_pk_bf16_f32 v124, v32, v33
    v_cvt_pk_bf16_f32 v125, v34, v35
    v_cvt_pk_bf16_f32 v126, v36, v37
    v_cvt_pk_bf16_f32 v127, v38, v39
    s_nop 1
    v_mfma_f32_32x32x16_bf16 v[104:119], a[84:87], v[124:127], v[104:119]
    s_cmp_eq_u32 s45, 2
    s_cbranch_scc1 L_k2_u0_p2end
    v_mfma_f32_32x32x16_bf16 v[24:39], a[0:3], v[8:11], v[72:87]
    v_mfma_f32_32x32x16_bf16 v[24:39], a[4:7], v[12:15], v[24:39]
    v_exp_f32 v40, v40
    v_exp_f32 v41, v41
    v_exp_f32 v42, v42
    v_exp_f32 v43, v43
    v_exp_f32 v44, v44
    v_exp_f32 v45, v45
    v_exp_f32 v46, v46
    v_exp_f32 v47, v47
    s_nop 0
    v_cvt_pk_bf16_f32 v120, v40, v41
    v_cvt_pk_bf16_f32 v121, v42, v43
    v_cvt_pk_bf16_f32 v122, v44, v45
    v_cvt_pk_bf16_f32 v123, v46, v47
    s_waitcnt vmcnt(2)
    s_nop 1
    v_mfma_f32_32x32x16_bf16 v[104:119], a[88:91], v[120:123], v[104:119]
    v_exp_f32 v48, v48
    v_exp_f32 v49, v49
    v_exp_f32 v50, v50
    v_exp_f32 v51, v51
    v_exp_f32 v52, v52
    v_exp_f32 v53, v53
    v_exp_f32 v54, v54
    v_exp_f32 v55, v55
    s_nop 0
    v_cvt_pk_bf16_f32 v124, v48, v49
    v_cvt_pk_bf16_f32 v125, v50, v51
    v_cvt_pk_bf16_f32 v126, v52, v53
    v_cvt_pk_bf16_f32 v127, v54, v55
    s_nop 1
    v_mfma_f32_32x32x16_bf16 v[104:119], a[92:95], v[124:127], v[104:119]
    s_cmp_eq_u32 s45, 1
    s_cbranch_scc1 L_k2_u0_p2end
    v_exp_f32 v24, v24
    v_exp_f32 v25, v25
    v_exp_f32 v26, v26
    v_exp_f32 v27, v27
    v_exp_f32 v28, v28
    v_exp_f32 v29, v29
    v_exp_f32 v30, v30
    v_exp_f32 v31, v31
    s_nop 0
    v_cvt_pk_bf16_f32 v120, v24, v25
    v_cvt_pk_bf16_f32 v121, v26, v27
    v_cvt_pk_bf16_f32 v122, v28, v29
    v_cvt_pk_bf16_f32 v123, v30, v31
    s_waitcnt vmcnt(0)
    s_nop 1
    v_mfma_f32_32x32x16_bf16 v[104:119], a[96:99], v[120:123], v[104:119]
    v_exp_f32 v32, v32
    v_exp_f32 v33, v33
    v_exp_f32 v34, v34
    v_exp_f32 v35, v35
    v_exp_f32 v36, v36
    v_exp_f32 v37, v37
    v_exp_f32 v38, v38
    v_exp_f32 v39, v39
    s_nop 0
    v_cvt_pk_bf16_f32 v124, v32, v33
    v_cvt_pk_bf16_f32 v125, v34, v35
    v_cvt_pk_bf16_f32 v126, v36, v37
    v_cvt_pk_bf16_f32 v127, v38, v39
    s_nop 1
    v_mfma_f32_32x32x16_bf16 v[104:119], a[100:103], v[124:127], v[104:119]
L_k2_u0_p2end:
    s_nop 11
    s_mul_i32 s32, s41, 40960
    s_add_u32 s33, s32, s59
    s_add_u32 s34, s32, s60
    v_rcp_f32 v4, v116
    s_nop 0
    v_mul_f32 v104, v104, v4
    v_mul_f32 v105, v105, v4
    v_mul_f32 v106, v106, v4
    v_mul_f32 v107, v107, v4
    v_mul_f32 v108, v108, v4
    v_mul_f32 v109, v109, v4
    v_mul_f32 v110, v110, v4
    v_mul_f32 v111, v111, v4
    v_mul_f32 v112, v112, v4
    v_mul_f32 v113, v113, v4
    v_cvt_pk_bf16_f32 v88, v104, v105
    v_cvt_pk_bf16_f32 v89, v106, v107
    v_cvt_pk_bf16_f32 v90, v108, v109
    v_cvt_pk_bf16_f32 v91, v110, v111
    v_cvt_pk_bf16_f32 v92, v112, v113
    buffer_store_dwordx4 v[88:91], v5, s[12:15], s33 offen sc1
    buffer_store_dword v92, v6, s[12:15], s34 offen sc1
    s_waitcnt vmcnt(0)
    v_mov_b32 v3, 0
    v_mov_b32 v4, 1
    s_mov_b64 exec, 1
    buffer_atomic_add v4, v3, s[12:15], s55 offen sc1
    s_mov_b64 exec, -1
L_k2_fin:
L_k2_end:
L_k1_end:
    s_endpgm
L_text_end:
.section .rodata,"a"
.p2align 6
.amdhsa_kernel parallel_sum__sliding_block__dense_activation_gelu__prompt_kernel
  .amdhsa_next_free_vgpr 256
  .amdhsa_next_free_sgpr 84
  .amdhsa_accum_offset 128
  .amdhsa_group_segment_fixed_size 0
  .amdhsa_kernarg_size 88
  .amdhsa_user_sgpr_count 2
  .amdhsa_user_sgpr_kernarg_segment_ptr 1
  .amdhsa_system_sgpr_workgroup_id_x 1
.end_amdhsa_kernel
```
